```python
import torch

def _softmax(x, axis=-1):
    return torch.softmax(x, dim=axis)
def _gelu(x):
    return torch.nn.functional.gelu(x, approximate="tanh")
def _silu(x):
    return torch.nn.functional.silu(x)
def _sigmoid(x):
    return torch.sigmoid(x)
def _layernorm(x, axis=-1, eps=1e-5):
    m = x.mean(dim=axis, keepdim=True)
    v = x.var(dim=axis, keepdim=True, unbiased=False)
    return (x - m) / torch.sqrt(v + eps)
def _scatter_add(tgt, idx, src, axis=0):
    return tgt.clone().index_add_(axis, idx, src)
def _segment_sum(src, seg, n):
    out = torch.zeros((n,) + src.shape[1:], dtype=src.dtype)
    return out.index_add_(0, seg, src)
def _pad(x, pw):
    flat = tuple(v for pair in reversed(pw) for v in pair)
    return torch.nn.functional.pad(x, flat)

kernel_name = 'standalone__mha_softmax__near_ridge'

def setup_inputs():

    _w = (lambda a: (lambda t: t.to(torch.bfloat16) if t.is_floating_point() else t)(torch.as_tensor(a)))
    B, H, Sq, Sk, D = 16, 16, 848, 512, 256
    return {
        "q": _w((lambda *s: torch.randn(*s, dtype=torch.bfloat16) * 0.8)(B, H, Sq, D)),
        "k": _w((lambda *s: torch.randn(*s, dtype=torch.bfloat16) * 0.8)(B, H, Sk, D)),
        "v": _w((lambda *s: torch.randn(*s, dtype=torch.bfloat16) * 0.05)(B, H, Sk, D)),
    }

def reference(q, k, v):
    scale = q.shape[-1] ** -0.5
    scores = torch.einsum("bhqd,bhkd->bhqk", q, k) * scale
    p = _softmax(scores, axis=-1)
    return torch.einsum("bhqk,bhkd->bhqd", p, v)
```

```asm
; @launch grid=(256,1,1) block=(256,1,1) lds=156160
.amdgcn_target "amdgcn-amd-amdhsa--gfx950"
.text
.globl standalone__mha_softmax__near_ridge_kernel
.p2align 8
.type standalone__mha_softmax__near_ridge_kernel,@function
standalone__mha_softmax__near_ridge_kernel:
s_cmp_ge_u32 s2, 256
s_cbranch_scc1 L_end
s_load_dwordx4 s[56:59], s[0:1], 0
s_load_dwordx4 s[60:63], s[0:1], 16
s_getpc_b64 s[6:7]
L_pc:
s_lshr_b32 s3, s2, 3
s_cmp_ge_u32 s3, 18
s_cselect_b32 s4, 18, 0
s_sub_u32 s3, s3, s4
s_lshl_b32 s3, s3, 12
v_lshl_add_u32 v192, v0, 4, s3
v_min_u32 v192, L_codeend2-L_pc-4, v192
global_load_dword v193, v192, s[6:7]
v_lshrrev_b32 v1, 6, v0
v_and_b32 v3, 31, v0
v_readfirstlane_b32 s25, v1
v_bfe_u32 v4, v0, 5, 1
v_lshlrev_b32 v243, 12, v4
v_lshl_add_u32 v243, v3, 4, v243
s_lshr_b32 s3, s2, 5
s_and_b32 s44, s2, 7
s_lshl_b32 s44, s44, 5
s_add_u32 s44, s44, s3
s_mul_i32 s54, s44, 53
s_mov_b32 s52, 0x295c10c0
s_mov_b32 s53, 0x2c9f13c4
s_bitcmp1_b32 s25, 1
s_cselect_b32 s52, 0x2f2316c8, s52
s_cselect_b32 s53, 0x322619cc, s53
s_bitcmp1_b32 s25, 0
s_cselect_b32 s52, s53, s52
s_mov_b32 s53, s52
s_and_b32 s3, s2, 24
s_lshr_b64 s[52:53], s[52:53], s3
s_bfe_u32 s46, s52, 0x60000
s_add_u32 s46, s46, s54
s_lshl_b32 s36, s46, 13
s_mul_i32 s4, s25, 16896
s_add_u32 s4, s4, 70144
s_mov_b32 s10, 0x6a00000
s_mov_b32 s11, 0x20000
v_and_b32 v2, 63, v0
v_lshlrev_b32 v242, 12, v1
v_lshl_add_u32 v242, v2, 4, v242
s_mul_i32 s26, s25, 4224
s_lshl_b32 s32, s44, 18
s_mov_b32 s14, 0x4000000
s_mov_b32 s15, s11
s_mov_b32 s5, s4
s_mov_b32 s38, s36
s_mov_b32 s39, 0
s_mov_b32 s29, s32
s_mov_b32 s47, s26
s_waitcnt lgkmcnt(0)
s_mov_b64 s[8:9], s[56:57]
s_mov_b64 s[12:13], s[58:59]
L_q01:
s_mov_b32 m0, s5
s_add_u32 s39, s39, 1
buffer_load_dwordx4 v243, s[8:11], s38 offen nt lds
s_add_u32 m0, s5, 544
s_add_u32 s5, s5, 2112
buffer_load_dwordx4 v243, s[8:11], s38 offen offset:512 nt lds
s_mov_b32 m0, s47
s_cmp_eq_u32 s39, 4
buffer_load_dwordx4 v242, s[12:15], s29 offen lds
s_cselect_b32 s3, 5, 1
s_cselect_b32 s48, 13, 1
s_lshl_b32 s3, s3, 10
s_add_u32 s38, s38, s3
s_lshl_b32 s3, s48, 10
s_add_u32 s29, s29, s3
s_mul_i32 s3, s48, 1056
s_add_u32 s47, s47, s3
s_cmp_lt_u32 s39, 8
s_cbranch_scc1 L_q01
s_add_u32 s29, s32, 32768
s_mov_b32 s30, s32
s_mov_b32 s18, 0x4000000
s_mov_b32 s19, 0x20000
s_mov_b32 s22, 0x6a00000
s_mov_b32 s23, 0x20000
s_mov_b64 s[16:17], s[60:61]
s_mov_b64 s[20:21], s[62:63]
s_bfe_u32 s41, s52, 0x20006
s_cmp_eq_u32 s41, 1
s_cselect_b32 s50, 6, 3
s_lshl_b32 s50, s50, 13
s_add_u32 s37, s36, s50
s_bitcmp1_b32 s41, 0
s_cselect_b32 s37, s37, 0x70000000
s_mov_b32 s69, s41
v_and_b32 v3, 15, v2
v_lshrrev_b32 v4, 4, v2
v_mul_u32_u24 v240, 1056, v3
v_lshl_add_u32 v240, v4, 4, v240
v_lshrrev_b32 v5, 2, v3
v_lshl_add_u32 v5, v4, 2, v5
v_mul_u32_u24 v241, 1040, v5
v_and_b32 v5, 1, v3
v_lshl_add_u32 v241, v5, 3, v241
v_bfe_u32 v5, v3, 1, 1
v_lshl_add_u32 v241, v5, 7, v241
v_add_u32 v241, 36864, v241
v_lshlrev_b32 v244, 9, v4
v_lshl_add_u32 v244, v3, 4, v244
v_mul_u32_u24 v6, 4608, v1
v_add_u32 v6, 137728, v6
v_mul_u32_u24 v245, 1152, v4
v_lshl_add_u32 v245, v3, 3, v245
v_add_u32 v245, v6, v245
v_mul_u32_u24 v254, 288, v4
v_bfe_u32 v5, v3, 1, 1
v_lshl_add_u32 v254, v5, 6, v254
v_and_b32 v5, 1, v3
v_lshl_add_u32 v254, v5, 7, v254
v_lshrrev_b32 v5, 2, v3
v_lshl_add_u32 v254, v5, 3, v254
v_add_u32 v254, v6, v254
s_mul_i32 s3, s25, 4160
v_and_b32 v5, 7, v3
v_mul_u32_u24 v255, 1056, v5
v_lshrrev_b32 v5, 3, v3
v_lshl_add_u32 v255, v5, 9, v255
v_lshl_add_u32 v255, v4, 4, v255
v_add_u32 v255, s4, v255
s_mov_b32 s27, 0x3db8aa3b
s_mov_b32 s28, 0x4e800000
s_mov_b32 s24, 0
s_mov_b64 vcc, -1
s_bfe_u32 s46, s52, 0x60008
s_add_u32 s46, s46, s54
s_add_u32 s46, s46, 424
s_lshl_b32 s56, s46, 13
s_bfe_u32 s41, s52, 0x2000e
s_cmp_eq_u32 s41, 1
s_cselect_b32 s50, 6, 3
s_lshl_b32 s50, s50, 13
s_add_u32 s57, s56, s50
s_bitcmp1_b32 s41, 0
s_cselect_b32 s57, s57, 0x70000000
s_lshl_b32 s41, s41, 2
s_or_b32 s69, s69, s41
s_bfe_u32 s46, s52, 0x60010
s_add_u32 s46, s46, s54
s_add_u32 s46, s46, 848
s_lshl_b32 s58, s46, 13
s_bfe_u32 s41, s52, 0x20016
s_cmp_eq_u32 s41, 1
s_cselect_b32 s50, 6, 3
s_lshl_b32 s50, s50, 13
s_add_u32 s59, s58, s50
s_bitcmp1_b32 s41, 0
s_cselect_b32 s59, s59, 0x70000000
s_lshl_b32 s41, s41, 4
s_or_b32 s69, s69, s41
s_bfe_u32 s46, s52, 0x60018
s_add_u32 s46, s46, s54
s_add_u32 s46, s46, 1272
s_lshl_b32 s60, s46, 13
s_bfe_u32 s41, s52, 0x2001e
s_cmp_eq_u32 s41, 1
s_cselect_b32 s50, 6, 3
s_lshl_b32 s50, s50, 13
s_add_u32 s61, s60, s50
s_bitcmp1_b32 s41, 0
s_cselect_b32 s61, s61, 0x70000000
s_lshl_b32 s41, s41, 6
s_or_b32 s69, s69, s41
s_mov_b32 s62, 0x70000000
s_mov_b32 s63, 0x70000000
s_waitcnt vmcnt(13)
ds_read_b128 a[0:3], v255 offset:0
ds_read_b128 a[4:7], v255 offset:64
ds_read_b128 a[8:11], v255 offset:128
ds_read_b128 a[12:15], v255 offset:192
ds_read_b128 a[16:19], v255 offset:256
ds_read_b128 a[20:23], v255 offset:320
ds_read_b128 a[24:27], v255 offset:384
ds_read_b128 a[28:31], v255 offset:448
s_add_u32 s38, s36, 16384
s_add_u32 m0, s4, 0
s_waitcnt lgkmcnt(0)
buffer_load_dwordx4 v243, s[8:11], s38 offen offset:0 nt lds
s_add_u32 m0, s4, 544
s_nop 0
buffer_load_dwordx4 v243, s[8:11], s38 offen offset:512 nt lds
s_add_u32 m0, s4, 1088
s_nop 0
buffer_load_dwordx4 v243, s[8:11], s38 offen offset:1024 nt lds
s_add_u32 m0, s4, 1632
s_nop 0
buffer_load_dwordx4 v243, s[8:11], s38 offen offset:1536 nt lds
s_add_u32 m0, s4, 2176
s_nop 0
buffer_load_dwordx4 v243, s[8:11], s38 offen offset:2048 nt lds
s_add_u32 m0, s4, 2720
s_nop 0
buffer_load_dwordx4 v243, s[8:11], s38 offen offset:2560 nt lds
s_add_u32 m0, s4, 3264
s_nop 0
buffer_load_dwordx4 v243, s[8:11], s38 offen offset:3072 nt lds
s_add_u32 m0, s4, 3808
s_nop 0
buffer_load_dwordx4 v243, s[8:11], s38 offen offset:3584 nt lds
s_waitcnt vmcnt(9)
ds_read_b128 a[32:35], v255 offset:8448
ds_read_b128 a[36:39], v255 offset:8512
ds_read_b128 a[40:43], v255 offset:8576
ds_read_b128 a[44:47], v255 offset:8640
ds_read_b128 a[48:51], v255 offset:8704
ds_read_b128 a[52:55], v255 offset:8768
ds_read_b128 a[56:59], v255 offset:8832
ds_read_b128 a[60:63], v255 offset:8896
s_mov_b32 s38, s37
s_add_u32 m0, s4, 8448
s_waitcnt lgkmcnt(0)
buffer_load_dwordx4 v243, s[8:11], s38 offen offset:0 nt lds
s_add_u32 m0, s4, 8992
s_nop 0
buffer_load_dwordx4 v243, s[8:11], s38 offen offset:512 nt lds
s_add_u32 m0, s4, 9536
s_nop 0
buffer_load_dwordx4 v243, s[8:11], s38 offen offset:1024 nt lds
s_add_u32 m0, s4, 10080
s_nop 0
buffer_load_dwordx4 v243, s[8:11], s38 offen offset:1536 nt lds
s_add_u32 m0, s4, 10624
s_nop 0
buffer_load_dwordx4 v243, s[8:11], s38 offen offset:2048 nt lds
s_add_u32 m0, s4, 11168
s_nop 0
buffer_load_dwordx4 v243, s[8:11], s38 offen offset:2560 nt lds
s_add_u32 m0, s4, 11712
s_nop 0
buffer_load_dwordx4 v243, s[8:11], s38 offen offset:3072 nt lds
s_add_u32 m0, s4, 12256
s_nop 0
buffer_load_dwordx4 v243, s[8:11], s38 offen offset:3584 nt lds
s_add_u32 m0, s3, 36864
s_nop 0
buffer_load_dwordx4 v242, s[16:19], s30 offen offset:0 lds
s_add_u32 m0, s3, 36880
s_nop 0
buffer_load_dwordx4 v242, s[16:19], s30 offen offset:1024 lds
s_add_u32 m0, s3, 36896
s_nop 0
buffer_load_dwordx4 v242, s[16:19], s30 offen offset:2048 lds
s_add_u32 m0, s3, 36912
s_nop 0
buffer_load_dwordx4 v242, s[16:19], s30 offen offset:3072 lds
s_add_u32 s30, s30, 16384
s_nop 0
s_barrier
ds_read_b128 a[192:195], v240 offset:0
ds_read_b128 a[196:199], v240 offset:64
ds_read_b128 a[200:203], v240 offset:128
ds_read_b128 a[204:207], v240 offset:192
ds_read_b128 a[208:211], v240 offset:256
ds_read_b128 a[212:215], v240 offset:320
ds_read_b128 a[216:219], v240 offset:384
ds_read_b128 a[220:223], v240 offset:448
s_waitcnt lgkmcnt(8)
L_blk:
s_mov_b64 s[34:35], s[36:37]
s_mov_b64 s[36:37], s[56:57]
s_mov_b64 s[56:57], s[58:59]
s_mov_b64 s[58:59], s[60:61]
s_mov_b64 s[60:61], s[62:63]
s_mov_b32 s31, s32
s_add_u32 s32, s32, 0x200000
s_add_u32 s24, s24, 1
s_cmp_eq_u32 s24, 4
s_cselect_b32 s32, 0x70000000, s32
s_mov_b32 s38, s36
s_add_u32 s33, s36, 8192
s_mov_b32 s5, s4
s_mov_b32 s39, 5
s_bitcmp1_b32 s69, 1
s_cselect_b32 s40, 4, 3
s_and_b32 s41, s69, 3
s_lshr_b32 s69, s69, 2
s_cmp_eq_u32 s41, 0
s_cbranch_scc1 L_blk3
s_cmp_eq_u32 s41, 1
s_cbranch_scc1 L_blkq
s_cmp_eq_u32 s41, 2
s_cbranch_scc1 L_blkp
L_blk4:
s_waitcnt lgkmcnt(7)
v_mfma_f32_16x16x32_bf16 v[192:195], a[192:195], a[0:3], 0
s_waitcnt lgkmcnt(6)
ds_read_b128 a[252:255], v240 offset:960
ds_read_b128 a[248:251], v240 offset:896
v_mfma_f32_16x16x32_bf16 v[192:195], a[196:199], a[4:7], v[192:195]
s_waitcnt lgkmcnt(7)
ds_read_b128 a[244:247], v240 offset:832
ds_read_b128 a[240:243], v240 offset:768
v_mfma_f32_16x16x32_bf16 v[192:195], a[200:203], a[8:11], v[192:195]
s_waitcnt lgkmcnt(8)
ds_read_b128 a[236:239], v240 offset:704
ds_read_b128 a[232:235], v240 offset:640
v_mfma_f32_16x16x32_bf16 v[192:195], a[204:207], a[12:15], v[192:195]
s_waitcnt lgkmcnt(9)
ds_read_b128 a[228:231], v240 offset:576
ds_read_b128 a[224:227], v240 offset:512
v_mfma_f32_16x16x32_bf16 v[192:195], a[208:211], a[16:19], v[192:195]
s_waitcnt lgkmcnt(10)
v_mov_b32 v250, 0
v_mov_b32 v251, 0
v_mfma_f32_16x16x32_bf16 v[192:195], a[212:215], a[20:23], v[192:195]
s_waitcnt lgkmcnt(9)
v_mov_b32 v252, 0
v_mov_b32 v253, 0
v_mfma_f32_16x16x32_bf16 v[192:195], a[216:219], a[24:27], v[192:195]
s_waitcnt lgkmcnt(8)
v_mfma_f32_16x16x32_bf16 v[192:195], a[220:223], a[28:31], v[192:195]
s_waitcnt lgkmcnt(7)
v_mfma_f32_16x16x32_bf16 v[208:211], a[252:255], a[28:31], 0
s_waitcnt lgkmcnt(6)
v_mfma_f32_16x16x32_bf16 v[208:211], a[248:251], a[24:27], v[208:211]
s_waitcnt lgkmcnt(5)
v_mfma_f32_16x16x32_bf16 v[208:211], a[244:247], a[20:23], v[208:211]
s_cbranch_vccz L_cw1
s_waitcnt vmcnt(20)
L_cw1:
s_waitcnt lgkmcnt(4)
v_mfma_f32_16x16x32_bf16 v[208:211], a[240:243], a[16:19], v[208:211]
s_waitcnt lgkmcnt(0)
v_max3_f32 v246, v192, v193, v194
v_max_f32 v246, v246, v195
v_mfma_f32_16x16x32_bf16 v[208:211], a[236:239], a[12:15], v[208:211]
s_barrier
v_mfma_f32_16x16x32_bf16 v[208:211], a[232:235], a[8:11], v[208:211]
s_add_u32 m0, s26, 0
v_mov_b32 v224, v246
v_mfma_f32_16x16x32_bf16 v[208:211], a[228:231], a[4:7], v[208:211]
buffer_load_dwordx4 v242, s[12:15], s29 offen offset:0 lds
v_mfma_f32_16x16x32_bf16 v[208:211], a[224:227], a[0:3], v[208:211]
v_permlane32_swap_b32 v246, v224
v_mfma_f32_16x16x32_bf16 v[212:215], a[224:227], a[32:35], 0
v_max_f32 v246, v246, v224
v_mov_b32 v224, v246
v_mfma_f32_16x16x32_bf16 v[212:215], a[228:231], a[36:39], v[212:215]
s_add_u32 m0, s26, 32
v_permlane16_swap_b32 v246, v224
v_mfma_f32_16x16x32_bf16 v[212:215], a[232:235], a[40:43], v[212:215]
buffer_load_dwordx4 v242, s[12:15], s29 offen offset:1024 lds
v_mfma_f32_16x16x32_bf16 v[212:215], a[236:239], a[44:47], v[212:215]
v_max_f32 v246, v246, v224
v_mul_f32 v246, s27, v246
v_mfma_f32_16x16x32_bf16 v[212:215], a[240:243], a[48:51], v[212:215]
s_cbranch_vccz L_cw2
s_waitcnt vmcnt(14)
L_cw2:
v_fma_f32 v192, v192, s27, -v246
v_fma_f32 v193, v193, s27, -v246
v_mfma_f32_16x16x32_bf16 v[212:215], a[244:247], a[52:55], v[212:215]
v_exp_f32 v192, v192
v_mfma_f32_16x16x32_bf16 v[212:215], a[248:251], a[56:59], v[212:215]
v_fma_f32 v194, v194, s27, -v246
v_fma_f32 v195, v195, s27, -v246
v_mfma_f32_16x16x32_bf16 v[212:215], a[252:255], a[60:63], v[212:215]
s_add_u32 m0, s26, 64
v_exp_f32 v193, v193
v_mfma_f32_16x16x32_bf16 v[196:199], a[220:223], a[60:63], 0
buffer_load_dwordx4 v242, s[12:15], s29 offen offset:2048 lds
v_mfma_f32_16x16x32_bf16 v[196:199], a[216:219], a[56:59], v[196:199]
v_add_f32 v250, v250, v192
v_add_f32 v250, v250, v193
v_mfma_f32_16x16x32_bf16 v[196:199], a[212:215], a[52:55], v[196:199]
v_exp_f32 v194, v194
v_mfma_f32_16x16x32_bf16 v[196:199], a[208:211], a[48:51], v[196:199]
s_add_u32 m0, s26, 96
v_cvt_pk_bf16_f32 v192, v192, v193
v_add_f32 v250, v250, v194
v_mfma_f32_16x16x32_bf16 v[196:199], a[204:207], a[44:47], v[196:199]
ds_read_b128 a[64:67], v255 offset:0
buffer_load_dwordx4 v242, s[12:15], s29 offen offset:3072 lds
v_mfma_f32_16x16x32_bf16 v[196:199], a[200:203], a[40:43], v[196:199]
s_add_u32 s29, s29, 16384
ds_read_b128 a[68:71], v255 offset:64
v_fma_f32 v208, v208, s27, -v246
v_mfma_f32_16x16x32_bf16 v[196:199], a[196:199], a[36:39], v[196:199]
ds_read_b128 a[72:75], v255 offset:128
v_fma_f32 v209, v209, s27, -v246
v_mfma_f32_16x16x32_bf16 v[196:199], a[192:195], a[32:35], v[196:199]
s_waitcnt lgkmcnt(2)
ds_read_b128 a[76:79], v255 offset:192
v_fma_f32 v210, v210, s27, -v246
v_mfma_f32_16x16x32_bf16 v[200:203], a[192:195], a[64:67], 0
s_waitcnt lgkmcnt(2)
ds_read_b128 a[80:83], v255 offset:256
v_fma_f32 v211, v211, s27, -v246
v_mfma_f32_16x16x32_bf16 v[200:203], a[196:199], a[68:71], v[200:203]
s_waitcnt lgkmcnt(2)
s_add_u32 m0, s3, 53504
ds_read_b128 a[84:87], v255 offset:320
ds_read_b128 a[88:91], v255 offset:384
v_mfma_f32_16x16x32_bf16 v[200:203], a[200:203], a[72:75], v[200:203]
s_waitcnt lgkmcnt(3)
buffer_load_dwordx4 v242, s[16:19], s30 offen offset:0 lds
v_mfma_f32_16x16x32_bf16 v[200:203], a[204:207], a[76:79], v[200:203]
s_waitcnt lgkmcnt(2)
ds_read_b128 a[92:95], v255 offset:448
v_max3_f32 v247, v196, v197, v198
v_mfma_f32_16x16x32_bf16 v[200:203], a[208:211], a[80:83], v[200:203]
s_cbranch_vccz L_cw3
s_waitcnt vmcnt(9)
L_cw3:
v_max_f32 v247, v247, v199
v_mov_b32 v225, v247
s_waitcnt lgkmcnt(2)
v_mfma_f32_16x16x32_bf16 v[200:203], a[212:215], a[84:87], v[200:203]
s_waitcnt lgkmcnt(1)
v_permlane32_swap_b32 v247, v225
v_mfma_f32_16x16x32_bf16 v[200:203], a[216:219], a[88:91], v[200:203]
s_waitcnt lgkmcnt(0)
s_add_u32 m0, s3, 53520
v_max_f32 v247, v247, v225
v_mov_b32 v225, v247
v_mfma_f32_16x16x32_bf16 v[200:203], a[220:223], a[92:95], v[200:203]
buffer_load_dwordx4 v242, s[16:19], s30 offen offset:1024 lds
v_mfma_f32_16x16x32_bf16 v[216:219], a[252:255], a[92:95], 0
v_permlane16_swap_b32 v247, v225
v_mfma_f32_16x16x32_bf16 v[216:219], a[248:251], a[88:91], v[216:219]
v_max_f32 v247, v247, v225
v_mul_f32 v247, s27, v247
v_mfma_f32_16x16x32_bf16 v[216:219], a[244:247], a[84:87], v[216:219]
v_exp_f32 v195, v195
v_mfma_f32_16x16x32_bf16 v[216:219], a[240:243], a[80:83], v[216:219]
s_add_u32 m0, s3, 53536
v_max3_f32 v248, v200, v201, v202
v_max_f32 v248, v248, v203
v_mfma_f32_16x16x32_bf16 v[216:219], a[236:239], a[76:79], v[216:219]
ds_read_b128 a[96:99], v255 offset:8448
buffer_load_dwordx4 v242, s[16:19], s30 offen offset:2048 lds
v_mfma_f32_16x16x32_bf16 v[216:219], a[232:235], a[72:75], v[216:219]
ds_read_b128 a[100:103], v255 offset:8512
v_mov_b32 v226, v248
v_mfma_f32_16x16x32_bf16 v[216:219], a[228:231], a[68:71], v[216:219]
ds_read_b128 a[104:107], v255 offset:8576
v_add_f32 v250, v250, v195
v_mfma_f32_16x16x32_bf16 v[216:219], a[224:227], a[64:67], v[216:219]
s_waitcnt lgkmcnt(2)
ds_read_b128 a[108:111], v255 offset:8640
v_cvt_pk_bf16_f32 v193, v194, v195
v_mfma_f32_16x16x32_bf16 v[204:207], a[192:195], a[96:99], 0
s_waitcnt lgkmcnt(2)
s_add_u32 m0, s3, 53552
ds_read_b128 a[112:115], v255 offset:8704
v_fma_f32 v196, v196, s27, -v247
v_mfma_f32_16x16x32_bf16 v[204:207], a[196:199], a[100:103], v[204:207]
s_waitcnt lgkmcnt(2)
ds_read_b128 a[116:119], v255 offset:8768
buffer_load_dwordx4 v242, s[16:19], s30 offen offset:3072 lds
v_mfma_f32_16x16x32_bf16 v[204:207], a[200:203], a[104:107], v[204:207]
s_waitcnt lgkmcnt(2)
s_add_u32 s30, s30, 16384
ds_read_b128 a[120:123], v255 offset:8832
v_fma_f32 v197, v197, s27, -v247
v_mfma_f32_16x16x32_bf16 v[204:207], a[204:207], a[108:111], v[204:207]
s_waitcnt lgkmcnt(2)
ds_read_b128 a[124:127], v255 offset:8896
v_fma_f32 v198, v198, s27, -v247
v_mfma_f32_16x16x32_bf16 v[204:207], a[208:211], a[112:115], v[204:207]
s_waitcnt lgkmcnt(2)
v_permlane32_swap_b32 v248, v226
v_mfma_f32_16x16x32_bf16 v[204:207], a[212:215], a[116:119], v[204:207]
s_waitcnt lgkmcnt(1)
v_max_f32 v248, v248, v226
v_mov_b32 v226, v248
v_mfma_f32_16x16x32_bf16 v[204:207], a[216:219], a[120:123], v[204:207]
s_waitcnt lgkmcnt(0)
v_permlane16_swap_b32 v248, v226
v_mfma_f32_16x16x32_bf16 v[204:207], a[220:223], a[124:127], v[204:207]
v_max_f32 v248, v248, v226
v_mul_f32 v248, s27, v248
v_mfma_f32_16x16x32_bf16 v[220:223], a[252:255], a[124:127], 0
v_exp_f32 v208, v208
v_mfma_f32_16x16x32_bf16 v[220:223], a[248:251], a[120:123], v[220:223]
v_exp_f32 v209, v209
v_mfma_f32_16x16x32_bf16 v[220:223], a[244:247], a[116:119], v[220:223]
v_add_f32 v250, v250, v208
v_add_f32 v250, v250, v209
v_mfma_f32_16x16x32_bf16 v[220:223], a[240:243], a[112:115], v[220:223]
v_max3_f32 v249, v204, v205, v206
v_max_f32 v249, v249, v207
v_mfma_f32_16x16x32_bf16 v[220:223], a[236:239], a[108:111], v[220:223]
v_mov_b32 v227, v249
v_cvt_pk_bf16_f32 v194, v208, v209
v_mfma_f32_16x16x32_bf16 v[220:223], a[232:235], a[104:107], v[220:223]
v_permlane32_swap_b32 v249, v227
v_mfma_f32_16x16x32_bf16 v[220:223], a[228:231], a[100:103], v[220:223]
v_max_f32 v249, v249, v227
v_mov_b32 v227, v249
v_exp_f32 v210, v210
v_exp_f32 v211, v211
v_exp_f32 v196, v196
v_fma_f32 v199, v199, s27, -v247
v_exp_f32 v197, v197
v_exp_f32 v198, v198
v_exp_f32 v199, v199
v_mfma_f32_16x16x32_bf16 v[220:223], a[224:227], a[96:99], v[220:223]
ds_read_b128 a[192:195], v240 offset:16896
ds_read_b128 a[196:199], v240 offset:16960
ds_read_b128 a[200:203], v240 offset:17024
ds_read_b128 a[204:207], v240 offset:17088
ds_read_b128 a[208:211], v240 offset:17152
ds_read_b128 a[212:215], v240 offset:17216
ds_read_b128 a[216:219], v240 offset:17280
ds_read_b128 a[220:223], v240 offset:17344
v_permlane16_swap_b32 v249, v227
v_max_f32 v249, v249, v227
v_mul_f32 v249, s27, v249
v_add_f32 v250, v250, v210
v_add_f32 v250, v250, v211
v_cvt_pk_bf16_f32 v195, v210, v211
v_add_f32 v251, v251, v196
v_add_f32 v251, v251, v197
v_cvt_pk_bf16_f32 v196, v196, v197
v_add_f32 v251, v251, v198
v_add_f32 v251, v251, v199
v_cvt_pk_bf16_f32 v197, v198, v199
s_waitcnt lgkmcnt(7)
v_mfma_f32_16x16x32_bf16 v[224:227], a[192:195], a[0:3], 0
s_waitcnt lgkmcnt(6)
ds_read_b128 a[224:227], v240 offset:17408
v_fma_f32 v212, v212, s27, -v247
v_mfma_f32_16x16x32_bf16 v[224:227], a[196:199], a[4:7], v[224:227]
s_waitcnt lgkmcnt(6)
v_fma_f32 v213, v213, s27, -v247
v_mfma_f32_16x16x32_bf16 v[224:227], a[200:203], a[8:11], v[224:227]
s_waitcnt lgkmcnt(5)
v_exp_f32 v212, v212
v_mfma_f32_16x16x32_bf16 v[224:227], a[204:207], a[12:15], v[224:227]
s_waitcnt lgkmcnt(4)
ds_read_b128 a[228:231], v240 offset:17472
v_fma_f32 v214, v214, s27, -v247
v_mfma_f32_16x16x32_bf16 v[224:227], a[208:211], a[16:19], v[224:227]
s_waitcnt lgkmcnt(4)
v_fma_f32 v215, v215, s27, -v247
v_add_f32 v251, v251, v212
v_mfma_f32_16x16x32_bf16 v[224:227], a[212:215], a[20:23], v[224:227]
s_waitcnt lgkmcnt(3)
v_exp_f32 v213, v213
v_mfma_f32_16x16x32_bf16 v[224:227], a[216:219], a[24:27], v[224:227]
s_waitcnt lgkmcnt(2)
ds_read_b128 a[232:235], v240 offset:17536
v_add_f32 v251, v251, v213
v_mfma_f32_16x16x32_bf16 v[224:227], a[220:223], a[28:31], v[224:227]
v_exp_f32 v214, v214
v_mfma_f32_16x16x32_bf16 v[228:231], a[220:223], a[60:63], 0
s_add_u32 m0, s5, 0
ds_read_b128 a[236:239], v240 offset:17600
v_cvt_pk_bf16_f32 v198, v212, v213
v_mfma_f32_16x16x32_bf16 v[228:231], a[216:219], a[56:59], v[228:231]
buffer_load_dwordx4 v243, s[8:11], s38 offen nt lds
v_mfma_f32_16x16x32_bf16 v[228:231], a[212:215], a[52:55], v[228:231]
s_add_u32 s38, s38, 512
v_exp_f32 v215, v215
v_mfma_f32_16x16x32_bf16 v[228:231], a[208:211], a[48:51], v[228:231]
ds_read_b128 a[240:243], v240 offset:17664
v_add_f32 v251, v251, v214
v_mfma_f32_16x16x32_bf16 v[228:231], a[204:207], a[44:47], v[228:231]
v_add_f32 v251, v251, v215
v_cvt_pk_bf16_f32 v199, v214, v215
v_mfma_f32_16x16x32_bf16 v[228:231], a[200:203], a[40:43], v[228:231]
v_fma_f32 v200, v200, s27, -v248
v_fma_f32 v201, v201, s27, -v248
v_mfma_f32_16x16x32_bf16 v[228:231], a[196:199], a[36:39], v[228:231]
ds_read_b128 a[244:247], v240 offset:17728
v_fma_f32 v202, v202, s27, -v248
v_mfma_f32_16x16x32_bf16 v[228:231], a[192:195], a[32:35], v[228:231]
v_exp_f32 v200, v200
v_mfma_f32_16x16x32_bf16 v[232:235], a[192:195], a[64:67], 0
ds_read_b128 a[248:251], v240 offset:17792
v_fma_f32 v203, v203, s27, -v248
v_mfma_f32_16x16x32_bf16 v[232:235], a[196:199], a[68:71], v[232:235]
v_exp_f32 v201, v201
v_mfma_f32_16x16x32_bf16 v[232:235], a[200:203], a[72:75], v[232:235]
s_add_u32 m0, s5, 8448
ds_read_b128 a[252:255], v240 offset:17856
v_add_f32 v252, v252, v200
v_mfma_f32_16x16x32_bf16 v[232:235], a[204:207], a[76:79], v[232:235]
s_add_u32 s5, s5, 1056
buffer_load_dwordx4 v243, s[8:11], s33 offen nt lds
v_mfma_f32_16x16x32_bf16 v[232:235], a[208:211], a[80:83], v[232:235]
s_add_u32 s33, s33, 512
v_exp_f32 v202, v202
v_mfma_f32_16x16x32_bf16 v[232:235], a[212:215], a[84:87], v[232:235]
v_add_f32 v252, v252, v201
v_cvt_pk_bf16_f32 v200, v200, v201
v_mfma_f32_16x16x32_bf16 v[232:235], a[216:219], a[88:91], v[232:235]
v_exp_f32 v203, v203
v_mfma_f32_16x16x32_bf16 v[232:235], a[220:223], a[92:95], v[232:235]
v_add_f32 v252, v252, v202
v_add_f32 v252, v252, v203
v_mfma_f32_16x16x32_bf16 v[236:239], a[220:223], a[124:127], 0
v_cvt_pk_bf16_f32 v201, v202, v203
v_fma_f32 v216, v216, s27, -v248
v_mfma_f32_16x16x32_bf16 v[236:239], a[216:219], a[120:123], v[236:239]
v_fma_f32 v217, v217, s27, -v248
v_fma_f32 v218, v218, s27, -v248
v_mfma_f32_16x16x32_bf16 v[236:239], a[212:215], a[116:119], v[236:239]
v_exp_f32 v216, v216
v_mfma_f32_16x16x32_bf16 v[236:239], a[208:211], a[112:115], v[236:239]
v_fma_f32 v219, v219, s27, -v248
v_add_f32 v252, v252, v216
v_mfma_f32_16x16x32_bf16 v[236:239], a[204:207], a[108:111], v[236:239]
v_exp_f32 v217, v217
v_mfma_f32_16x16x32_bf16 v[236:239], a[200:203], a[104:107], v[236:239]
s_cbranch_vccz L_cw4
s_waitcnt vmcnt(10)
L_cw4:
v_exp_f32 v218, v218
v_mfma_f32_16x16x32_bf16 v[236:239], a[196:199], a[100:103], v[236:239]
s_waitcnt lgkmcnt(0)
v_add_f32 v252, v252, v217
v_cvt_pk_bf16_f32 v202, v216, v217
v_mfma_f32_16x16x32_bf16 v[236:239], a[192:195], a[96:99], v[236:239]
s_barrier
v_mfma_f32_16x16x32_bf16 v[208:211], a[224:227], a[0:3], 0
s_add_u32 m0, s26, 16896
v_exp_f32 v219, v219
v_mfma_f32_16x16x32_bf16 v[208:211], a[228:231], a[4:7], v[208:211]
buffer_load_dwordx4 v242, s[12:15], s29 offen offset:0 lds
v_mfma_f32_16x16x32_bf16 v[208:211], a[232:235], a[8:11], v[208:211]
ds_read_b64_tr_b16 a[192:193], v241 offset:0
v_add_f32 v252, v252, v218
v_mfma_f32_16x16x32_bf16 v[208:211], a[236:239], a[12:15], v[208:211]
ds_read_b64_tr_b16 a[194:195], v241 offset:512
v_add_f32 v252, v252, v219
v_mfma_f32_16x16x32_bf16 v[208:211], a[240:243], a[16:19], v[208:211]
v_cvt_pk_bf16_f32 v203, v218, v219
v_fma_f32 v204, v204, s27, -v249
v_mfma_f32_16x16x32_bf16 v[208:211], a[244:247], a[20:23], v[208:211]
ds_read_b64_tr_b16 a[196:197], v241 offset:16
v_fma_f32 v205, v205, s27, -v249
v_mfma_f32_16x16x32_bf16 v[208:211], a[248:251], a[24:27], v[208:211]
v_exp_f32 v204, v204
v_mfma_f32_16x16x32_bf16 v[208:211], a[252:255], a[28:31], v[208:211]
s_add_u32 m0, s26, 16928
ds_read_b64_tr_b16 a[198:199], v241 offset:528
v_fma_f32 v206, v206, s27, -v249
v_mfma_f32_16x16x32_bf16 v[212:215], a[252:255], a[60:63], 0
buffer_load_dwordx4 v242, s[12:15], s29 offen offset:1024 lds
v_mfma_f32_16x16x32_bf16 v[212:215], a[248:251], a[56:59], v[212:215]
ds_read_b64_tr_b16 a[200:201], v241 offset:32
v_fma_f32 v207, v207, s27, -v249
v_mfma_f32_16x16x32_bf16 v[212:215], a[244:247], a[52:55], v[212:215]
v_exp_f32 v205, v205
v_mfma_f32_16x16x32_bf16 v[212:215], a[240:243], a[48:51], v[212:215]
ds_read_b64_tr_b16 a[202:203], v241 offset:544
v_add_f32 v253, v253, v204
v_mfma_f32_16x16x32_bf16 v[212:215], a[236:239], a[44:47], v[212:215]
v_exp_f32 v206, v206
v_mfma_f32_16x16x32_bf16 v[212:215], a[232:235], a[40:43], v[212:215]
ds_read_b64_tr_b16 a[204:205], v241 offset:48
v_add_f32 v253, v253, v205
v_mfma_f32_16x16x32_bf16 v[212:215], a[228:231], a[36:39], v[212:215]
v_cvt_pk_bf16_f32 v204, v204, v205
v_add_f32 v253, v253, v206
v_mfma_f32_16x16x32_bf16 v[212:215], a[224:227], a[32:35], v[212:215]
s_add_u32 m0, s26, 16960
v_exp_f32 v207, v207
v_mfma_f32_16x16x32_bf16 v[216:219], a[224:227], a[64:67], 0
buffer_load_dwordx4 v242, s[12:15], s29 offen offset:2048 lds
v_mfma_f32_16x16x32_bf16 v[216:219], a[228:231], a[68:71], v[216:219]
ds_read_b64_tr_b16 a[206:207], v241 offset:560
v_add_f32 v253, v253, v207
v_mfma_f32_16x16x32_bf16 v[216:219], a[232:235], a[72:75], v[216:219]
ds_read_b64_tr_b16 a[208:209], v241 offset:64
v_cvt_pk_bf16_f32 v205, v206, v207
v_mfma_f32_16x16x32_bf16 v[216:219], a[236:239], a[76:79], v[216:219]
v_fma_f32 v220, v220, s27, -v249
v_fma_f32 v221, v221, s27, -v249
v_mfma_f32_16x16x32_bf16 v[216:219], a[240:243], a[80:83], v[216:219]
ds_read_b64_tr_b16 a[210:211], v241 offset:576
v_fma_f32 v222, v222, s27, -v249
v_mfma_f32_16x16x32_bf16 v[216:219], a[244:247], a[84:87], v[216:219]
v_exp_f32 v220, v220
v_mfma_f32_16x16x32_bf16 v[216:219], a[248:251], a[88:91], v[216:219]
v_fma_f32 v223, v223, s27, -v249
v_exp_f32 v221, v221
v_exp_f32 v222, v222
v_exp_f32 v223, v223
v_mfma_f32_16x16x32_bf16 v[216:219], a[252:255], a[92:95], v[216:219]
s_add_u32 m0, s26, 16992
v_add_f32 v253, v253, v220
v_add_f32 v253, v253, v221
v_cvt_pk_bf16_f32 v206, v220, v221
v_add_f32 v253, v253, v222
v_add_f32 v253, v253, v223
v_cvt_pk_bf16_f32 v207, v222, v223
v_mfma_f32_16x16x32_bf16 v[220:223], a[252:255], a[124:127], 0
buffer_load_dwordx4 v242, s[12:15], s29 offen offset:3072 lds
v_mfma_f32_16x16x32_bf16 v[220:223], a[248:251], a[120:123], v[220:223]
s_add_u32 s29, s29, 16384
ds_read_b64_tr_b16 a[212:213], v241 offset:80
ds_read_b64_tr_b16 a[214:215], v241 offset:592
v_mfma_f32_16x16x32_bf16 v[220:223], a[244:247], a[116:119], v[220:223]
ds_read_b64_tr_b16 a[216:217], v241 offset:96
v_mfma_f32_16x16x32_bf16 v[220:223], a[240:243], a[112:115], v[220:223]
ds_read_b64_tr_b16 a[218:219], v241 offset:608
v_mfma_f32_16x16x32_bf16 v[220:223], a[236:239], a[108:111], v[220:223]
v_mfma_f32_16x16x32_bf16 v[220:223], a[232:235], a[104:107], v[220:223]
ds_read_b64_tr_b16 a[220:221], v241 offset:112
v_mfma_f32_16x16x32_bf16 v[220:223], a[228:231], a[100:103], v[220:223]
v_mfma_f32_16x16x32_bf16 v[220:223], a[224:227], a[96:99], v[220:223]
s_waitcnt lgkmcnt(13)
ds_read_b64_tr_b16 a[222:223], v241 offset:624
v_fma_f32 v224, v224, s27, -v246
v_mfma_f32_16x16x32_bf16 v[0:3], v[192:195], a[192:195], 0
v_fma_f32 v225, v225, s27, -v246
v_mfma_f32_16x16x32_bf16 v[64:67], v[196:199], a[192:195], 0
v_exp_f32 v224, v224
v_mfma_f32_16x16x32_bf16 v[128:131], v[200:203], a[192:195], 0
ds_read_b64_tr_b16 a[224:225], v241 offset:256
v_fma_f32 v226, v226, s27, -v246
v_mfma_f32_16x16x32_bf16 a[128:131], v[204:207], a[192:195], 0
s_waitcnt lgkmcnt(13)
v_fma_f32 v227, v227, s27, -v246
v_mfma_f32_16x16x32_bf16 a[132:135], v[204:207], a[196:199], 0
v_exp_f32 v225, v225
v_mfma_f32_16x16x32_bf16 v[132:135], v[200:203], a[196:199], 0
ds_read_b64_tr_b16 a[226:227], v241 offset:768
v_add_f32 v250, v250, v224
v_mfma_f32_16x16x32_bf16 v[68:71], v[196:199], a[196:199], 0
v_exp_f32 v226, v226
v_mfma_f32_16x16x32_bf16 v[4:7], v[192:195], a[196:199], 0
s_waitcnt lgkmcnt(12)
ds_read_b64_tr_b16 a[228:229], v241 offset:272
v_add_f32 v250, v250, v225
v_mfma_f32_16x16x32_bf16 v[8:11], v[192:195], a[200:203], 0
ds_read_b64_tr_b16 a[230:231], v241 offset:784
v_cvt_pk_bf16_f32 v224, v224, v225
v_mfma_f32_16x16x32_bf16 v[72:75], v[196:199], a[200:203], 0
v_exp_f32 v227, v227
v_mfma_f32_16x16x32_bf16 v[136:139], v[200:203], a[200:203], 0
v_add_f32 v250, v250, v226
v_add_f32 v250, v250, v227
v_mfma_f32_16x16x32_bf16 a[136:139], v[204:207], a[200:203], 0
s_waitcnt lgkmcnt(12)
ds_read_b64_tr_b16 a[232:233], v241 offset:288
v_cvt_pk_bf16_f32 v225, v226, v227
v_mfma_f32_16x16x32_bf16 a[140:143], v[204:207], a[204:207], 0
v_fma_f32 v228, v228, s27, -v247
v_fma_f32 v229, v229, s27, -v247
v_mfma_f32_16x16x32_bf16 v[140:143], v[200:203], a[204:207], 0
v_exp_f32 v228, v228
v_mfma_f32_16x16x32_bf16 v[76:79], v[196:199], a[204:207], 0
ds_read_b64_tr_b16 a[234:235], v241 offset:800
v_fma_f32 v230, v230, s27, -v247
v_mfma_f32_16x16x32_bf16 v[12:15], v[192:195], a[204:207], 0
s_waitcnt lgkmcnt(12)
ds_read_b64_tr_b16 a[236:237], v241 offset:304
v_fma_f32 v231, v231, s27, -v247
v_mfma_f32_16x16x32_bf16 v[16:19], v[192:195], a[208:211], 0
v_exp_f32 v229, v229
v_mfma_f32_16x16x32_bf16 v[80:83], v[196:199], a[208:211], 0
ds_read_b64_tr_b16 a[238:239], v241 offset:816
v_add_f32 v251, v251, v228
v_mfma_f32_16x16x32_bf16 v[144:147], v[200:203], a[208:211], 0
v_exp_f32 v230, v230
v_mfma_f32_16x16x32_bf16 a[144:147], v[204:207], a[208:211], 0
s_waitcnt lgkmcnt(12)
ds_read_b64_tr_b16 a[240:241], v241 offset:320
v_add_f32 v251, v251, v229
v_mfma_f32_16x16x32_bf16 a[148:151], v[204:207], a[212:215], 0
v_cvt_pk_bf16_f32 v228, v228, v229
v_mfma_f32_16x16x32_bf16 v[148:151], v[200:203], a[212:215], 0
v_exp_f32 v231, v231
v_mfma_f32_16x16x32_bf16 v[84:87], v[196:199], a[212:215], 0
ds_read_b64_tr_b16 a[242:243], v241 offset:832
v_add_f32 v251, v251, v230
v_mfma_f32_16x16x32_bf16 v[20:23], v[192:195], a[212:215], 0
s_waitcnt lgkmcnt(12)
v_add_f32 v251, v251, v231
v_cvt_pk_bf16_f32 v229, v230, v231
v_mfma_f32_16x16x32_bf16 v[24:27], v[192:195], a[216:219], 0
ds_read_b64_tr_b16 a[244:245], v241 offset:336
v_fma_f32 v232, v232, s27, -v248
v_mfma_f32_16x16x32_bf16 v[88:91], v[196:199], a[216:219], 0
ds_read_b64_tr_b16 a[246:247], v241 offset:848
v_fma_f32 v233, v233, s27, -v248
v_mfma_f32_16x16x32_bf16 v[152:155], v[200:203], a[216:219], 0
v_exp_f32 v232, v232
v_mfma_f32_16x16x32_bf16 a[152:155], v[204:207], a[216:219], 0
s_waitcnt lgkmcnt(12)
v_fma_f32 v234, v234, s27, -v248
v_fma_f32 v235, v235, s27, -v248
v_mfma_f32_16x16x32_bf16 a[156:159], v[204:207], a[220:223], 0
v_exp_f32 v233, v233
v_mfma_f32_16x16x32_bf16 v[156:159], v[200:203], a[220:223], 0
ds_read_b64_tr_b16 a[248:249], v241 offset:352
v_add_f32 v252, v252, v232
v_mfma_f32_16x16x32_bf16 v[92:95], v[196:199], a[220:223], 0
v_exp_f32 v234, v234
v_mfma_f32_16x16x32_bf16 v[28:31], v[192:195], a[220:223], 0
s_waitcnt lgkmcnt(11)
ds_read_b64_tr_b16 a[250:251], v241 offset:864
v_add_f32 v252, v252, v233
v_mfma_f32_16x16x32_bf16 v[32:35], v[192:195], a[224:227], 0
ds_read_b64_tr_b16 a[252:253], v241 offset:368
v_cvt_pk_bf16_f32 v232, v232, v233
v_mfma_f32_16x16x32_bf16 v[96:99], v[196:199], a[224:227], 0
v_exp_f32 v235, v235
v_mfma_f32_16x16x32_bf16 v[160:163], v[200:203], a[224:227], 0
ds_read_b64_tr_b16 a[254:255], v241 offset:880
v_add_f32 v252, v252, v234
v_mfma_f32_16x16x32_bf16 a[160:163], v[204:207], a[224:227], 0
s_waitcnt lgkmcnt(12)
v_add_f32 v252, v252, v235
v_cvt_pk_bf16_f32 v233, v234, v235
v_mfma_f32_16x16x32_bf16 a[164:167], v[204:207], a[228:231], 0
v_fma_f32 v236, v236, s27, -v249
v_fma_f32 v237, v237, s27, -v249
v_mfma_f32_16x16x32_bf16 v[164:167], v[200:203], a[228:231], 0
v_exp_f32 v236, v236
v_mfma_f32_16x16x32_bf16 v[100:103], v[196:199], a[228:231], 0
v_fma_f32 v238, v238, s27, -v249
v_fma_f32 v239, v239, s27, -v249
v_mfma_f32_16x16x32_bf16 v[36:39], v[192:195], a[228:231], 0
s_waitcnt lgkmcnt(10)
v_exp_f32 v237, v237
v_mfma_f32_16x16x32_bf16 v[40:43], v[192:195], a[232:235], 0
v_add_f32 v253, v253, v236
v_mfma_f32_16x16x32_bf16 v[104:107], v[196:199], a[232:235], 0
v_exp_f32 v238, v238
v_mfma_f32_16x16x32_bf16 v[168:171], v[200:203], a[232:235], 0
v_add_f32 v253, v253, v237
v_cvt_pk_bf16_f32 v236, v236, v237
v_mfma_f32_16x16x32_bf16 a[168:171], v[204:207], a[232:235], 0
s_waitcnt vmcnt(10) lgkmcnt(0)
v_exp_f32 v239, v239
v_mfma_f32_16x16x32_bf16 a[172:175], v[204:207], a[236:239], 0
s_barrier
v_mfma_f32_16x16x32_bf16 v[172:175], v[200:203], a[236:239], 0
s_add_u32 m0, s3, 36864
ds_read_b128 a[192:195], v240 offset:0
v_add_f32 v253, v253, v238
v_mfma_f32_16x16x32_bf16 v[108:111], v[196:199], a[236:239], 0
buffer_load_dwordx4 v242, s[16:19], s30 offen offset:0 lds
v_mfma_f32_16x16x32_bf16 v[44:47], v[192:195], a[236:239], 0
ds_read_b128 a[196:199], v240 offset:64
v_add_f32 v253, v253, v239
v_mfma_f32_16x16x32_bf16 v[48:51], v[192:195], a[240:243], 0
ds_read_b128 a[200:203], v240 offset:128
v_cvt_pk_bf16_f32 v237, v238, v239
v_mfma_f32_16x16x32_bf16 v[112:115], v[196:199], a[240:243], 0
s_add_u32 m0, s3, 36880
v_fma_f32 v208, v208, s27, -v246
v_fma_f32 v209, v209, s27, -v246
v_mfma_f32_16x16x32_bf16 v[176:179], v[200:203], a[240:243], 0
buffer_load_dwordx4 v242, s[16:19], s30 offen offset:1024 lds
v_mfma_f32_16x16x32_bf16 a[176:179], v[204:207], a[240:243], 0
v_exp_f32 v208, v208
v_mfma_f32_16x16x32_bf16 a[180:183], v[204:207], a[244:247], 0
ds_read_b128 a[204:207], v240 offset:192
ds_read_b128 a[208:211], v240 offset:256
v_mfma_f32_16x16x32_bf16 v[180:183], v[200:203], a[244:247], 0
s_add_u32 m0, s3, 36896
ds_read_b128 a[212:215], v240 offset:320
v_fma_f32 v210, v210, s27, -v246
v_mfma_f32_16x16x32_bf16 v[116:119], v[196:199], a[244:247], 0
buffer_load_dwordx4 v242, s[16:19], s30 offen offset:2048 lds
v_mfma_f32_16x16x32_bf16 v[52:55], v[192:195], a[244:247], 0
ds_read_b128 a[216:219], v240 offset:384
v_fma_f32 v211, v211, s27, -v246
v_mfma_f32_16x16x32_bf16 v[56:59], v[192:195], a[248:251], 0
v_exp_f32 v209, v209
v_mfma_f32_16x16x32_bf16 v[120:123], v[196:199], a[248:251], 0
s_add_u32 m0, s3, 36912
ds_read_b128 a[220:223], v240 offset:448
v_add_f32 v250, v250, v208
v_mfma_f32_16x16x32_bf16 v[184:187], v[200:203], a[248:251], 0
buffer_load_dwordx4 v242, s[16:19], s30 offen offset:3072 lds
v_mfma_f32_16x16x32_bf16 a[184:187], v[204:207], a[248:251], 0
s_add_u32 s30, s30, 16384
v_exp_f32 v210, v210
v_mfma_f32_16x16x32_bf16 a[188:191], v[204:207], a[252:255], 0
v_add_f32 v250, v250, v209
v_cvt_pk_bf16_f32 v226, v208, v209
v_mfma_f32_16x16x32_bf16 v[188:191], v[200:203], a[252:255], 0
v_exp_f32 v211, v211
v_mfma_f32_16x16x32_bf16 v[124:127], v[196:199], a[252:255], 0
v_add_f32 v250, v250, v210
v_add_f32 v250, v250, v211
v_mfma_f32_16x16x32_bf16 v[60:63], v[192:195], a[252:255], 0
v_cvt_pk_bf16_f32 v227, v210, v211
.p2align 6
L_loop4:
s_waitcnt lgkmcnt(7)
v_mfma_f32_16x16x32_bf16 v[192:195], a[192:195], a[0:3], 0
s_waitcnt lgkmcnt(6)
ds_read_b128 a[224:227], v240 offset:512
v_fma_f32 v212, v212, s27, -v247
v_mfma_f32_16x16x32_bf16 v[192:195], a[196:199], a[4:7], v[192:195]
s_waitcnt lgkmcnt(6)
v_fma_f32 v213, v213, s27, -v247
v_mfma_f32_16x16x32_bf16 v[192:195], a[200:203], a[8:11], v[192:195]
s_waitcnt lgkmcnt(5)
v_exp_f32 v212, v212
v_mfma_f32_16x16x32_bf16 v[192:195], a[204:207], a[12:15], v[192:195]
s_waitcnt lgkmcnt(4)
ds_read_b128 a[228:231], v240 offset:576
v_fma_f32 v214, v214, s27, -v247
v_mfma_f32_16x16x32_bf16 v[192:195], a[208:211], a[16:19], v[192:195]
s_waitcnt lgkmcnt(4)
ds_read_b128 a[232:235], v240 offset:640
v_fma_f32 v215, v215, s27, -v247
v_mfma_f32_16x16x32_bf16 v[192:195], a[212:215], a[20:23], v[192:195]
s_waitcnt lgkmcnt(4)
v_exp_f32 v213, v213
v_mfma_f32_16x16x32_bf16 v[192:195], a[216:219], a[24:27], v[192:195]
s_waitcnt lgkmcnt(3)
v_add_f32 v251, v251, v212
v_mfma_f32_16x16x32_bf16 v[192:195], a[220:223], a[28:31], v[192:195]
v_exp_f32 v214, v214
v_mfma_f32_16x16x32_bf16 v[196:199], a[220:223], a[60:63], 0
s_add_u32 m0, s5, 0
ds_read_b128 a[236:239], v240 offset:704
v_mfma_f32_16x16x32_bf16 v[196:199], a[216:219], a[56:59], v[196:199]
buffer_load_dwordx4 v243, s[8:11], s38 offen nt lds
v_mfma_f32_16x16x32_bf16 v[196:199], a[212:215], a[52:55], v[196:199]
s_add_u32 s38, s38, 512
ds_read_b128 a[240:243], v240 offset:768
v_add_f32 v251, v251, v213
v_mfma_f32_16x16x32_bf16 v[196:199], a[208:211], a[48:51], v[196:199]
v_cvt_pk_bf16_f32 v230, v212, v213
v_mfma_f32_16x16x32_bf16 v[196:199], a[204:207], a[44:47], v[196:199]
v_exp_f32 v215, v215
v_mfma_f32_16x16x32_bf16 v[196:199], a[200:203], a[40:43], v[196:199]
ds_read_b128 a[244:247], v240 offset:832
v_add_f32 v251, v251, v214
v_mfma_f32_16x16x32_bf16 v[196:199], a[196:199], a[36:39], v[196:199]
v_add_f32 v251, v251, v215
v_cvt_pk_bf16_f32 v231, v214, v215
v_mfma_f32_16x16x32_bf16 v[196:199], a[192:195], a[32:35], v[196:199]
v_fma_f32 v216, v216, s27, -v248
v_fma_f32 v217, v217, s27, -v248
v_mfma_f32_16x16x32_bf16 v[200:203], a[192:195], a[64:67], 0
ds_read_b128 a[248:251], v240 offset:896
v_mfma_f32_16x16x32_bf16 v[200:203], a[196:199], a[68:71], v[200:203]
v_exp_f32 v216, v216
v_mfma_f32_16x16x32_bf16 v[200:203], a[200:203], a[72:75], v[200:203]
ds_read_b128 a[252:255], v240 offset:960
v_fma_f32 v218, v218, s27, -v248
v_mfma_f32_16x16x32_bf16 v[200:203], a[204:207], a[76:79], v[200:203]
v_fma_f32 v219, v219, s27, -v248
v_mfma_f32_16x16x32_bf16 v[200:203], a[208:211], a[80:83], v[200:203]
v_exp_f32 v217, v217
v_mfma_f32_16x16x32_bf16 v[200:203], a[212:215], a[84:87], v[200:203]
v_add_f32 v252, v252, v216
v_mfma_f32_16x16x32_bf16 v[200:203], a[216:219], a[88:91], v[200:203]
v_exp_f32 v218, v218
v_mfma_f32_16x16x32_bf16 v[200:203], a[220:223], a[92:95], v[200:203]
v_add_f32 v252, v252, v217
v_cvt_pk_bf16_f32 v234, v216, v217
v_mfma_f32_16x16x32_bf16 v[204:207], a[220:223], a[124:127], 0
v_exp_f32 v219, v219
v_mfma_f32_16x16x32_bf16 v[204:207], a[216:219], a[120:123], v[204:207]
v_add_f32 v252, v252, v218
v_mfma_f32_16x16x32_bf16 v[204:207], a[212:215], a[116:119], v[204:207]
v_add_f32 v252, v252, v219
v_cvt_pk_bf16_f32 v235, v218, v219
v_mfma_f32_16x16x32_bf16 v[204:207], a[208:211], a[112:115], v[204:207]
v_fma_f32 v220, v220, s27, -v249
v_mfma_f32_16x16x32_bf16 v[204:207], a[204:207], a[108:111], v[204:207]
v_fma_f32 v221, v221, s27, -v249
v_mfma_f32_16x16x32_bf16 v[204:207], a[200:203], a[104:107], v[204:207]
v_exp_f32 v220, v220
v_mfma_f32_16x16x32_bf16 v[204:207], a[196:199], a[100:103], v[204:207]
s_waitcnt vmcnt(10) lgkmcnt(0)
v_fma_f32 v222, v222, s27, -v249
v_fma_f32 v223, v223, s27, -v249
v_mfma_f32_16x16x32_bf16 v[204:207], a[192:195], a[96:99], v[204:207]
s_barrier
v_mfma_f32_16x16x32_bf16 v[208:211], a[224:227], a[0:3], 0
s_add_u32 m0, s26, 0
ds_read_b64_tr_b16 a[192:193], v241 offset:16640
v_mfma_f32_16x16x32_bf16 v[208:211], a[228:231], a[4:7], v[208:211]
buffer_load_dwordx4 v242, s[12:15], s29 offen offset:0 lds
v_mfma_f32_16x16x32_bf16 v[208:211], a[232:235], a[8:11], v[208:211]
v_exp_f32 v221, v221
v_mfma_f32_16x16x32_bf16 v[208:211], a[236:239], a[12:15], v[208:211]
ds_read_b64_tr_b16 a[194:195], v241 offset:17152
v_add_f32 v253, v253, v220
v_mfma_f32_16x16x32_bf16 v[208:211], a[240:243], a[16:19], v[208:211]
v_exp_f32 v222, v222
v_mfma_f32_16x16x32_bf16 v[208:211], a[244:247], a[20:23], v[208:211]
ds_read_b64_tr_b16 a[196:197], v241 offset:16656
v_add_f32 v253, v253, v221
v_mfma_f32_16x16x32_bf16 v[208:211], a[248:251], a[24:27], v[208:211]
ds_read_b64_tr_b16 a[198:199], v241 offset:17168
v_cvt_pk_bf16_f32 v238, v220, v221
v_mfma_f32_16x16x32_bf16 v[208:211], a[252:255], a[28:31], v[208:211]
s_add_u32 m0, s26, 32
v_exp_f32 v223, v223
v_mfma_f32_16x16x32_bf16 v[212:215], a[252:255], a[60:63], 0
buffer_load_dwordx4 v242, s[12:15], s29 offen offset:1024 lds
v_mfma_f32_16x16x32_bf16 v[212:215], a[248:251], a[56:59], v[212:215]
ds_read_b64_tr_b16 a[200:201], v241 offset:16672
v_mfma_f32_16x16x32_bf16 v[212:215], a[244:247], a[52:55], v[212:215]
ds_read_b64_tr_b16 a[202:203], v241 offset:17184
v_add_f32 v253, v253, v222
v_mfma_f32_16x16x32_bf16 v[212:215], a[240:243], a[48:51], v[212:215]
v_add_f32 v253, v253, v223
v_mfma_f32_16x16x32_bf16 v[212:215], a[236:239], a[44:47], v[212:215]
ds_read_b64_tr_b16 a[204:205], v241 offset:16688
v_cvt_pk_bf16_f32 v239, v222, v223
v_mfma_f32_16x16x32_bf16 v[212:215], a[232:235], a[40:43], v[212:215]
v_fma_f32 v192, v192, s27, -v246
v_fma_f32 v193, v193, s27, -v246
v_mfma_f32_16x16x32_bf16 v[212:215], a[228:231], a[36:39], v[212:215]
v_exp_f32 v192, v192
v_mfma_f32_16x16x32_bf16 v[212:215], a[224:227], a[32:35], v[212:215]
s_add_u32 m0, s26, 64
ds_read_b64_tr_b16 a[206:207], v241 offset:17200
v_mfma_f32_16x16x32_bf16 v[216:219], a[224:227], a[64:67], 0
buffer_load_dwordx4 v242, s[12:15], s29 offen offset:2048 lds
v_mfma_f32_16x16x32_bf16 v[216:219], a[228:231], a[68:71], v[216:219]
ds_read_b64_tr_b16 a[208:209], v241 offset:16704
v_fma_f32 v194, v194, s27, -v246
v_mfma_f32_16x16x32_bf16 v[216:219], a[232:235], a[72:75], v[216:219]
ds_read_b64_tr_b16 a[210:211], v241 offset:17216
v_fma_f32 v195, v195, s27, -v246
v_mfma_f32_16x16x32_bf16 v[216:219], a[236:239], a[76:79], v[216:219]
v_exp_f32 v193, v193
v_mfma_f32_16x16x32_bf16 v[216:219], a[240:243], a[80:83], v[216:219]
v_add_f32 v250, v250, v192
v_mfma_f32_16x16x32_bf16 v[216:219], a[244:247], a[84:87], v[216:219]
ds_read_b64_tr_b16 a[212:213], v241 offset:16720
v_mfma_f32_16x16x32_bf16 v[216:219], a[248:251], a[88:91], v[216:219]
v_exp_f32 v194, v194
v_mfma_f32_16x16x32_bf16 v[216:219], a[252:255], a[92:95], v[216:219]
s_add_u32 m0, s26, 96
ds_read_b64_tr_b16 a[214:215], v241 offset:17232
v_mfma_f32_16x16x32_bf16 v[220:223], a[252:255], a[124:127], 0
buffer_load_dwordx4 v242, s[12:15], s29 offen offset:3072 lds
v_mfma_f32_16x16x32_bf16 v[220:223], a[248:251], a[120:123], v[220:223]
s_add_u32 s29, s29, 16384
ds_read_b64_tr_b16 a[216:217], v241 offset:16736
v_add_f32 v250, v250, v193
v_mfma_f32_16x16x32_bf16 v[220:223], a[244:247], a[116:119], v[220:223]
v_cvt_pk_bf16_f32 v192, v192, v193
v_mfma_f32_16x16x32_bf16 v[220:223], a[240:243], a[112:115], v[220:223]
v_exp_f32 v195, v195
v_mfma_f32_16x16x32_bf16 v[220:223], a[236:239], a[108:111], v[220:223]
ds_read_b64_tr_b16 a[218:219], v241 offset:17248
v_add_f32 v250, v250, v194
v_mfma_f32_16x16x32_bf16 v[220:223], a[232:235], a[104:107], v[220:223]
v_add_f32 v250, v250, v195
v_cvt_pk_bf16_f32 v193, v194, v195
v_mfma_f32_16x16x32_bf16 v[220:223], a[228:231], a[100:103], v[220:223]
ds_read_b64_tr_b16 a[220:221], v241 offset:16752
v_mfma_f32_16x16x32_bf16 v[220:223], a[224:227], a[96:99], v[220:223]
s_waitcnt lgkmcnt(13)
v_fma_f32 v196, v196, s27, -v247
v_fma_f32 v197, v197, s27, -v247
v_mfma_f32_16x16x32_bf16 v[0:3], v[224:227], a[192:195], v[0:3]
ds_read_b64_tr_b16 a[222:223], v241 offset:17264
v_mfma_f32_16x16x32_bf16 v[64:67], v[228:231], a[192:195], v[64:67]
v_exp_f32 v196, v196
v_mfma_f32_16x16x32_bf16 v[128:131], v[232:235], a[192:195], v[128:131]
ds_read_b64_tr_b16 a[224:225], v241 offset:16896
v_fma_f32 v198, v198, s27, -v247
v_mfma_f32_16x16x32_bf16 a[128:131], v[236:239], a[192:195], a[128:131]
s_waitcnt lgkmcnt(13)
v_fma_f32 v199, v199, s27, -v247
v_mfma_f32_16x16x32_bf16 a[132:135], v[236:239], a[196:199], a[132:135]
v_exp_f32 v197, v197
v_mfma_f32_16x16x32_bf16 v[132:135], v[232:235], a[196:199], v[132:135]
ds_read_b64_tr_b16 a[226:227], v241 offset:17408
v_add_f32 v251, v251, v196
v_mfma_f32_16x16x32_bf16 v[68:71], v[228:231], a[196:199], v[68:71]
ds_read_b64_tr_b16 a[228:229], v241 offset:16912
v_mfma_f32_16x16x32_bf16 v[4:7], v[224:227], a[196:199], v[4:7]
s_waitcnt lgkmcnt(13)
v_exp_f32 v198, v198
v_mfma_f32_16x16x32_bf16 v[8:11], v[224:227], a[200:203], v[8:11]
ds_read_b64_tr_b16 a[230:231], v241 offset:17424
v_add_f32 v251, v251, v197
v_mfma_f32_16x16x32_bf16 v[72:75], v[228:231], a[200:203], v[72:75]
v_cvt_pk_bf16_f32 v196, v196, v197
v_mfma_f32_16x16x32_bf16 v[136:139], v[232:235], a[200:203], v[136:139]
v_exp_f32 v199, v199
v_mfma_f32_16x16x32_bf16 a[136:139], v[236:239], a[200:203], a[136:139]
s_waitcnt lgkmcnt(12)
ds_read_b64_tr_b16 a[232:233], v241 offset:16928
v_add_f32 v251, v251, v198
v_mfma_f32_16x16x32_bf16 a[140:143], v[236:239], a[204:207], a[140:143]
ds_read_b64_tr_b16 a[234:235], v241 offset:17440
v_add_f32 v251, v251, v199
v_mfma_f32_16x16x32_bf16 v[140:143], v[232:235], a[204:207], v[140:143]
v_cvt_pk_bf16_f32 v197, v198, v199
v_mfma_f32_16x16x32_bf16 v[76:79], v[228:231], a[204:207], v[76:79]
v_fma_f32 v200, v200, s27, -v248
v_fma_f32 v201, v201, s27, -v248
v_mfma_f32_16x16x32_bf16 v[12:15], v[224:227], a[204:207], v[12:15]
s_waitcnt lgkmcnt(12)
ds_read_b64_tr_b16 a[236:237], v241 offset:16944
v_mfma_f32_16x16x32_bf16 v[16:19], v[224:227], a[208:211], v[16:19]
v_exp_f32 v200, v200
v_mfma_f32_16x16x32_bf16 v[80:83], v[228:231], a[208:211], v[80:83]
ds_read_b64_tr_b16 a[238:239], v241 offset:17456
v_fma_f32 v202, v202, s27, -v248
v_mfma_f32_16x16x32_bf16 v[144:147], v[232:235], a[208:211], v[144:147]
v_fma_f32 v203, v203, s27, -v248
v_mfma_f32_16x16x32_bf16 a[144:147], v[236:239], a[208:211], a[144:147]
s_waitcnt lgkmcnt(12)
ds_read_b64_tr_b16 a[240:241], v241 offset:16960
v_mfma_f32_16x16x32_bf16 a[148:151], v[236:239], a[212:215], a[148:151]
v_exp_f32 v201, v201
v_mfma_f32_16x16x32_bf16 v[148:151], v[232:235], a[212:215], v[148:151]
ds_read_b64_tr_b16 a[242:243], v241 offset:17472
v_add_f32 v252, v252, v200
v_mfma_f32_16x16x32_bf16 v[84:87], v[228:231], a[212:215], v[84:87]
v_exp_f32 v202, v202
v_mfma_f32_16x16x32_bf16 v[20:23], v[224:227], a[212:215], v[20:23]
s_waitcnt lgkmcnt(12)
ds_read_b64_tr_b16 a[244:245], v241 offset:16976
v_add_f32 v252, v252, v201
v_mfma_f32_16x16x32_bf16 v[24:27], v[224:227], a[216:219], v[24:27]
v_cvt_pk_bf16_f32 v200, v200, v201
v_mfma_f32_16x16x32_bf16 v[88:91], v[228:231], a[216:219], v[88:91]
v_exp_f32 v203, v203
v_mfma_f32_16x16x32_bf16 v[152:155], v[232:235], a[216:219], v[152:155]
ds_read_b64_tr_b16 a[246:247], v241 offset:17488
v_mfma_f32_16x16x32_bf16 a[152:155], v[236:239], a[216:219], a[152:155]
s_waitcnt lgkmcnt(12)
v_add_f32 v252, v252, v202
v_add_f32 v252, v252, v203
v_mfma_f32_16x16x32_bf16 a[156:159], v[236:239], a[220:223], a[156:159]
ds_read_b64_tr_b16 a[248:249], v241 offset:16992
v_cvt_pk_bf16_f32 v201, v202, v203
v_mfma_f32_16x16x32_bf16 v[156:159], v[232:235], a[220:223], v[156:159]
v_fma_f32 v204, v204, s27, -v249
v_mfma_f32_16x16x32_bf16 v[92:95], v[228:231], a[220:223], v[92:95]
ds_read_b64_tr_b16 a[250:251], v241 offset:17504
v_fma_f32 v205, v205, s27, -v249
v_mfma_f32_16x16x32_bf16 v[28:31], v[224:227], a[220:223], v[28:31]
s_waitcnt lgkmcnt(12)
v_exp_f32 v204, v204
v_mfma_f32_16x16x32_bf16 v[32:35], v[224:227], a[224:227], v[32:35]
ds_read_b64_tr_b16 a[252:253], v241 offset:17008
v_fma_f32 v206, v206, s27, -v249
v_mfma_f32_16x16x32_bf16 v[96:99], v[228:231], a[224:227], v[96:99]
v_fma_f32 v207, v207, s27, -v249
v_mfma_f32_16x16x32_bf16 v[160:163], v[232:235], a[224:227], v[160:163]
ds_read_b64_tr_b16 a[254:255], v241 offset:17520
v_mfma_f32_16x16x32_bf16 a[160:163], v[236:239], a[224:227], a[160:163]
s_waitcnt lgkmcnt(12)
v_exp_f32 v205, v205
v_mfma_f32_16x16x32_bf16 a[164:167], v[236:239], a[228:231], a[164:167]
v_add_f32 v253, v253, v204
v_mfma_f32_16x16x32_bf16 v[164:167], v[232:235], a[228:231], v[164:167]
v_exp_f32 v206, v206
v_mfma_f32_16x16x32_bf16 v[100:103], v[228:231], a[228:231], v[100:103]
v_add_f32 v253, v253, v205
v_cvt_pk_bf16_f32 v204, v204, v205
v_mfma_f32_16x16x32_bf16 v[36:39], v[224:227], a[228:231], v[36:39]
s_waitcnt lgkmcnt(10)
v_exp_f32 v207, v207
v_mfma_f32_16x16x32_bf16 v[40:43], v[224:227], a[232:235], v[40:43]
v_add_f32 v253, v253, v206
v_add_f32 v253, v253, v207
v_mfma_f32_16x16x32_bf16 v[104:107], v[228:231], a[232:235], v[104:107]
v_cvt_pk_bf16_f32 v205, v206, v207
v_mfma_f32_16x16x32_bf16 v[168:171], v[232:235], a[232:235], v[168:171]
v_fma_f32 v208, v208, s27, -v246
v_fma_f32 v209, v209, s27, -v246
v_mfma_f32_16x16x32_bf16 a[168:171], v[236:239], a[232:235], a[168:171]
s_waitcnt vmcnt(9) lgkmcnt(0)
v_exp_f32 v208, v208
v_mfma_f32_16x16x32_bf16 a[172:175], v[236:239], a[236:239], a[172:175]
s_barrier
v_mfma_f32_16x16x32_bf16 v[172:175], v[232:235], a[236:239], v[172:175]
s_add_u32 m0, s3, 53504
ds_read_b128 a[192:195], v240 offset:16896
ds_read_b128 a[196:199], v240 offset:16960
v_mfma_f32_16x16x32_bf16 v[108:111], v[228:231], a[236:239], v[108:111]
buffer_load_dwordx4 v242, s[16:19], s30 offen offset:0 lds
v_mfma_f32_16x16x32_bf16 v[44:47], v[224:227], a[236:239], v[44:47]
ds_read_b128 a[200:203], v240 offset:17024
v_fma_f32 v210, v210, s27, -v246
v_mfma_f32_16x16x32_bf16 v[48:51], v[224:227], a[240:243], v[48:51]
ds_read_b128 a[204:207], v240 offset:17088
v_fma_f32 v211, v211, s27, -v246
v_mfma_f32_16x16x32_bf16 v[112:115], v[228:231], a[240:243], v[112:115]
s_add_u32 m0, s3, 53520
v_mfma_f32_16x16x32_bf16 v[176:179], v[232:235], a[240:243], v[176:179]
buffer_load_dwordx4 v242, s[16:19], s30 offen offset:1024 lds
v_mfma_f32_16x16x32_bf16 a[176:179], v[236:239], a[240:243], a[176:179]
ds_read_b128 a[208:211], v240 offset:17152
v_mfma_f32_16x16x32_bf16 a[180:183], v[236:239], a[244:247], a[180:183]
v_exp_f32 v209, v209
v_mfma_f32_16x16x32_bf16 v[180:183], v[232:235], a[244:247], v[180:183]
s_add_u32 m0, s3, 53536
ds_read_b128 a[212:215], v240 offset:17216
v_add_f32 v250, v250, v208
v_mfma_f32_16x16x32_bf16 v[116:119], v[228:231], a[244:247], v[116:119]
buffer_load_dwordx4 v242, s[16:19], s30 offen offset:2048 lds
v_mfma_f32_16x16x32_bf16 v[52:55], v[224:227], a[244:247], v[52:55]
ds_read_b128 a[216:219], v240 offset:17280
ds_read_b128 a[220:223], v240 offset:17344
v_mfma_f32_16x16x32_bf16 v[56:59], v[224:227], a[248:251], v[56:59]
v_exp_f32 v210, v210
v_mfma_f32_16x16x32_bf16 v[120:123], v[228:231], a[248:251], v[120:123]
s_add_u32 m0, s3, 53552
v_add_f32 v250, v250, v209
v_mfma_f32_16x16x32_bf16 v[184:187], v[232:235], a[248:251], v[184:187]
buffer_load_dwordx4 v242, s[16:19], s30 offen offset:3072 lds
v_mfma_f32_16x16x32_bf16 a[184:187], v[236:239], a[248:251], a[184:187]
s_add_u32 s30, s30, 16384
v_cvt_pk_bf16_f32 v194, v208, v209
v_mfma_f32_16x16x32_bf16 a[188:191], v[236:239], a[252:255], a[188:191]
v_exp_f32 v211, v211
v_mfma_f32_16x16x32_bf16 v[188:191], v[232:235], a[252:255], v[188:191]
v_add_f32 v250, v250, v210
v_add_f32 v250, v250, v211
v_mfma_f32_16x16x32_bf16 v[124:127], v[228:231], a[252:255], v[124:127]
v_cvt_pk_bf16_f32 v195, v210, v211
v_mfma_f32_16x16x32_bf16 v[60:63], v[224:227], a[252:255], v[60:63]
s_waitcnt lgkmcnt(7)
v_mfma_f32_16x16x32_bf16 v[224:227], a[192:195], a[0:3], 0
s_waitcnt lgkmcnt(6)
ds_read_b128 a[224:227], v240 offset:17408
v_fma_f32 v212, v212, s27, -v247
v_mfma_f32_16x16x32_bf16 v[224:227], a[196:199], a[4:7], v[224:227]
s_waitcnt lgkmcnt(6)
v_fma_f32 v213, v213, s27, -v247
v_mfma_f32_16x16x32_bf16 v[224:227], a[200:203], a[8:11], v[224:227]
s_waitcnt lgkmcnt(5)
v_exp_f32 v212, v212
v_mfma_f32_16x16x32_bf16 v[224:227], a[204:207], a[12:15], v[224:227]
s_waitcnt lgkmcnt(4)
ds_read_b128 a[228:231], v240 offset:17472
v_fma_f32 v214, v214, s27, -v247
v_mfma_f32_16x16x32_bf16 v[224:227], a[208:211], a[16:19], v[224:227]
s_waitcnt lgkmcnt(4)
ds_read_b128 a[232:235], v240 offset:17536
v_fma_f32 v215, v215, s27, -v247
v_mfma_f32_16x16x32_bf16 v[224:227], a[212:215], a[20:23], v[224:227]
s_waitcnt lgkmcnt(4)
v_exp_f32 v213, v213
v_mfma_f32_16x16x32_bf16 v[224:227], a[216:219], a[24:27], v[224:227]
s_waitcnt lgkmcnt(3)
v_add_f32 v251, v251, v212
v_mfma_f32_16x16x32_bf16 v[224:227], a[220:223], a[28:31], v[224:227]
v_exp_f32 v214, v214
v_mfma_f32_16x16x32_bf16 v[228:231], a[220:223], a[60:63], 0
s_add_u32 m0, s5, 8448
ds_read_b128 a[236:239], v240 offset:17600
v_mfma_f32_16x16x32_bf16 v[228:231], a[216:219], a[56:59], v[228:231]
s_add_u32 s5, s5, 1056
buffer_load_dwordx4 v243, s[8:11], s33 offen nt lds
v_mfma_f32_16x16x32_bf16 v[228:231], a[212:215], a[52:55], v[228:231]
s_add_u32 s33, s33, 512
ds_read_b128 a[240:243], v240 offset:17664
v_add_f32 v251, v251, v213
v_mfma_f32_16x16x32_bf16 v[228:231], a[208:211], a[48:51], v[228:231]
v_cvt_pk_bf16_f32 v198, v212, v213
v_mfma_f32_16x16x32_bf16 v[228:231], a[204:207], a[44:47], v[228:231]
v_exp_f32 v215, v215
v_mfma_f32_16x16x32_bf16 v[228:231], a[200:203], a[40:43], v[228:231]
ds_read_b128 a[244:247], v240 offset:17728
v_add_f32 v251, v251, v214
v_mfma_f32_16x16x32_bf16 v[228:231], a[196:199], a[36:39], v[228:231]
v_add_f32 v251, v251, v215
v_cvt_pk_bf16_f32 v199, v214, v215
v_mfma_f32_16x16x32_bf16 v[228:231], a[192:195], a[32:35], v[228:231]
v_fma_f32 v216, v216, s27, -v248
v_fma_f32 v217, v217, s27, -v248
v_mfma_f32_16x16x32_bf16 v[232:235], a[192:195], a[64:67], 0
ds_read_b128 a[248:251], v240 offset:17792
v_mfma_f32_16x16x32_bf16 v[232:235], a[196:199], a[68:71], v[232:235]
v_exp_f32 v216, v216
v_mfma_f32_16x16x32_bf16 v[232:235], a[200:203], a[72:75], v[232:235]
ds_read_b128 a[252:255], v240 offset:17856
v_fma_f32 v218, v218, s27, -v248
v_mfma_f32_16x16x32_bf16 v[232:235], a[204:207], a[76:79], v[232:235]
v_fma_f32 v219, v219, s27, -v248
v_mfma_f32_16x16x32_bf16 v[232:235], a[208:211], a[80:83], v[232:235]
v_exp_f32 v217, v217
v_mfma_f32_16x16x32_bf16 v[232:235], a[212:215], a[84:87], v[232:235]
v_add_f32 v252, v252, v216
v_mfma_f32_16x16x32_bf16 v[232:235], a[216:219], a[88:91], v[232:235]
v_exp_f32 v218, v218
v_mfma_f32_16x16x32_bf16 v[232:235], a[220:223], a[92:95], v[232:235]
v_add_f32 v252, v252, v217
v_cvt_pk_bf16_f32 v202, v216, v217
v_mfma_f32_16x16x32_bf16 v[236:239], a[220:223], a[124:127], 0
v_exp_f32 v219, v219
v_mfma_f32_16x16x32_bf16 v[236:239], a[216:219], a[120:123], v[236:239]
v_add_f32 v252, v252, v218
v_mfma_f32_16x16x32_bf16 v[236:239], a[212:215], a[116:119], v[236:239]
v_add_f32 v252, v252, v219
v_cvt_pk_bf16_f32 v203, v218, v219
v_mfma_f32_16x16x32_bf16 v[236:239], a[208:211], a[112:115], v[236:239]
v_fma_f32 v220, v220, s27, -v249
v_mfma_f32_16x16x32_bf16 v[236:239], a[204:207], a[108:111], v[236:239]
v_fma_f32 v221, v221, s27, -v249
v_mfma_f32_16x16x32_bf16 v[236:239], a[200:203], a[104:107], v[236:239]
v_exp_f32 v220, v220
v_mfma_f32_16x16x32_bf16 v[236:239], a[196:199], a[100:103], v[236:239]
s_waitcnt vmcnt(10) lgkmcnt(0)
v_fma_f32 v222, v222, s27, -v249
v_fma_f32 v223, v223, s27, -v249
v_mfma_f32_16x16x32_bf16 v[236:239], a[192:195], a[96:99], v[236:239]
s_barrier
v_mfma_f32_16x16x32_bf16 v[208:211], a[224:227], a[0:3], 0
s_add_u32 m0, s26, 16896
ds_read_b64_tr_b16 a[192:193], v241 offset:0
v_mfma_f32_16x16x32_bf16 v[208:211], a[228:231], a[4:7], v[208:211]
buffer_load_dwordx4 v242, s[12:15], s29 offen offset:0 lds
v_mfma_f32_16x16x32_bf16 v[208:211], a[232:235], a[8:11], v[208:211]
v_exp_f32 v221, v221
v_mfma_f32_16x16x32_bf16 v[208:211], a[236:239], a[12:15], v[208:211]
ds_read_b64_tr_b16 a[194:195], v241 offset:512
v_add_f32 v253, v253, v220
v_mfma_f32_16x16x32_bf16 v[208:211], a[240:243], a[16:19], v[208:211]
v_exp_f32 v222, v222
v_mfma_f32_16x16x32_bf16 v[208:211], a[244:247], a[20:23], v[208:211]
ds_read_b64_tr_b16 a[196:197], v241 offset:16
v_add_f32 v253, v253, v221
v_mfma_f32_16x16x32_bf16 v[208:211], a[248:251], a[24:27], v[208:211]
ds_read_b64_tr_b16 a[198:199], v241 offset:528
v_cvt_pk_bf16_f32 v206, v220, v221
v_mfma_f32_16x16x32_bf16 v[208:211], a[252:255], a[28:31], v[208:211]
s_add_u32 m0, s26, 16928
v_exp_f32 v223, v223
v_mfma_f32_16x16x32_bf16 v[212:215], a[252:255], a[60:63], 0
buffer_load_dwordx4 v242, s[12:15], s29 offen offset:1024 lds
v_mfma_f32_16x16x32_bf16 v[212:215], a[248:251], a[56:59], v[212:215]
ds_read_b64_tr_b16 a[200:201], v241 offset:32
v_mfma_f32_16x16x32_bf16 v[212:215], a[244:247], a[52:55], v[212:215]
ds_read_b64_tr_b16 a[202:203], v241 offset:544
v_add_f32 v253, v253, v222
v_mfma_f32_16x16x32_bf16 v[212:215], a[240:243], a[48:51], v[212:215]
v_add_f32 v253, v253, v223
v_mfma_f32_16x16x32_bf16 v[212:215], a[236:239], a[44:47], v[212:215]
ds_read_b64_tr_b16 a[204:205], v241 offset:48
v_cvt_pk_bf16_f32 v207, v222, v223
v_mfma_f32_16x16x32_bf16 v[212:215], a[232:235], a[40:43], v[212:215]
v_fma_f32 v224, v224, s27, -v246
v_fma_f32 v225, v225, s27, -v246
v_mfma_f32_16x16x32_bf16 v[212:215], a[228:231], a[36:39], v[212:215]
v_exp_f32 v224, v224
v_mfma_f32_16x16x32_bf16 v[212:215], a[224:227], a[32:35], v[212:215]
s_add_u32 m0, s26, 16960
ds_read_b64_tr_b16 a[206:207], v241 offset:560
v_mfma_f32_16x16x32_bf16 v[216:219], a[224:227], a[64:67], 0
buffer_load_dwordx4 v242, s[12:15], s29 offen offset:2048 lds
v_mfma_f32_16x16x32_bf16 v[216:219], a[228:231], a[68:71], v[216:219]
ds_read_b64_tr_b16 a[208:209], v241 offset:64
v_fma_f32 v226, v226, s27, -v246
v_mfma_f32_16x16x32_bf16 v[216:219], a[232:235], a[72:75], v[216:219]
ds_read_b64_tr_b16 a[210:211], v241 offset:576
v_fma_f32 v227, v227, s27, -v246
v_mfma_f32_16x16x32_bf16 v[216:219], a[236:239], a[76:79], v[216:219]
v_exp_f32 v225, v225
v_mfma_f32_16x16x32_bf16 v[216:219], a[240:243], a[80:83], v[216:219]
v_add_f32 v250, v250, v224
v_mfma_f32_16x16x32_bf16 v[216:219], a[244:247], a[84:87], v[216:219]
ds_read_b64_tr_b16 a[212:213], v241 offset:80
v_mfma_f32_16x16x32_bf16 v[216:219], a[248:251], a[88:91], v[216:219]
v_exp_f32 v226, v226
v_mfma_f32_16x16x32_bf16 v[216:219], a[252:255], a[92:95], v[216:219]
s_add_u32 m0, s26, 16992
ds_read_b64_tr_b16 a[214:215], v241 offset:592
v_mfma_f32_16x16x32_bf16 v[220:223], a[252:255], a[124:127], 0
buffer_load_dwordx4 v242, s[12:15], s29 offen offset:3072 lds
v_mfma_f32_16x16x32_bf16 v[220:223], a[248:251], a[120:123], v[220:223]
s_add_u32 s29, s29, 16384
ds_read_b64_tr_b16 a[216:217], v241 offset:96
v_add_f32 v250, v250, v225
v_mfma_f32_16x16x32_bf16 v[220:223], a[244:247], a[116:119], v[220:223]
v_cvt_pk_bf16_f32 v224, v224, v225
v_mfma_f32_16x16x32_bf16 v[220:223], a[240:243], a[112:115], v[220:223]
v_exp_f32 v227, v227
v_mfma_f32_16x16x32_bf16 v[220:223], a[236:239], a[108:111], v[220:223]
ds_read_b64_tr_b16 a[218:219], v241 offset:608
v_add_f32 v250, v250, v226
v_mfma_f32_16x16x32_bf16 v[220:223], a[232:235], a[104:107], v[220:223]
v_add_f32 v250, v250, v227
v_cvt_pk_bf16_f32 v225, v226, v227
v_mfma_f32_16x16x32_bf16 v[220:223], a[228:231], a[100:103], v[220:223]
ds_read_b64_tr_b16 a[220:221], v241 offset:112
v_mfma_f32_16x16x32_bf16 v[220:223], a[224:227], a[96:99], v[220:223]
s_waitcnt lgkmcnt(13)
v_fma_f32 v228, v228, s27, -v247
v_fma_f32 v229, v229, s27, -v247
v_mfma_f32_16x16x32_bf16 v[0:3], v[192:195], a[192:195], v[0:3]
ds_read_b64_tr_b16 a[222:223], v241 offset:624
v_mfma_f32_16x16x32_bf16 v[64:67], v[196:199], a[192:195], v[64:67]
v_exp_f32 v228, v228
v_mfma_f32_16x16x32_bf16 v[128:131], v[200:203], a[192:195], v[128:131]
ds_read_b64_tr_b16 a[224:225], v241 offset:256
v_fma_f32 v230, v230, s27, -v247
v_mfma_f32_16x16x32_bf16 a[128:131], v[204:207], a[192:195], a[128:131]
s_waitcnt lgkmcnt(13)
v_fma_f32 v231, v231, s27, -v247
v_mfma_f32_16x16x32_bf16 a[132:135], v[204:207], a[196:199], a[132:135]
v_exp_f32 v229, v229
v_mfma_f32_16x16x32_bf16 v[132:135], v[200:203], a[196:199], v[132:135]
ds_read_b64_tr_b16 a[226:227], v241 offset:768
v_add_f32 v251, v251, v228
v_mfma_f32_16x16x32_bf16 v[68:71], v[196:199], a[196:199], v[68:71]
ds_read_b64_tr_b16 a[228:229], v241 offset:272
v_mfma_f32_16x16x32_bf16 v[4:7], v[192:195], a[196:199], v[4:7]
s_waitcnt lgkmcnt(13)
v_exp_f32 v230, v230
v_mfma_f32_16x16x32_bf16 v[8:11], v[192:195], a[200:203], v[8:11]
ds_read_b64_tr_b16 a[230:231], v241 offset:784
v_add_f32 v251, v251, v229
v_mfma_f32_16x16x32_bf16 v[72:75], v[196:199], a[200:203], v[72:75]
v_cvt_pk_bf16_f32 v228, v228, v229
v_mfma_f32_16x16x32_bf16 v[136:139], v[200:203], a[200:203], v[136:139]
v_exp_f32 v231, v231
v_mfma_f32_16x16x32_bf16 a[136:139], v[204:207], a[200:203], a[136:139]
s_waitcnt lgkmcnt(12)
ds_read_b64_tr_b16 a[232:233], v241 offset:288
v_add_f32 v251, v251, v230
v_mfma_f32_16x16x32_bf16 a[140:143], v[204:207], a[204:207], a[140:143]
ds_read_b64_tr_b16 a[234:235], v241 offset:800
v_add_f32 v251, v251, v231
v_mfma_f32_16x16x32_bf16 v[140:143], v[200:203], a[204:207], v[140:143]
v_cvt_pk_bf16_f32 v229, v230, v231
v_mfma_f32_16x16x32_bf16 v[76:79], v[196:199], a[204:207], v[76:79]
v_fma_f32 v232, v232, s27, -v248
v_fma_f32 v233, v233, s27, -v248
v_mfma_f32_16x16x32_bf16 v[12:15], v[192:195], a[204:207], v[12:15]
s_waitcnt lgkmcnt(12)
ds_read_b64_tr_b16 a[236:237], v241 offset:304
v_mfma_f32_16x16x32_bf16 v[16:19], v[192:195], a[208:211], v[16:19]
v_exp_f32 v232, v232
v_mfma_f32_16x16x32_bf16 v[80:83], v[196:199], a[208:211], v[80:83]
ds_read_b64_tr_b16 a[238:239], v241 offset:816
v_fma_f32 v234, v234, s27, -v248
v_mfma_f32_16x16x32_bf16 v[144:147], v[200:203], a[208:211], v[144:147]
v_fma_f32 v235, v235, s27, -v248
v_mfma_f32_16x16x32_bf16 a[144:147], v[204:207], a[208:211], a[144:147]
s_waitcnt lgkmcnt(12)
ds_read_b64_tr_b16 a[240:241], v241 offset:320
v_mfma_f32_16x16x32_bf16 a[148:151], v[204:207], a[212:215], a[148:151]
v_exp_f32 v233, v233
v_mfma_f32_16x16x32_bf16 v[148:151], v[200:203], a[212:215], v[148:151]
ds_read_b64_tr_b16 a[242:243], v241 offset:832
v_add_f32 v252, v252, v232
v_mfma_f32_16x16x32_bf16 v[84:87], v[196:199], a[212:215], v[84:87]
v_exp_f32 v234, v234
v_mfma_f32_16x16x32_bf16 v[20:23], v[192:195], a[212:215], v[20:23]
s_waitcnt lgkmcnt(12)
ds_read_b64_tr_b16 a[244:245], v241 offset:336
v_add_f32 v252, v252, v233
v_mfma_f32_16x16x32_bf16 v[24:27], v[192:195], a[216:219], v[24:27]
v_cvt_pk_bf16_f32 v232, v232, v233
v_mfma_f32_16x16x32_bf16 v[88:91], v[196:199], a[216:219], v[88:91]
v_exp_f32 v235, v235
v_mfma_f32_16x16x32_bf16 v[152:155], v[200:203], a[216:219], v[152:155]
ds_read_b64_tr_b16 a[246:247], v241 offset:848
v_mfma_f32_16x16x32_bf16 a[152:155], v[204:207], a[216:219], a[152:155]
s_waitcnt lgkmcnt(12)
v_add_f32 v252, v252, v234
v_add_f32 v252, v252, v235
v_mfma_f32_16x16x32_bf16 a[156:159], v[204:207], a[220:223], a[156:159]
ds_read_b64_tr_b16 a[248:249], v241 offset:352
v_cvt_pk_bf16_f32 v233, v234, v235
v_mfma_f32_16x16x32_bf16 v[156:159], v[200:203], a[220:223], v[156:159]
v_fma_f32 v236, v236, s27, -v249
v_mfma_f32_16x16x32_bf16 v[92:95], v[196:199], a[220:223], v[92:95]
ds_read_b64_tr_b16 a[250:251], v241 offset:864
v_fma_f32 v237, v237, s27, -v249
v_mfma_f32_16x16x32_bf16 v[28:31], v[192:195], a[220:223], v[28:31]
s_waitcnt lgkmcnt(12)
v_exp_f32 v236, v236
v_mfma_f32_16x16x32_bf16 v[32:35], v[192:195], a[224:227], v[32:35]
ds_read_b64_tr_b16 a[252:253], v241 offset:368
v_fma_f32 v238, v238, s27, -v249
v_mfma_f32_16x16x32_bf16 v[96:99], v[196:199], a[224:227], v[96:99]
v_fma_f32 v239, v239, s27, -v249
v_mfma_f32_16x16x32_bf16 v[160:163], v[200:203], a[224:227], v[160:163]
ds_read_b64_tr_b16 a[254:255], v241 offset:880
v_mfma_f32_16x16x32_bf16 a[160:163], v[204:207], a[224:227], a[160:163]
s_waitcnt lgkmcnt(12)
v_exp_f32 v237, v237
v_mfma_f32_16x16x32_bf16 a[164:167], v[204:207], a[228:231], a[164:167]
v_add_f32 v253, v253, v236
v_mfma_f32_16x16x32_bf16 v[164:167], v[200:203], a[228:231], v[164:167]
v_exp_f32 v238, v238
v_mfma_f32_16x16x32_bf16 v[100:103], v[196:199], a[228:231], v[100:103]
v_add_f32 v253, v253, v237
v_cvt_pk_bf16_f32 v236, v236, v237
v_mfma_f32_16x16x32_bf16 v[36:39], v[192:195], a[228:231], v[36:39]
s_waitcnt lgkmcnt(10)
v_exp_f32 v239, v239
v_mfma_f32_16x16x32_bf16 v[40:43], v[192:195], a[232:235], v[40:43]
v_add_f32 v253, v253, v238
v_add_f32 v253, v253, v239
v_mfma_f32_16x16x32_bf16 v[104:107], v[196:199], a[232:235], v[104:107]
v_cvt_pk_bf16_f32 v237, v238, v239
v_mfma_f32_16x16x32_bf16 v[168:171], v[200:203], a[232:235], v[168:171]
v_fma_f32 v208, v208, s27, -v246
v_fma_f32 v209, v209, s27, -v246
v_mfma_f32_16x16x32_bf16 a[168:171], v[204:207], a[232:235], a[168:171]
s_waitcnt vmcnt(9) lgkmcnt(0)
v_exp_f32 v208, v208
v_mfma_f32_16x16x32_bf16 a[172:175], v[204:207], a[236:239], a[172:175]
s_barrier
v_mfma_f32_16x16x32_bf16 v[172:175], v[200:203], a[236:239], v[172:175]
s_add_u32 m0, s3, 36864
ds_read_b128 a[192:195], v240 offset:0
ds_read_b128 a[196:199], v240 offset:64
v_mfma_f32_16x16x32_bf16 v[108:111], v[196:199], a[236:239], v[108:111]
buffer_load_dwordx4 v242, s[16:19], s30 offen offset:0 lds
v_mfma_f32_16x16x32_bf16 v[44:47], v[192:195], a[236:239], v[44:47]
ds_read_b128 a[200:203], v240 offset:128
v_fma_f32 v210, v210, s27, -v246
v_mfma_f32_16x16x32_bf16 v[48:51], v[192:195], a[240:243], v[48:51]
ds_read_b128 a[204:207], v240 offset:192
v_fma_f32 v211, v211, s27, -v246
v_mfma_f32_16x16x32_bf16 v[112:115], v[196:199], a[240:243], v[112:115]
s_add_u32 m0, s3, 36880
v_mfma_f32_16x16x32_bf16 v[176:179], v[200:203], a[240:243], v[176:179]
buffer_load_dwordx4 v242, s[16:19], s30 offen offset:1024 lds
v_mfma_f32_16x16x32_bf16 a[176:179], v[204:207], a[240:243], a[176:179]
ds_read_b128 a[208:211], v240 offset:256
v_mfma_f32_16x16x32_bf16 a[180:183], v[204:207], a[244:247], a[180:183]
v_exp_f32 v209, v209
v_mfma_f32_16x16x32_bf16 v[180:183], v[200:203], a[244:247], v[180:183]
s_add_u32 m0, s3, 36896
ds_read_b128 a[212:215], v240 offset:320
v_add_f32 v250, v250, v208
v_mfma_f32_16x16x32_bf16 v[116:119], v[196:199], a[244:247], v[116:119]
buffer_load_dwordx4 v242, s[16:19], s30 offen offset:2048 lds
v_mfma_f32_16x16x32_bf16 v[52:55], v[192:195], a[244:247], v[52:55]
ds_read_b128 a[216:219], v240 offset:384
ds_read_b128 a[220:223], v240 offset:448
v_mfma_f32_16x16x32_bf16 v[56:59], v[192:195], a[248:251], v[56:59]
v_exp_f32 v210, v210
v_mfma_f32_16x16x32_bf16 v[120:123], v[196:199], a[248:251], v[120:123]
s_add_u32 m0, s3, 36912
v_add_f32 v250, v250, v209
v_mfma_f32_16x16x32_bf16 v[184:187], v[200:203], a[248:251], v[184:187]
buffer_load_dwordx4 v242, s[16:19], s30 offen offset:3072 lds
v_mfma_f32_16x16x32_bf16 a[184:187], v[204:207], a[248:251], a[184:187]
s_add_u32 s30, s30, 16384
v_cvt_pk_bf16_f32 v226, v208, v209
v_mfma_f32_16x16x32_bf16 a[188:191], v[204:207], a[252:255], a[188:191]
v_exp_f32 v211, v211
v_mfma_f32_16x16x32_bf16 v[188:191], v[200:203], a[252:255], v[188:191]
v_add_f32 v250, v250, v210
v_add_f32 v250, v250, v211
v_mfma_f32_16x16x32_bf16 v[124:127], v[196:199], a[252:255], v[124:127]
v_cvt_pk_bf16_f32 v227, v210, v211
v_mfma_f32_16x16x32_bf16 v[60:63], v[192:195], a[252:255], v[60:63]
s_sub_u32 s39, s39, 1
s_cbranch_scc0 L_loop4
s_waitcnt lgkmcnt(7)
v_mfma_f32_16x16x32_bf16 v[192:195], a[192:195], a[0:3], 0
s_waitcnt lgkmcnt(6)
ds_read_b128 a[224:227], v240 offset:512
v_fma_f32 v212, v212, s27, -v247
v_mfma_f32_16x16x32_bf16 v[192:195], a[196:199], a[4:7], v[192:195]
s_waitcnt lgkmcnt(6)
v_fma_f32 v213, v213, s27, -v247
v_mfma_f32_16x16x32_bf16 v[192:195], a[200:203], a[8:11], v[192:195]
s_waitcnt lgkmcnt(5)
v_exp_f32 v212, v212
v_mfma_f32_16x16x32_bf16 v[192:195], a[204:207], a[12:15], v[192:195]
s_waitcnt lgkmcnt(4)
ds_read_b128 a[228:231], v240 offset:576
v_fma_f32 v214, v214, s27, -v247
v_mfma_f32_16x16x32_bf16 v[192:195], a[208:211], a[16:19], v[192:195]
s_waitcnt lgkmcnt(4)
ds_read_b128 a[232:235], v240 offset:640
v_fma_f32 v215, v215, s27, -v247
v_mfma_f32_16x16x32_bf16 v[192:195], a[212:215], a[20:23], v[192:195]
s_waitcnt lgkmcnt(4)
v_exp_f32 v213, v213
v_mfma_f32_16x16x32_bf16 v[192:195], a[216:219], a[24:27], v[192:195]
s_waitcnt lgkmcnt(3)
v_add_f32 v251, v251, v212
v_mfma_f32_16x16x32_bf16 v[192:195], a[220:223], a[28:31], v[192:195]
v_exp_f32 v214, v214
v_mfma_f32_16x16x32_bf16 v[196:199], a[220:223], a[60:63], 0
s_add_u32 m0, s5, 0
v_add_f32 v251, v251, v213
v_cvt_pk_bf16_f32 v230, v212, v213
v_mfma_f32_16x16x32_bf16 v[196:199], a[216:219], a[56:59], v[196:199]
buffer_load_dwordx4 v243, s[8:11], s38 offen nt lds
v_mfma_f32_16x16x32_bf16 v[196:199], a[212:215], a[52:55], v[196:199]
s_add_u32 s38, s38, 512
ds_read_b128 a[236:239], v240 offset:704
ds_read_b128 a[240:243], v240 offset:768
v_mfma_f32_16x16x32_bf16 v[196:199], a[208:211], a[48:51], v[196:199]
v_exp_f32 v215, v215
v_mfma_f32_16x16x32_bf16 v[196:199], a[204:207], a[44:47], v[196:199]
v_add_f32 v251, v251, v214
v_add_f32 v251, v251, v215
v_mfma_f32_16x16x32_bf16 v[196:199], a[200:203], a[40:43], v[196:199]
ds_read_b128 a[244:247], v240 offset:832
v_cvt_pk_bf16_f32 v231, v214, v215
v_mfma_f32_16x16x32_bf16 v[196:199], a[196:199], a[36:39], v[196:199]
v_fma_f32 v216, v216, s27, -v248
v_fma_f32 v217, v217, s27, -v248
v_mfma_f32_16x16x32_bf16 v[196:199], a[192:195], a[32:35], v[196:199]
v_exp_f32 v216, v216
v_mfma_f32_16x16x32_bf16 v[200:203], a[192:195], a[64:67], 0
ds_read_b128 a[248:251], v240 offset:896
v_fma_f32 v218, v218, s27, -v248
v_mfma_f32_16x16x32_bf16 v[200:203], a[196:199], a[68:71], v[200:203]
v_fma_f32 v219, v219, s27, -v248
v_mfma_f32_16x16x32_bf16 v[200:203], a[200:203], a[72:75], v[200:203]
s_add_u32 m0, s5, 8448
v_exp_f32 v217, v217
v_mfma_f32_16x16x32_bf16 v[200:203], a[204:207], a[76:79], v[200:203]
s_add_u32 s5, s5, 1056
buffer_load_dwordx4 v243, s[8:11], s33 offen nt lds
v_mfma_f32_16x16x32_bf16 v[200:203], a[208:211], a[80:83], v[200:203]
s_add_u32 s33, s33, 512
ds_read_b128 a[252:255], v240 offset:960
v_add_f32 v252, v252, v216
v_mfma_f32_16x16x32_bf16 v[200:203], a[212:215], a[84:87], v[200:203]
v_exp_f32 v218, v218
v_mfma_f32_16x16x32_bf16 v[200:203], a[216:219], a[88:91], v[200:203]
v_add_f32 v252, v252, v217
v_cvt_pk_bf16_f32 v234, v216, v217
v_mfma_f32_16x16x32_bf16 v[200:203], a[220:223], a[92:95], v[200:203]
v_exp_f32 v219, v219
v_mfma_f32_16x16x32_bf16 v[204:207], a[220:223], a[124:127], 0
v_add_f32 v252, v252, v218
v_add_f32 v252, v252, v219
v_mfma_f32_16x16x32_bf16 v[204:207], a[216:219], a[120:123], v[204:207]
v_cvt_pk_bf16_f32 v235, v218, v219
v_fma_f32 v220, v220, s27, -v249
v_mfma_f32_16x16x32_bf16 v[204:207], a[212:215], a[116:119], v[204:207]
v_fma_f32 v221, v221, s27, -v249
v_mfma_f32_16x16x32_bf16 v[204:207], a[208:211], a[112:115], v[204:207]
v_exp_f32 v220, v220
v_mfma_f32_16x16x32_bf16 v[204:207], a[204:207], a[108:111], v[204:207]
v_fma_f32 v222, v222, s27, -v249
v_fma_f32 v223, v223, s27, -v249
v_mfma_f32_16x16x32_bf16 v[204:207], a[200:203], a[104:107], v[204:207]
v_exp_f32 v221, v221
v_mfma_f32_16x16x32_bf16 v[204:207], a[196:199], a[100:103], v[204:207]
s_waitcnt vmcnt(11) lgkmcnt(0)
v_add_f32 v253, v253, v220
v_mfma_f32_16x16x32_bf16 v[204:207], a[192:195], a[96:99], v[204:207]
s_barrier
v_mfma_f32_16x16x32_bf16 v[208:211], a[224:227], a[0:3], 0
s_mov_b32 s29, s32
s_add_u32 m0, s26, 0
ds_read_b64_tr_b16 a[192:193], v241 offset:16640
v_mfma_f32_16x16x32_bf16 v[208:211], a[228:231], a[4:7], v[208:211]
buffer_load_dwordx4 v242, s[12:15], s29 offen offset:0 lds
v_mfma_f32_16x16x32_bf16 v[208:211], a[232:235], a[8:11], v[208:211]
v_exp_f32 v222, v222
v_mfma_f32_16x16x32_bf16 v[208:211], a[236:239], a[12:15], v[208:211]
ds_read_b64_tr_b16 a[194:195], v241 offset:17152
v_add_f32 v253, v253, v221
v_mfma_f32_16x16x32_bf16 v[208:211], a[240:243], a[16:19], v[208:211]
ds_read_b64_tr_b16 a[196:197], v241 offset:16656
v_cvt_pk_bf16_f32 v238, v220, v221
v_mfma_f32_16x16x32_bf16 v[208:211], a[244:247], a[20:23], v[208:211]
v_exp_f32 v223, v223
v_mfma_f32_16x16x32_bf16 v[208:211], a[248:251], a[24:27], v[208:211]
ds_read_b64_tr_b16 a[198:199], v241 offset:17168
v_add_f32 v253, v253, v222
v_mfma_f32_16x16x32_bf16 v[208:211], a[252:255], a[28:31], v[208:211]
s_add_u32 m0, s26, 32
v_add_f32 v253, v253, v223
v_cvt_pk_bf16_f32 v239, v222, v223
v_mfma_f32_16x16x32_bf16 v[212:215], a[252:255], a[60:63], 0
buffer_load_dwordx4 v242, s[12:15], s29 offen offset:1024 lds
v_mfma_f32_16x16x32_bf16 v[212:215], a[248:251], a[56:59], v[212:215]
ds_read_b64_tr_b16 a[200:201], v241 offset:16672
v_fma_f32 v192, v192, s27, -v246
v_mfma_f32_16x16x32_bf16 v[212:215], a[244:247], a[52:55], v[212:215]
ds_read_b64_tr_b16 a[202:203], v241 offset:17184
v_fma_f32 v193, v193, s27, -v246
v_mfma_f32_16x16x32_bf16 v[212:215], a[240:243], a[48:51], v[212:215]
v_exp_f32 v192, v192
v_mfma_f32_16x16x32_bf16 v[212:215], a[236:239], a[44:47], v[212:215]
ds_read_b64_tr_b16 a[204:205], v241 offset:16688
v_fma_f32 v194, v194, s27, -v246
v_mfma_f32_16x16x32_bf16 v[212:215], a[232:235], a[40:43], v[212:215]
v_fma_f32 v195, v195, s27, -v246
v_mfma_f32_16x16x32_bf16 v[212:215], a[228:231], a[36:39], v[212:215]
v_exp_f32 v193, v193
v_mfma_f32_16x16x32_bf16 v[212:215], a[224:227], a[32:35], v[212:215]
s_add_u32 m0, s26, 64
ds_read_b64_tr_b16 a[206:207], v241 offset:17200
v_add_f32 v250, v250, v192
v_mfma_f32_16x16x32_bf16 v[216:219], a[224:227], a[64:67], 0
buffer_load_dwordx4 v242, s[12:15], s29 offen offset:2048 lds
v_mfma_f32_16x16x32_bf16 v[216:219], a[228:231], a[68:71], v[216:219]
v_exp_f32 v194, v194
v_mfma_f32_16x16x32_bf16 v[216:219], a[232:235], a[72:75], v[216:219]
ds_read_b64_tr_b16 a[208:209], v241 offset:16704
v_add_f32 v250, v250, v193
v_mfma_f32_16x16x32_bf16 v[216:219], a[236:239], a[76:79], v[216:219]
ds_read_b64_tr_b16 a[210:211], v241 offset:17216
v_cvt_pk_bf16_f32 v192, v192, v193
v_mfma_f32_16x16x32_bf16 v[216:219], a[240:243], a[80:83], v[216:219]
v_exp_f32 v195, v195
v_mfma_f32_16x16x32_bf16 v[216:219], a[244:247], a[84:87], v[216:219]
ds_read_b64_tr_b16 a[212:213], v241 offset:16720
v_add_f32 v250, v250, v194
v_mfma_f32_16x16x32_bf16 v[216:219], a[248:251], a[88:91], v[216:219]
v_add_f32 v250, v250, v195
v_mfma_f32_16x16x32_bf16 v[216:219], a[252:255], a[92:95], v[216:219]
s_add_u32 m0, s26, 96
ds_read_b64_tr_b16 a[214:215], v241 offset:17232
v_mfma_f32_16x16x32_bf16 v[220:223], a[252:255], a[124:127], 0
buffer_load_dwordx4 v242, s[12:15], s29 offen offset:3072 lds
v_mfma_f32_16x16x32_bf16 v[220:223], a[248:251], a[120:123], v[220:223]
s_add_u32 s29, s29, 16384
ds_read_b64_tr_b16 a[216:217], v241 offset:16736
v_cvt_pk_bf16_f32 v193, v194, v195
v_mfma_f32_16x16x32_bf16 v[220:223], a[244:247], a[116:119], v[220:223]
v_fma_f32 v196, v196, s27, -v247
v_fma_f32 v197, v197, s27, -v247
v_mfma_f32_16x16x32_bf16 v[220:223], a[240:243], a[112:115], v[220:223]
v_exp_f32 v196, v196
v_mfma_f32_16x16x32_bf16 v[220:223], a[236:239], a[108:111], v[220:223]
ds_read_b64_tr_b16 a[218:219], v241 offset:17248
v_fma_f32 v198, v198, s27, -v247
v_mfma_f32_16x16x32_bf16 v[220:223], a[232:235], a[104:107], v[220:223]
ds_read_b64_tr_b16 a[220:221], v241 offset:16752
v_fma_f32 v199, v199, s27, -v247
v_mfma_f32_16x16x32_bf16 v[220:223], a[228:231], a[100:103], v[220:223]
v_exp_f32 v197, v197
v_mfma_f32_16x16x32_bf16 v[220:223], a[224:227], a[96:99], v[220:223]
s_waitcnt lgkmcnt(13)
ds_read_b64_tr_b16 a[222:223], v241 offset:17264
v_add_f32 v251, v251, v196
v_mfma_f32_16x16x32_bf16 v[0:3], v[224:227], a[192:195], v[0:3]
v_exp_f32 v198, v198
v_mfma_f32_16x16x32_bf16 v[64:67], v[228:231], a[192:195], v[64:67]
v_add_f32 v251, v251, v197
v_cvt_pk_bf16_f32 v196, v196, v197
v_mfma_f32_16x16x32_bf16 v[128:131], v[232:235], a[192:195], v[128:131]
ds_read_b64_tr_b16 a[224:225], v241 offset:16896
v_mfma_f32_16x16x32_bf16 a[128:131], v[236:239], a[192:195], a[128:131]
s_waitcnt lgkmcnt(13)
v_exp_f32 v199, v199
v_mfma_f32_16x16x32_bf16 a[132:135], v[236:239], a[196:199], a[132:135]
ds_read_b64_tr_b16 a[226:227], v241 offset:17408
v_add_f32 v251, v251, v198
v_mfma_f32_16x16x32_bf16 v[132:135], v[232:235], a[196:199], v[132:135]
v_add_f32 v251, v251, v199
v_cvt_pk_bf16_f32 v197, v198, v199
v_mfma_f32_16x16x32_bf16 v[68:71], v[228:231], a[196:199], v[68:71]
ds_read_b64_tr_b16 a[228:229], v241 offset:16912
v_fma_f32 v200, v200, s27, -v248
v_mfma_f32_16x16x32_bf16 v[4:7], v[224:227], a[196:199], v[4:7]
s_waitcnt lgkmcnt(13)
v_fma_f32 v201, v201, s27, -v248
v_mfma_f32_16x16x32_bf16 v[8:11], v[224:227], a[200:203], v[8:11]
ds_read_b64_tr_b16 a[230:231], v241 offset:17424
v_mfma_f32_16x16x32_bf16 v[72:75], v[228:231], a[200:203], v[72:75]
v_exp_f32 v200, v200
v_mfma_f32_16x16x32_bf16 v[136:139], v[232:235], a[200:203], v[136:139]
v_fma_f32 v202, v202, s27, -v248
v_fma_f32 v203, v203, s27, -v248
v_mfma_f32_16x16x32_bf16 a[136:139], v[236:239], a[200:203], a[136:139]
s_waitcnt lgkmcnt(12)
v_exp_f32 v201, v201
v_mfma_f32_16x16x32_bf16 a[140:143], v[236:239], a[204:207], a[140:143]
ds_read_b64_tr_b16 a[232:233], v241 offset:16928
v_add_f32 v252, v252, v200
v_mfma_f32_16x16x32_bf16 v[140:143], v[232:235], a[204:207], v[140:143]
ds_read_b64_tr_b16 a[234:235], v241 offset:17440
v_mfma_f32_16x16x32_bf16 v[76:79], v[228:231], a[204:207], v[76:79]
v_exp_f32 v202, v202
v_mfma_f32_16x16x32_bf16 v[12:15], v[224:227], a[204:207], v[12:15]
s_waitcnt lgkmcnt(12)
ds_read_b64_tr_b16 a[236:237], v241 offset:16944
v_add_f32 v252, v252, v201
v_mfma_f32_16x16x32_bf16 v[16:19], v[224:227], a[208:211], v[16:19]
v_cvt_pk_bf16_f32 v200, v200, v201
v_mfma_f32_16x16x32_bf16 v[80:83], v[228:231], a[208:211], v[80:83]
v_exp_f32 v203, v203
v_mfma_f32_16x16x32_bf16 v[144:147], v[232:235], a[208:211], v[144:147]
ds_read_b64_tr_b16 a[238:239], v241 offset:17456
v_add_f32 v252, v252, v202
v_mfma_f32_16x16x32_bf16 a[144:147], v[236:239], a[208:211], a[144:147]
s_waitcnt lgkmcnt(12)
ds_read_b64_tr_b16 a[240:241], v241 offset:16960
v_add_f32 v252, v252, v203
v_mfma_f32_16x16x32_bf16 a[148:151], v[236:239], a[212:215], a[148:151]
v_cvt_pk_bf16_f32 v201, v202, v203
v_fma_f32 v204, v204, s27, -v249
v_mfma_f32_16x16x32_bf16 v[148:151], v[232:235], a[212:215], v[148:151]
ds_read_b64_tr_b16 a[242:243], v241 offset:17472
v_fma_f32 v205, v205, s27, -v249
v_mfma_f32_16x16x32_bf16 v[84:87], v[228:231], a[212:215], v[84:87]
v_exp_f32 v204, v204
v_mfma_f32_16x16x32_bf16 v[20:23], v[224:227], a[212:215], v[20:23]
s_waitcnt lgkmcnt(12)
v_fma_f32 v206, v206, s27, -v249
v_fma_f32 v207, v207, s27, -v249
v_mfma_f32_16x16x32_bf16 v[24:27], v[224:227], a[216:219], v[24:27]
ds_read_b64_tr_b16 a[244:245], v241 offset:16976
v_mfma_f32_16x16x32_bf16 v[88:91], v[228:231], a[216:219], v[88:91]
v_exp_f32 v205, v205
v_mfma_f32_16x16x32_bf16 v[152:155], v[232:235], a[216:219], v[152:155]
ds_read_b64_tr_b16 a[246:247], v241 offset:17488
v_add_f32 v253, v253, v204
v_mfma_f32_16x16x32_bf16 a[152:155], v[236:239], a[216:219], a[152:155]
s_waitcnt lgkmcnt(12)
v_exp_f32 v206, v206
v_mfma_f32_16x16x32_bf16 a[156:159], v[236:239], a[220:223], a[156:159]
ds_read_b64_tr_b16 a[248:249], v241 offset:16992
v_add_f32 v253, v253, v205
v_mfma_f32_16x16x32_bf16 v[156:159], v[232:235], a[220:223], v[156:159]
v_cvt_pk_bf16_f32 v204, v204, v205
v_mfma_f32_16x16x32_bf16 v[92:95], v[228:231], a[220:223], v[92:95]
v_exp_f32 v207, v207
v_mfma_f32_16x16x32_bf16 v[28:31], v[224:227], a[220:223], v[28:31]
s_waitcnt lgkmcnt(11)
ds_read_b64_tr_b16 a[250:251], v241 offset:17504
v_add_f32 v253, v253, v206
v_mfma_f32_16x16x32_bf16 v[32:35], v[224:227], a[224:227], v[32:35]
ds_read_b64_tr_b16 a[252:253], v241 offset:17008
v_add_f32 v253, v253, v207
v_mfma_f32_16x16x32_bf16 v[96:99], v[228:231], a[224:227], v[96:99]
v_cvt_pk_bf16_f32 v205, v206, v207
v_fma_f32 v208, v208, s27, -v246
v_mfma_f32_16x16x32_bf16 v[160:163], v[232:235], a[224:227], v[160:163]
ds_read_b64_tr_b16 a[254:255], v241 offset:17520
v_fma_f32 v209, v209, s27, -v246
v_mfma_f32_16x16x32_bf16 a[160:163], v[236:239], a[224:227], a[160:163]
s_waitcnt lgkmcnt(12)
v_exp_f32 v208, v208
v_mfma_f32_16x16x32_bf16 a[164:167], v[236:239], a[228:231], a[164:167]
v_fma_f32 v210, v210, s27, -v246
v_fma_f32 v211, v211, s27, -v246
v_mfma_f32_16x16x32_bf16 v[164:167], v[232:235], a[228:231], v[164:167]
v_exp_f32 v209, v209
v_mfma_f32_16x16x32_bf16 v[100:103], v[228:231], a[228:231], v[100:103]
v_add_f32 v250, v250, v208
v_mfma_f32_16x16x32_bf16 v[36:39], v[224:227], a[228:231], v[36:39]
s_waitcnt lgkmcnt(10)
v_exp_f32 v210, v210
v_mfma_f32_16x16x32_bf16 v[40:43], v[224:227], a[232:235], v[40:43]
v_add_f32 v250, v250, v209
v_cvt_pk_bf16_f32 v194, v208, v209
v_mfma_f32_16x16x32_bf16 v[104:107], v[228:231], a[232:235], v[104:107]
v_exp_f32 v211, v211
v_mfma_f32_16x16x32_bf16 v[168:171], v[232:235], a[232:235], v[168:171]
v_add_f32 v250, v250, v210
v_add_f32 v250, v250, v211
v_mfma_f32_16x16x32_bf16 a[168:171], v[236:239], a[232:235], a[168:171]
s_waitcnt vmcnt(10) lgkmcnt(0)
v_cvt_pk_bf16_f32 v195, v210, v211
v_fma_f32 v212, v212, s27, -v247
v_mfma_f32_16x16x32_bf16 a[172:175], v[236:239], a[236:239], a[172:175]
s_barrier
v_mfma_f32_16x16x32_bf16 v[172:175], v[232:235], a[236:239], v[172:175]
s_add_u32 m0, s3, 53504
ds_read_b128 a[192:195], v240 offset:16896
ds_read_b128 a[196:199], v240 offset:16960
v_mfma_f32_16x16x32_bf16 v[108:111], v[228:231], a[236:239], v[108:111]
buffer_load_dwordx4 v242, s[16:19], s30 offen offset:0 lds
v_mfma_f32_16x16x32_bf16 v[44:47], v[224:227], a[236:239], v[44:47]
ds_read_b128 a[200:203], v240 offset:17024
v_fma_f32 v213, v213, s27, -v247
v_mfma_f32_16x16x32_bf16 v[48:51], v[224:227], a[240:243], v[48:51]
v_exp_f32 v212, v212
v_mfma_f32_16x16x32_bf16 v[112:115], v[228:231], a[240:243], v[112:115]
s_add_u32 m0, s3, 53520
ds_read_b128 a[204:207], v240 offset:17088
v_mfma_f32_16x16x32_bf16 v[176:179], v[232:235], a[240:243], v[176:179]
buffer_load_dwordx4 v242, s[16:19], s30 offen offset:1024 lds
v_mfma_f32_16x16x32_bf16 a[176:179], v[236:239], a[240:243], a[176:179]
ds_read_b128 a[208:211], v240 offset:17152
v_fma_f32 v214, v214, s27, -v247
v_mfma_f32_16x16x32_bf16 a[180:183], v[236:239], a[244:247], a[180:183]
ds_read_b128 a[212:215], v240 offset:17216
v_fma_f32 v215, v215, s27, -v247
v_mfma_f32_16x16x32_bf16 v[180:183], v[232:235], a[244:247], v[180:183]
s_add_u32 m0, s3, 53536
v_exp_f32 v213, v213
v_mfma_f32_16x16x32_bf16 v[116:119], v[228:231], a[244:247], v[116:119]
buffer_load_dwordx4 v242, s[16:19], s30 offen offset:2048 lds
v_mfma_f32_16x16x32_bf16 v[52:55], v[224:227], a[244:247], v[52:55]
ds_read_b128 a[216:219], v240 offset:17280
v_add_f32 v251, v251, v212
v_mfma_f32_16x16x32_bf16 v[56:59], v[224:227], a[248:251], v[56:59]
v_exp_f32 v214, v214
v_mfma_f32_16x16x32_bf16 v[120:123], v[228:231], a[248:251], v[120:123]
s_add_u32 m0, s3, 53552
ds_read_b128 a[220:223], v240 offset:17344
v_mfma_f32_16x16x32_bf16 v[184:187], v[232:235], a[248:251], v[184:187]
buffer_load_dwordx4 v242, s[16:19], s30 offen offset:3072 lds
v_mfma_f32_16x16x32_bf16 a[184:187], v[236:239], a[248:251], a[184:187]
s_add_u32 s30, s30, 16384
v_add_f32 v251, v251, v213
v_cvt_pk_bf16_f32 v198, v212, v213
v_mfma_f32_16x16x32_bf16 a[188:191], v[236:239], a[252:255], a[188:191]
v_exp_f32 v215, v215
v_mfma_f32_16x16x32_bf16 v[188:191], v[232:235], a[252:255], v[188:191]
v_add_f32 v251, v251, v214
v_add_f32 v251, v251, v215
v_mfma_f32_16x16x32_bf16 v[124:127], v[228:231], a[252:255], v[124:127]
v_cvt_pk_bf16_f32 v199, v214, v215
v_mfma_f32_16x16x32_bf16 v[60:63], v[224:227], a[252:255], v[60:63]
s_waitcnt lgkmcnt(7)
v_mfma_f32_16x16x32_bf16 v[224:227], a[192:195], a[0:3], 0
s_waitcnt lgkmcnt(6)
ds_read_b128 a[224:227], v240 offset:17408
v_fma_f32 v216, v216, s27, -v248
v_mfma_f32_16x16x32_bf16 v[224:227], a[196:199], a[4:7], v[224:227]
s_waitcnt lgkmcnt(6)
v_fma_f32 v217, v217, s27, -v248
v_fma_f32 v218, v218, s27, -v248
v_mfma_f32_16x16x32_bf16 v[224:227], a[200:203], a[8:11], v[224:227]
s_waitcnt lgkmcnt(5)
v_exp_f32 v216, v216
v_mfma_f32_16x16x32_bf16 v[224:227], a[204:207], a[12:15], v[224:227]
s_waitcnt lgkmcnt(4)
ds_read_b128 a[228:231], v240 offset:17472
v_fma_f32 v219, v219, s27, -v248
v_mfma_f32_16x16x32_bf16 v[224:227], a[208:211], a[16:19], v[224:227]
s_waitcnt lgkmcnt(4)
v_exp_f32 v217, v217
v_mfma_f32_16x16x32_bf16 v[224:227], a[212:215], a[20:23], v[224:227]
s_waitcnt lgkmcnt(3)
ds_read_b128 a[232:235], v240 offset:17536
v_add_f32 v252, v252, v216
v_mfma_f32_16x16x32_bf16 v[224:227], a[216:219], a[24:27], v[224:227]
s_waitcnt lgkmcnt(3)
v_exp_f32 v218, v218
v_mfma_f32_16x16x32_bf16 v[224:227], a[220:223], a[28:31], v[224:227]
v_add_f32 v252, v252, v217
v_cvt_pk_bf16_f32 v202, v216, v217
v_mfma_f32_16x16x32_bf16 v[228:231], a[220:223], a[60:63], 0
v_exp_f32 v219, v219
v_mfma_f32_16x16x32_bf16 v[228:231], a[216:219], a[56:59], v[228:231]
ds_read_b128 a[236:239], v240 offset:17600
v_add_f32 v252, v252, v218
v_mfma_f32_16x16x32_bf16 v[228:231], a[212:215], a[52:55], v[228:231]
v_add_f32 v252, v252, v219
v_cvt_pk_bf16_f32 v203, v218, v219
v_mfma_f32_16x16x32_bf16 v[228:231], a[208:211], a[48:51], v[228:231]
ds_read_b128 a[240:243], v240 offset:17664
v_fma_f32 v220, v220, s27, -v249
v_mfma_f32_16x16x32_bf16 v[228:231], a[204:207], a[44:47], v[228:231]
v_fma_f32 v221, v221, s27, -v249
v_fma_f32 v222, v222, s27, -v249
v_mfma_f32_16x16x32_bf16 v[228:231], a[200:203], a[40:43], v[228:231]
v_exp_f32 v220, v220
v_mfma_f32_16x16x32_bf16 v[228:231], a[196:199], a[36:39], v[228:231]
ds_read_b128 a[244:247], v240 offset:17728
v_fma_f32 v223, v223, s27, -v249
v_mfma_f32_16x16x32_bf16 v[228:231], a[192:195], a[32:35], v[228:231]
v_exp_f32 v221, v221
v_mfma_f32_16x16x32_bf16 v[232:235], a[192:195], a[64:67], 0
ds_read_b128 a[248:251], v240 offset:17792
v_add_f32 v253, v253, v220
v_mfma_f32_16x16x32_bf16 v[232:235], a[196:199], a[68:71], v[232:235]
v_exp_f32 v222, v222
v_mfma_f32_16x16x32_bf16 v[232:235], a[200:203], a[72:75], v[232:235]
v_add_f32 v253, v253, v221
v_cvt_pk_bf16_f32 v206, v220, v221
v_mfma_f32_16x16x32_bf16 v[232:235], a[204:207], a[76:79], v[232:235]
v_exp_f32 v223, v223
v_mfma_f32_16x16x32_bf16 v[232:235], a[208:211], a[80:83], v[232:235]
ds_read_b128 a[252:255], v240 offset:17856
v_add_f32 v253, v253, v222
v_mfma_f32_16x16x32_bf16 v[232:235], a[212:215], a[84:87], v[232:235]
v_add_f32 v253, v253, v223
v_cvt_pk_bf16_f32 v207, v222, v223
v_mfma_f32_16x16x32_bf16 v[232:235], a[216:219], a[88:91], v[232:235]
v_fma_f32 v224, v224, s27, -v246
v_fma_f32 v225, v225, s27, -v246
v_mfma_f32_16x16x32_bf16 v[232:235], a[220:223], a[92:95], v[232:235]
v_exp_f32 v224, v224
v_mfma_f32_16x16x32_bf16 v[236:239], a[220:223], a[124:127], 0
v_fma_f32 v226, v226, s27, -v246
v_fma_f32 v227, v227, s27, -v246
v_mfma_f32_16x16x32_bf16 v[236:239], a[216:219], a[120:123], v[236:239]
v_exp_f32 v225, v225
v_mfma_f32_16x16x32_bf16 v[236:239], a[212:215], a[116:119], v[236:239]
v_add_f32 v250, v250, v224
v_add_f32 v250, v250, v225
v_mfma_f32_16x16x32_bf16 v[236:239], a[208:211], a[112:115], v[236:239]
v_exp_f32 v226, v226
v_mfma_f32_16x16x32_bf16 v[236:239], a[204:207], a[108:111], v[236:239]
v_cvt_pk_bf16_f32 v224, v224, v225
v_add_f32 v250, v250, v226
v_mfma_f32_16x16x32_bf16 v[236:239], a[200:203], a[104:107], v[236:239]
v_exp_f32 v227, v227
v_mfma_f32_16x16x32_bf16 v[236:239], a[196:199], a[100:103], v[236:239]
s_waitcnt vmcnt(10) lgkmcnt(0)
v_add_f32 v250, v250, v227
v_cvt_pk_bf16_f32 v225, v226, v227
v_mfma_f32_16x16x32_bf16 v[236:239], a[192:195], a[96:99], v[236:239]
s_barrier
v_mfma_f32_16x16x32_bf16 v[208:211], a[224:227], a[0:3], 0
s_add_u32 m0, s26, 16896
v_fma_f32 v228, v228, s27, -v247
v_fma_f32 v229, v229, s27, -v247
v_mfma_f32_16x16x32_bf16 v[208:211], a[228:231], a[4:7], v[208:211]
buffer_load_dwordx4 v242, s[12:15], s29 offen offset:0 lds
v_mfma_f32_16x16x32_bf16 v[208:211], a[232:235], a[8:11], v[208:211]
v_exp_f32 v228, v228
v_mfma_f32_16x16x32_bf16 v[208:211], a[236:239], a[12:15], v[208:211]
ds_read_b64_tr_b16 a[192:193], v241 offset:0
v_fma_f32 v230, v230, s27, -v247
v_mfma_f32_16x16x32_bf16 v[208:211], a[240:243], a[16:19], v[208:211]
ds_read_b64_tr_b16 a[194:195], v241 offset:512
v_fma_f32 v231, v231, s27, -v247
v_mfma_f32_16x16x32_bf16 v[208:211], a[244:247], a[20:23], v[208:211]
s_add_u32 m0, s26, 16928
v_exp_f32 v229, v229
v_mfma_f32_16x16x32_bf16 v[208:211], a[248:251], a[24:27], v[208:211]
buffer_load_dwordx4 v242, s[12:15], s29 offen offset:1024 lds
v_mfma_f32_16x16x32_bf16 v[208:211], a[252:255], a[28:31], v[208:211]
ds_read_b64_tr_b16 a[196:197], v241 offset:16
v_add_f32 v251, v251, v228
v_mfma_f32_16x16x32_bf16 v[212:215], a[252:255], a[60:63], 0
s_waitcnt vmcnt(10)
v_exp_f32 v230, v230
v_mfma_f32_16x16x32_bf16 v[212:215], a[248:251], a[56:59], v[212:215]
ds_read_b64_tr_b16 a[198:199], v241 offset:528
v_add_f32 v251, v251, v229
v_mfma_f32_16x16x32_bf16 v[212:215], a[244:247], a[52:55], v[212:215]
s_add_u32 m0, s26, 16960
ds_read_b128 a[0:3], v255 offset:0
v_cvt_pk_bf16_f32 v228, v228, v229
v_mfma_f32_16x16x32_bf16 v[212:215], a[240:243], a[48:51], v[212:215]
buffer_load_dwordx4 v242, s[12:15], s29 offen offset:2048 lds
v_mfma_f32_16x16x32_bf16 v[212:215], a[236:239], a[44:47], v[212:215]
ds_read_b128 a[4:7], v255 offset:64
ds_read_b64_tr_b16 a[200:201], v241 offset:32
v_mfma_f32_16x16x32_bf16 v[212:215], a[232:235], a[40:43], v[212:215]
ds_read_b128 a[8:11], v255 offset:128
ds_read_b128 a[12:15], v255 offset:192
v_mfma_f32_16x16x32_bf16 v[212:215], a[228:231], a[36:39], v[212:215]
ds_read_b128 a[16:19], v255 offset:256
ds_read_b64_tr_b16 a[202:203], v241 offset:544
v_mfma_f32_16x16x32_bf16 v[212:215], a[224:227], a[32:35], v[212:215]
s_add_u32 m0, s26, 16992
ds_read_b128 a[20:23], v255 offset:320
ds_read_b64_tr_b16 a[204:205], v241 offset:48
v_mfma_f32_16x16x32_bf16 v[216:219], a[224:227], a[64:67], 0
buffer_load_dwordx4 v242, s[12:15], s29 offen offset:3072 lds
v_mfma_f32_16x16x32_bf16 v[216:219], a[228:231], a[68:71], v[216:219]
s_add_u32 s29, s29, 16384
ds_read_b128 a[24:27], v255 offset:384
ds_read_b128 a[28:31], v255 offset:448
v_mfma_f32_16x16x32_bf16 v[216:219], a[232:235], a[72:75], v[216:219]
v_exp_f32 v231, v231
v_mfma_f32_16x16x32_bf16 v[216:219], a[236:239], a[76:79], v[216:219]
ds_read_b64_tr_b16 a[206:207], v241 offset:560
v_add_f32 v251, v251, v230
v_mfma_f32_16x16x32_bf16 v[216:219], a[240:243], a[80:83], v[216:219]
v_add_f32 v251, v251, v231
v_cvt_pk_bf16_f32 v229, v230, v231
v_mfma_f32_16x16x32_bf16 v[216:219], a[244:247], a[84:87], v[216:219]
ds_read_b64_tr_b16 a[208:209], v241 offset:64
v_fma_f32 v232, v232, s27, -v248
v_mfma_f32_16x16x32_bf16 v[216:219], a[248:251], a[88:91], v[216:219]
ds_read_b64_tr_b16 a[210:211], v241 offset:576
v_fma_f32 v233, v233, s27, -v248
v_mfma_f32_16x16x32_bf16 v[216:219], a[252:255], a[92:95], v[216:219]
v_exp_f32 v232, v232
v_mfma_f32_16x16x32_bf16 v[220:223], a[252:255], a[124:127], 0
v_fma_f32 v234, v234, s27, -v248
v_fma_f32 v235, v235, s27, -v248
v_mfma_f32_16x16x32_bf16 v[220:223], a[248:251], a[120:123], v[220:223]
ds_read_b64_tr_b16 a[212:213], v241 offset:80
v_add_f32 v252, v252, v232
v_mfma_f32_16x16x32_bf16 v[220:223], a[244:247], a[116:119], v[220:223]
v_exp_f32 v233, v233
v_mfma_f32_16x16x32_bf16 v[220:223], a[240:243], a[112:115], v[220:223]
v_exp_f32 v234, v234
v_mfma_f32_16x16x32_bf16 v[220:223], a[236:239], a[108:111], v[220:223]
ds_read_b64_tr_b16 a[214:215], v241 offset:592
v_add_f32 v252, v252, v233
v_mfma_f32_16x16x32_bf16 v[220:223], a[232:235], a[104:107], v[220:223]
ds_read_b64_tr_b16 a[216:217], v241 offset:96
v_cvt_pk_bf16_f32 v232, v232, v233
v_mfma_f32_16x16x32_bf16 v[220:223], a[228:231], a[100:103], v[220:223]
v_exp_f32 v235, v235
v_mfma_f32_16x16x32_bf16 v[220:223], a[224:227], a[96:99], v[220:223]
s_waitcnt lgkmcnt(15)
v_add_f32 v252, v252, v234
v_add_f32 v252, v252, v235
v_mfma_f32_16x16x32_bf16 v[0:3], v[192:195], a[192:195], v[0:3]
ds_read_b64_tr_b16 a[218:219], v241 offset:608
v_cvt_pk_bf16_f32 v233, v234, v235
v_mfma_f32_16x16x32_bf16 v[64:67], v[196:199], a[192:195], v[64:67]
v_fma_f32 v236, v236, s27, -v249
v_fma_f32 v237, v237, s27, -v249
v_mfma_f32_16x16x32_bf16 v[128:131], v[200:203], a[192:195], v[128:131]
v_exp_f32 v236, v236
v_mfma_f32_16x16x32_bf16 a[128:131], v[204:207], a[192:195], a[128:131]
s_waitcnt lgkmcnt(15)
ds_read_b64_tr_b16 a[220:221], v241 offset:112
v_fma_f32 v238, v238, s27, -v249
v_mfma_f32_16x16x32_bf16 a[132:135], v[204:207], a[196:199], a[132:135]
s_add_u32 s38, s36, 16384
ds_read_b64_tr_b16 a[222:223], v241 offset:624
v_fma_f32 v239, v239, s27, -v249
v_mfma_f32_16x16x32_bf16 v[132:135], v[200:203], a[196:199], v[132:135]
s_add_u32 m0, s4, 0
v_exp_f32 v237, v237
v_mfma_f32_16x16x32_bf16 v[68:71], v[196:199], a[196:199], v[68:71]
s_waitcnt lgkmcnt(9)
buffer_load_dwordx4 v243, s[8:11], s38 offen offset:0 nt lds
v_mfma_f32_16x16x32_bf16 v[4:7], v[192:195], a[196:199], v[4:7]
ds_read_b64_tr_b16 a[224:225], v241 offset:256
v_add_f32 v253, v253, v236
v_mfma_f32_16x16x32_bf16 v[8:11], v[192:195], a[200:203], v[8:11]
v_exp_f32 v238, v238
v_mfma_f32_16x16x32_bf16 v[72:75], v[196:199], a[200:203], v[72:75]
s_add_u32 m0, s4, 544
v_add_f32 v253, v253, v237
v_cvt_pk_bf16_f32 v236, v236, v237
v_mfma_f32_16x16x32_bf16 v[136:139], v[200:203], a[200:203], v[136:139]
buffer_load_dwordx4 v243, s[8:11], s38 offen offset:512 nt lds
v_mfma_f32_16x16x32_bf16 a[136:139], v[204:207], a[200:203], a[136:139]
s_waitcnt lgkmcnt(9)
ds_read_b64_tr_b16 a[226:227], v241 offset:768
v_add_f32 v253, v253, v238
v_mfma_f32_16x16x32_bf16 a[140:143], v[204:207], a[204:207], a[140:143]
v_exp_f32 v239, v239
v_mfma_f32_16x16x32_bf16 v[140:143], v[200:203], a[204:207], v[140:143]
ds_read_b64_tr_b16 a[228:229], v241 offset:272
v_add_f32 v253, v253, v239
v_mfma_f32_16x16x32_bf16 v[76:79], v[196:199], a[204:207], v[76:79]
s_add_u32 m0, s4, 1088
ds_read_b64_tr_b16 a[230:231], v241 offset:784
v_cvt_pk_bf16_f32 v237, v238, v239
v_mfma_f32_16x16x32_bf16 v[12:15], v[192:195], a[204:207], v[12:15]
s_waitcnt lgkmcnt(10)
buffer_load_dwordx4 v243, s[8:11], s38 offen offset:1024 nt lds
v_mfma_f32_16x16x32_bf16 v[16:19], v[192:195], a[208:211], v[16:19]
v_fma_f32 v208, v208, s27, -v246
v_fma_f32 v209, v209, s27, -v246
v_mfma_f32_16x16x32_bf16 v[80:83], v[196:199], a[208:211], v[80:83]
v_exp_f32 v208, v208
v_mfma_f32_16x16x32_bf16 v[144:147], v[200:203], a[208:211], v[144:147]
ds_read_b64_tr_b16 a[232:233], v241 offset:288
v_fma_f32 v210, v210, s27, -v246
v_mfma_f32_16x16x32_bf16 a[144:147], v[204:207], a[208:211], a[144:147]
s_waitcnt lgkmcnt(9)
ds_read_b64_tr_b16 a[234:235], v241 offset:800
v_fma_f32 v211, v211, s27, -v246
v_mfma_f32_16x16x32_bf16 a[148:151], v[204:207], a[212:215], a[148:151]
s_add_u32 m0, s4, 1632
v_exp_f32 v209, v209
v_mfma_f32_16x16x32_bf16 v[148:151], v[200:203], a[212:215], v[148:151]
buffer_load_dwordx4 v243, s[8:11], s38 offen offset:1536 nt lds
v_mfma_f32_16x16x32_bf16 v[84:87], v[196:199], a[212:215], v[84:87]
ds_read_b64_tr_b16 a[236:237], v241 offset:304
v_add_f32 v250, v250, v208
v_mfma_f32_16x16x32_bf16 v[20:23], v[192:195], a[212:215], v[20:23]
s_waitcnt lgkmcnt(9)
v_exp_f32 v210, v210
v_mfma_f32_16x16x32_bf16 v[24:27], v[192:195], a[216:219], v[24:27]
ds_read_b64_tr_b16 a[238:239], v241 offset:816
v_add_f32 v250, v250, v209
v_mfma_f32_16x16x32_bf16 v[88:91], v[196:199], a[216:219], v[88:91]
s_add_u32 m0, s4, 2176
ds_read_b64_tr_b16 a[240:241], v241 offset:320
v_cvt_pk_bf16_f32 v226, v208, v209
v_mfma_f32_16x16x32_bf16 v[152:155], v[200:203], a[216:219], v[152:155]
buffer_load_dwordx4 v243, s[8:11], s38 offen offset:2048 nt lds
v_mfma_f32_16x16x32_bf16 a[152:155], v[204:207], a[216:219], a[152:155]
s_waitcnt lgkmcnt(9)
v_exp_f32 v211, v211
v_mfma_f32_16x16x32_bf16 a[156:159], v[204:207], a[220:223], a[156:159]
v_add_f32 v250, v250, v210
v_add_f32 v250, v250, v211
v_mfma_f32_16x16x32_bf16 v[156:159], v[200:203], a[220:223], v[156:159]
s_add_u32 m0, s4, 2720
v_cvt_pk_bf16_f32 v227, v210, v211
v_fma_f32 v212, v212, s27, -v247
v_mfma_f32_16x16x32_bf16 v[92:95], v[196:199], a[220:223], v[92:95]
buffer_load_dwordx4 v243, s[8:11], s38 offen offset:2560 nt lds
v_mfma_f32_16x16x32_bf16 v[28:31], v[192:195], a[220:223], v[28:31]
s_waitcnt lgkmcnt(7)
ds_read_b64_tr_b16 a[242:243], v241 offset:832
v_fma_f32 v213, v213, s27, -v247
v_mfma_f32_16x16x32_bf16 v[32:35], v[192:195], a[224:227], v[32:35]
ds_read_b64_tr_b16 a[244:245], v241 offset:336
v_fma_f32 v214, v214, s27, -v247
v_mfma_f32_16x16x32_bf16 v[96:99], v[196:199], a[224:227], v[96:99]
v_exp_f32 v212, v212
v_mfma_f32_16x16x32_bf16 v[160:163], v[200:203], a[224:227], v[160:163]
s_add_u32 m0, s4, 3264
ds_read_b64_tr_b16 a[246:247], v241 offset:848
v_fma_f32 v215, v215, s27, -v247
v_mfma_f32_16x16x32_bf16 a[160:163], v[204:207], a[224:227], a[160:163]
s_waitcnt lgkmcnt(8)
buffer_load_dwordx4 v243, s[8:11], s38 offen offset:3072 nt lds
v_mfma_f32_16x16x32_bf16 a[164:167], v[204:207], a[228:231], a[164:167]
ds_read_b64_tr_b16 a[248:249], v241 offset:352
v_add_f32 v251, v251, v212
v_mfma_f32_16x16x32_bf16 v[164:167], v[200:203], a[228:231], v[164:167]
v_exp_f32 v213, v213
v_mfma_f32_16x16x32_bf16 v[100:103], v[196:199], a[228:231], v[100:103]
v_exp_f32 v214, v214
v_mfma_f32_16x16x32_bf16 v[36:39], v[192:195], a[228:231], v[36:39]
s_waitcnt lgkmcnt(7)
ds_read_b64_tr_b16 a[250:251], v241 offset:864
v_add_f32 v251, v251, v213
v_mfma_f32_16x16x32_bf16 v[40:43], v[192:195], a[232:235], v[40:43]
s_add_u32 m0, s4, 3808
ds_read_b64_tr_b16 a[252:253], v241 offset:368
v_cvt_pk_bf16_f32 v230, v212, v213
v_mfma_f32_16x16x32_bf16 v[104:107], v[196:199], a[232:235], v[104:107]
buffer_load_dwordx4 v243, s[8:11], s38 offen offset:3584 nt lds
v_mfma_f32_16x16x32_bf16 v[168:171], v[200:203], a[232:235], v[168:171]
v_exp_f32 v215, v215
v_mfma_f32_16x16x32_bf16 a[168:171], v[204:207], a[232:235], a[168:171]
s_waitcnt lgkmcnt(7)
ds_read_b64_tr_b16 a[254:255], v241 offset:880
v_add_f32 v251, v251, v214
v_mfma_f32_16x16x32_bf16 a[172:175], v[204:207], a[236:239], a[172:175]
v_add_f32 v251, v251, v215
v_cvt_pk_bf16_f32 v231, v214, v215
v_mfma_f32_16x16x32_bf16 v[172:175], v[200:203], a[236:239], v[172:175]
v_fma_f32 v216, v216, s27, -v248
v_fma_f32 v217, v217, s27, -v248
v_mfma_f32_16x16x32_bf16 v[108:111], v[196:199], a[236:239], v[108:111]
v_exp_f32 v216, v216
v_mfma_f32_16x16x32_bf16 v[44:47], v[192:195], a[236:239], v[44:47]
s_waitcnt vmcnt(12) lgkmcnt(0)
v_fma_f32 v218, v218, s27, -v248
v_fma_f32 v219, v219, s27, -v248
v_mfma_f32_16x16x32_bf16 v[48:51], v[192:195], a[240:243], v[48:51]
s_barrier
v_mfma_f32_16x16x32_bf16 v[112:115], v[196:199], a[240:243], v[112:115]
v_exp_f32 v217, v217
v_mfma_f32_16x16x32_bf16 v[176:179], v[200:203], a[240:243], v[176:179]
v_add_f32 v252, v252, v216
v_add_f32 v252, v252, v217
v_mfma_f32_16x16x32_bf16 a[176:179], v[204:207], a[240:243], a[176:179]
v_exp_f32 v218, v218
v_mfma_f32_16x16x32_bf16 a[180:183], v[204:207], a[244:247], a[180:183]
ds_read_b64_tr_b16 a[192:193], v241 offset:16640
v_cvt_pk_bf16_f32 v234, v216, v217
v_mfma_f32_16x16x32_bf16 v[180:183], v[200:203], a[244:247], v[180:183]
v_exp_f32 v219, v219
v_mfma_f32_16x16x32_bf16 v[116:119], v[196:199], a[244:247], v[116:119]
ds_read_b64_tr_b16 a[194:195], v241 offset:17152
v_add_f32 v252, v252, v218
v_mfma_f32_16x16x32_bf16 v[52:55], v[192:195], a[244:247], v[52:55]
ds_read_b64_tr_b16 a[196:197], v241 offset:16656
ds_read_b64_tr_b16 a[198:199], v241 offset:17168
v_mfma_f32_16x16x32_bf16 v[56:59], v[192:195], a[248:251], v[56:59]
ds_read_b64_tr_b16 a[200:201], v241 offset:16672
ds_read_b64_tr_b16 a[202:203], v241 offset:17184
v_mfma_f32_16x16x32_bf16 v[120:123], v[196:199], a[248:251], v[120:123]
ds_read_b64_tr_b16 a[204:205], v241 offset:16688
ds_read_b64_tr_b16 a[206:207], v241 offset:17200
v_mfma_f32_16x16x32_bf16 v[184:187], v[200:203], a[248:251], v[184:187]
v_add_f32 v252, v252, v219
v_cvt_pk_bf16_f32 v235, v218, v219
v_mfma_f32_16x16x32_bf16 a[184:187], v[204:207], a[248:251], a[184:187]
v_fma_f32 v220, v220, s27, -v249
v_fma_f32 v221, v221, s27, -v249
v_mfma_f32_16x16x32_bf16 a[188:191], v[204:207], a[252:255], a[188:191]
v_exp_f32 v220, v220
v_mfma_f32_16x16x32_bf16 v[188:191], v[200:203], a[252:255], v[188:191]
v_fma_f32 v222, v222, s27, -v249
v_fma_f32 v223, v223, s27, -v249
v_mfma_f32_16x16x32_bf16 v[124:127], v[196:199], a[252:255], v[124:127]
v_exp_f32 v221, v221
v_exp_f32 v222, v222
v_exp_f32 v223, v223
v_mfma_f32_16x16x32_bf16 v[60:63], v[192:195], a[252:255], v[60:63]
v_add_f32 v253, v253, v220
v_add_f32 v253, v253, v221
v_cvt_pk_bf16_f32 v238, v220, v221
v_add_f32 v253, v253, v222
v_add_f32 v253, v253, v223
v_cvt_pk_bf16_f32 v239, v222, v223
L_last4:
s_waitcnt lgkmcnt(6)
v_mfma_f32_16x16x32_bf16 v[0:3], v[224:227], a[192:195], v[0:3]
s_mov_b32 s30, s32
ds_read_b128 a[32:35], v255 offset:8448
v_mov_b32 v192, 1.0
v_mfma_f32_16x16x32_bf16 v[64:67], v[228:231], a[192:195], v[64:67]
ds_read_b128 a[36:39], v255 offset:8512
ds_read_b64_tr_b16 a[208:209], v241 offset:16704
v_mfma_f32_16x16x32_bf16 v[128:131], v[232:235], a[192:195], v[128:131]
s_add_u32 m0, s3, 36864
ds_read_b128 a[40:43], v255 offset:8576
ds_read_b64_tr_b16 a[210:211], v241 offset:17216
v_mfma_f32_16x16x4_f32 v[208:211], v250, v192, 0
s_add_u32 s92, s34, 0
buffer_load_dwordx4 v242, s[16:19], s30 offen offset:0 lds
v_mfma_f32_16x16x4_f32 v[212:215], v251, v192, 0
s_add_u32 s93, s34, 4096
ds_read_b128 a[44:47], v255 offset:8640
ds_read_b128 a[48:51], v255 offset:8704
v_mfma_f32_16x16x4_f32 v[216:219], v252, v192, 0
s_add_u32 s94, s34, 8192
ds_read_b128 a[52:55], v255 offset:8768
ds_read_b64_tr_b16 a[212:213], v241 offset:16720
v_mfma_f32_16x16x4_f32 v[220:223], v253, v192, 0
s_add_u32 s95, s34, 12288
ds_read_b128 a[56:59], v255 offset:8832
ds_read_b64_tr_b16 a[214:215], v241 offset:17232
v_mfma_f32_16x16x32_bf16 a[128:131], v[236:239], a[192:195], a[128:131]
s_waitcnt lgkmcnt(15)
ds_read_b128 a[60:63], v255 offset:8896
ds_read_b64_tr_b16 a[216:217], v241 offset:16736
v_mfma_f32_16x16x32_bf16 a[132:135], v[236:239], a[196:199], a[132:135]
s_add_u32 s96, s34, 16384
v_mfma_f32_16x16x32_bf16 v[132:135], v[232:235], a[196:199], v[132:135]
s_add_u32 m0, s3, 36880
ds_read_b64_tr_b16 a[218:219], v241 offset:17248
v_mfma_f32_16x16x32_bf16 v[68:71], v[228:231], a[196:199], v[68:71]
s_add_u32 s97, s34, 20480
buffer_load_dwordx4 v242, s[16:19], s30 offen offset:1024 lds
v_mfma_f32_16x16x32_bf16 v[4:7], v[224:227], a[196:199], v[4:7]
s_waitcnt lgkmcnt(15)
v_max3_f32 v193, v208, v209, v210
v_max_f32 v193, v193, v211
v_mfma_f32_16x16x32_bf16 v[8:11], v[224:227], a[200:203], v[8:11]
s_add_u32 s98, s34, 24576
v_rcp_f32 v208, v208
v_mfma_f32_16x16x32_bf16 v[72:75], v[228:231], a[200:203], v[72:75]
s_add_u32 s99, s34, 28672
v_rcp_f32 v209, v209
v_mfma_f32_16x16x32_bf16 v[136:139], v[232:235], a[200:203], v[136:139]
v_rcp_f32 v210, v210
v_mfma_f32_16x16x32_bf16 a[136:139], v[236:239], a[200:203], a[136:139]
s_waitcnt lgkmcnt(14)
v_rcp_f32 v211, v211
v_mfma_f32_16x16x32_bf16 a[140:143], v[236:239], a[204:207], a[140:143]
v_max3_f32 v193, v193, v212, v213
v_max3_f32 v193, v193, v214, v215
v_mfma_f32_16x16x32_bf16 v[140:143], v[232:235], a[204:207], v[140:143]
s_add_u32 m0, s3, 36896
v_rcp_f32 v212, v212
v_mfma_f32_16x16x32_bf16 v[76:79], v[228:231], a[204:207], v[76:79]
buffer_load_dwordx4 v242, s[16:19], s30 offen offset:2048 lds
v_mfma_f32_16x16x32_bf16 v[12:15], v[224:227], a[204:207], v[12:15]
s_waitcnt lgkmcnt(9)
v_rcp_f32 v213, v213
v_mfma_f32_16x16x32_bf16 v[16:19], v[224:227], a[208:211], v[16:19]
v_rcp_f32 v214, v214
v_mfma_f32_16x16x32_bf16 v[80:83], v[228:231], a[208:211], v[80:83]
v_rcp_f32 v215, v215
v_mfma_f32_16x16x32_bf16 v[144:147], v[232:235], a[208:211], v[144:147]
v_max3_f32 v193, v193, v216, v217
v_max3_f32 v193, v193, v218, v219
v_mfma_f32_16x16x32_bf16 a[144:147], v[236:239], a[208:211], a[144:147]
s_waitcnt lgkmcnt(3)
v_rcp_f32 v216, v216
v_mfma_f32_16x16x32_bf16 a[148:151], v[236:239], a[212:215], a[148:151]
v_rcp_f32 v217, v217
v_mfma_f32_16x16x32_bf16 v[148:151], v[232:235], a[212:215], v[148:151]
s_add_u32 m0, s3, 36912
v_rcp_f32 v218, v218
v_mfma_f32_16x16x32_bf16 v[84:87], v[228:231], a[212:215], v[84:87]
buffer_load_dwordx4 v242, s[16:19], s30 offen offset:3072 lds
v_mfma_f32_16x16x32_bf16 v[20:23], v[224:227], a[212:215], v[20:23]
s_waitcnt lgkmcnt(0)
v_rcp_f32 v219, v219
v_mfma_f32_16x16x32_bf16 v[24:27], v[224:227], a[216:219], v[24:27]
s_add_u32 s30, s30, 16384
v_max3_f32 v193, v193, v220, v221
v_max3_f32 v193, v193, v222, v223
v_mfma_f32_16x16x32_bf16 v[88:91], v[228:231], a[216:219], v[88:91]
ds_read_b64_tr_b16 a[220:221], v241 offset:16752
ds_read_b64_tr_b16 a[222:223], v241 offset:17264
v_mfma_f32_16x16x32_bf16 v[152:155], v[232:235], a[216:219], v[152:155]
v_rcp_f32 v220, v220
v_mfma_f32_16x16x32_bf16 a[152:155], v[236:239], a[216:219], a[152:155]
s_waitcnt lgkmcnt(0)
v_rcp_f32 v221, v221
v_mfma_f32_16x16x32_bf16 a[156:159], v[236:239], a[220:223], a[156:159]
v_rcp_f32 v222, v222
v_mfma_f32_16x16x32_bf16 v[156:159], v[232:235], a[220:223], v[156:159]
ds_read_b64_tr_b16 a[224:225], v241 offset:16896
ds_read_b64_tr_b16 a[226:227], v241 offset:17408
v_mfma_f32_16x16x32_bf16 v[92:95], v[228:231], a[220:223], v[92:95]
v_rcp_f32 v223, v223
v_mfma_f32_16x16x32_bf16 v[28:31], v[224:227], a[220:223], v[28:31]
s_waitcnt lgkmcnt(0)
ds_read_b64_tr_b16 a[228:229], v241 offset:16912
v_cmp_nge_f32 s[42:43], s28, v193
v_mfma_f32_16x16x32_bf16 v[32:35], v[224:227], a[224:227], v[32:35]
ds_read_b64_tr_b16 a[230:231], v241 offset:17424
ds_read_b64_tr_b16 a[232:233], v241 offset:16928
v_mfma_f32_16x16x32_bf16 v[96:99], v[228:231], a[224:227], v[96:99]
ds_read_b64_tr_b16 a[234:235], v241 offset:17440
ds_read_b64_tr_b16 a[236:237], v241 offset:16944
v_mfma_f32_16x16x32_bf16 v[160:163], v[232:235], a[224:227], v[160:163]
ds_read_b64_tr_b16 a[238:239], v241 offset:17456
ds_read_b64_tr_b16 a[240:241], v241 offset:16960
v_mfma_f32_16x16x32_bf16 a[160:163], v[236:239], a[224:227], a[160:163]
s_waitcnt lgkmcnt(5)
ds_read_b64_tr_b16 a[242:243], v241 offset:17472
v_mul_f32 v0, v0, v208
v_mfma_f32_16x16x32_bf16 a[164:167], v[236:239], a[228:231], a[164:167]
v_mul_f32 v1, v1, v209
v_mul_f32 v2, v2, v210
v_mfma_f32_16x16x32_bf16 v[164:167], v[232:235], a[228:231], v[164:167]
v_mul_f32 v3, v3, v211
v_mul_f32 v4, v4, v208
v_mfma_f32_16x16x32_bf16 v[100:103], v[228:231], a[228:231], v[100:103]
v_mul_f32 v5, v5, v209
v_mul_f32 v6, v6, v210
v_mfma_f32_16x16x32_bf16 v[36:39], v[224:227], a[228:231], v[36:39]
s_waitcnt lgkmcnt(4)
v_mul_f32 v7, v7, v211
v_mul_f32 v8, v8, v208
v_mfma_f32_16x16x32_bf16 v[40:43], v[224:227], a[232:235], v[40:43]
v_mul_f32 v9, v9, v209
v_mul_f32 v10, v10, v210
v_mfma_f32_16x16x32_bf16 v[104:107], v[228:231], a[232:235], v[104:107]
v_mul_f32 v11, v11, v211
v_mul_f32 v12, v12, v208
v_mfma_f32_16x16x32_bf16 v[168:171], v[232:235], a[232:235], v[168:171]
v_mul_f32 v13, v13, v209
v_mul_f32 v14, v14, v210
v_mfma_f32_16x16x32_bf16 a[168:171], v[236:239], a[232:235], a[168:171]
s_waitcnt lgkmcnt(2)
v_mul_f32 v15, v15, v211
v_cvt_pk_bf16_f32 v0, v0, v4
v_mfma_f32_16x16x32_bf16 a[172:175], v[236:239], a[236:239], a[172:175]
v_cvt_pk_bf16_f32 v4, v2, v6
v_cvt_pk_bf16_f32 v2, v1, v5
v_mfma_f32_16x16x32_bf16 v[172:175], v[232:235], a[236:239], v[172:175]
v_cvt_pk_bf16_f32 v6, v3, v7
v_cvt_pk_bf16_f32 v1, v8, v12
v_mfma_f32_16x16x32_bf16 v[108:111], v[228:231], a[236:239], v[108:111]
v_cvt_pk_bf16_f32 v3, v9, v13
v_cvt_pk_bf16_f32 v5, v10, v14
v_mfma_f32_16x16x32_bf16 v[44:47], v[224:227], a[236:239], v[44:47]
s_waitcnt lgkmcnt(0)
ds_read_b64_tr_b16 a[244:245], v241 offset:16976
v_cvt_pk_bf16_f32 v7, v11, v15
v_mfma_f32_16x16x32_bf16 v[48:51], v[224:227], a[240:243], v[48:51]
ds_read_b64_tr_b16 a[246:247], v241 offset:17488
ds_read_b64_tr_b16 a[248:249], v241 offset:16992
v_mfma_f32_16x16x32_bf16 v[112:115], v[228:231], a[240:243], v[112:115]
ds_read_b64_tr_b16 a[250:251], v241 offset:17504
ds_read_b64_tr_b16 a[252:253], v241 offset:17008
v_mfma_f32_16x16x32_bf16 v[176:179], v[232:235], a[240:243], v[176:179]
ds_read_b64_tr_b16 a[254:255], v241 offset:17520
v_mfma_f32_16x16x32_bf16 a[176:179], v[236:239], a[240:243], a[176:179]
s_waitcnt lgkmcnt(4)
v_mfma_f32_16x16x32_bf16 a[180:183], v[236:239], a[244:247], a[180:183]
v_mfma_f32_16x16x32_bf16 v[180:183], v[232:235], a[244:247], v[180:183]
v_mfma_f32_16x16x32_bf16 v[116:119], v[228:231], a[244:247], v[116:119]
v_mfma_f32_16x16x32_bf16 v[52:55], v[224:227], a[244:247], v[52:55]
s_waitcnt lgkmcnt(2)
v_mfma_f32_16x16x32_bf16 v[56:59], v[224:227], a[248:251], v[56:59]
v_mfma_f32_16x16x32_bf16 v[120:123], v[228:231], a[248:251], v[120:123]
v_mfma_f32_16x16x32_bf16 v[184:187], v[232:235], a[248:251], v[184:187]
v_mfma_f32_16x16x32_bf16 a[184:187], v[236:239], a[248:251], a[184:187]
s_waitcnt lgkmcnt(0)
v_mfma_f32_16x16x32_bf16 a[188:191], v[236:239], a[252:255], a[188:191]
v_mfma_f32_16x16x32_bf16 v[188:191], v[232:235], a[252:255], v[188:191]
v_mfma_f32_16x16x32_bf16 v[124:127], v[228:231], a[252:255], v[124:127]
v_mfma_f32_16x16x32_bf16 v[60:63], v[224:227], a[252:255], v[60:63]
s_cmp_ge_u32 s24, 4
s_cbranch_scc1 L_fin4
ds_write_b64 v245, v[0:1] offset:0
ds_write_b64 v245, v[2:3] offset:288
v_pk_mul_f32 v[16:17], v[16:17], v[208:209]
v_pk_mul_f32 v[18:19], v[18:19], v[210:211]
v_pk_mul_f32 v[20:21], v[20:21], v[208:209]
v_pk_mul_f32 v[22:23], v[22:23], v[210:211]
ds_write_b64 v245, v[4:5] offset:576
v_pk_mul_f32 v[24:25], v[24:25], v[208:209]
v_pk_mul_f32 v[26:27], v[26:27], v[210:211]
v_pk_mul_f32 v[28:29], v[28:29], v[208:209]
v_pk_mul_f32 v[30:31], v[30:31], v[210:211]
ds_write_b64 v245, v[6:7] offset:864
v_cvt_pk_bf16_f32 v16, v16, v20
v_cvt_pk_bf16_f32 v20, v18, v22
v_cvt_pk_bf16_f32 v18, v17, v21
v_cvt_pk_bf16_f32 v22, v19, v23
v_cvt_pk_bf16_f32 v17, v24, v28
v_cvt_pk_bf16_f32 v19, v25, v29
v_cvt_pk_bf16_f32 v21, v26, v30
v_cvt_pk_bf16_f32 v23, v27, v31
ds_write_b64 v245, v[16:17] offset:128
v_pk_mul_f32 v[64:65], v[64:65], v[212:213]
v_pk_mul_f32 v[66:67], v[66:67], v[214:215]
ds_write_b64 v245, v[18:19] offset:416
v_pk_mul_f32 v[68:69], v[68:69], v[212:213]
v_pk_mul_f32 v[70:71], v[70:71], v[214:215]
v_pk_mul_f32 v[72:73], v[72:73], v[212:213]
v_pk_mul_f32 v[74:75], v[74:75], v[214:215]
v_pk_mul_f32 v[76:77], v[76:77], v[212:213]
ds_write_b64 v245, v[20:21] offset:704
v_pk_mul_f32 v[78:79], v[78:79], v[214:215]
v_cvt_pk_bf16_f32 v64, v64, v68
v_cvt_pk_bf16_f32 v68, v66, v70
v_cvt_pk_bf16_f32 v66, v65, v69
ds_write_b64 v245, v[22:23] offset:992
v_cvt_pk_bf16_f32 v70, v67, v71
v_cvt_pk_bf16_f32 v65, v72, v76
v_cvt_pk_bf16_f32 v67, v73, v77
v_cvt_pk_bf16_f32 v69, v74, v78
v_cvt_pk_bf16_f32 v71, v75, v79
ds_read_b64_tr_b16 v[0:1], v254 offset:0
ds_read_b64_tr_b16 v[2:3], v254 offset:32
ds_read_b64_tr_b16 v[4:5], v254 offset:1152
v_pk_mul_f32 v[80:81], v[80:81], v[212:213]
ds_read_b64_tr_b16 v[6:7], v254 offset:1184
ds_read_b64_tr_b16 v[8:9], v254 offset:2304
ds_read_b64_tr_b16 v[10:11], v254 offset:2336
v_pk_mul_f32 v[82:83], v[82:83], v[214:215]
ds_read_b64_tr_b16 v[12:13], v254 offset:3456
ds_read_b64_tr_b16 v[14:15], v254 offset:3488
ds_write_b64 v245, v[64:65] offset:0
v_pk_mul_f32 v[84:85], v[84:85], v[212:213]
v_pk_mul_f32 v[86:87], v[86:87], v[214:215]
v_pk_mul_f32 v[88:89], v[88:89], v[212:213]
v_pk_mul_f32 v[90:91], v[90:91], v[214:215]
v_pk_mul_f32 v[92:93], v[92:93], v[212:213]
v_pk_mul_f32 v[94:95], v[94:95], v[214:215]
ds_write_b64 v245, v[66:67] offset:288
s_waitcnt lgkmcnt(8)
buffer_store_dwordx4 v[0:3], v244, s[20:23], s92 offen offset:0
v_cvt_pk_bf16_f32 v80, v80, v84
v_cvt_pk_bf16_f32 v84, v82, v86
ds_write_b64 v245, v[68:69] offset:576
v_cvt_pk_bf16_f32 v82, v81, v85
v_cvt_pk_bf16_f32 v86, v83, v87
v_cvt_pk_bf16_f32 v81, v88, v92
s_waitcnt lgkmcnt(7)
buffer_store_dwordx4 v[4:7], v244, s[20:23], s92 offen offset:2048
ds_write_b64 v245, v[70:71] offset:864
v_cvt_pk_bf16_f32 v83, v89, v93
v_cvt_pk_bf16_f32 v85, v90, v94
v_cvt_pk_bf16_f32 v87, v91, v95
v_pk_mul_f32 v[128:129], v[128:129], v[216:217]
ds_write_b64 v245, v[80:81] offset:128
s_waitcnt lgkmcnt(7)
buffer_store_dwordx4 v[8:11], v244, s[20:23], s93 offen offset:0
v_pk_mul_f32 v[130:131], v[130:131], v[218:219]
v_pk_mul_f32 v[132:133], v[132:133], v[216:217]
v_pk_mul_f32 v[134:135], v[134:135], v[218:219]
ds_write_b64 v245, v[82:83] offset:416
v_pk_mul_f32 v[136:137], v[136:137], v[216:217]
v_pk_mul_f32 v[138:139], v[138:139], v[218:219]
v_pk_mul_f32 v[140:141], v[140:141], v[216:217]
v_pk_mul_f32 v[142:143], v[142:143], v[218:219]
s_waitcnt lgkmcnt(6)
buffer_store_dwordx4 v[12:15], v244, s[20:23], s93 offen offset:2048
ds_write_b64 v245, v[84:85] offset:704
v_cvt_pk_bf16_f32 v128, v128, v132
v_cvt_pk_bf16_f32 v132, v130, v134
v_cvt_pk_bf16_f32 v130, v129, v133
ds_write_b64 v245, v[86:87] offset:992
v_cvt_pk_bf16_f32 v134, v131, v135
v_cvt_pk_bf16_f32 v129, v136, v140
v_cvt_pk_bf16_f32 v131, v137, v141
v_cvt_pk_bf16_f32 v133, v138, v142
v_cvt_pk_bf16_f32 v135, v139, v143
ds_read_b64_tr_b16 v[64:65], v254 offset:0
ds_read_b64_tr_b16 v[66:67], v254 offset:32
ds_read_b64_tr_b16 v[68:69], v254 offset:1152
v_pk_mul_f32 v[144:145], v[144:145], v[216:217]
ds_read_b64_tr_b16 v[70:71], v254 offset:1184
ds_read_b64_tr_b16 v[72:73], v254 offset:2304
ds_read_b64_tr_b16 v[74:75], v254 offset:2336
ds_read_b64_tr_b16 v[76:77], v254 offset:3456
v_pk_mul_f32 v[146:147], v[146:147], v[218:219]
ds_read_b64_tr_b16 v[78:79], v254 offset:3488
ds_write_b64 v245, v[128:129] offset:0
v_pk_mul_f32 v[148:149], v[148:149], v[216:217]
v_pk_mul_f32 v[150:151], v[150:151], v[218:219]
v_pk_mul_f32 v[152:153], v[152:153], v[216:217]
v_pk_mul_f32 v[154:155], v[154:155], v[218:219]
v_pk_mul_f32 v[156:157], v[156:157], v[216:217]
ds_write_b64 v245, v[130:131] offset:288
s_waitcnt lgkmcnt(8)
buffer_store_dwordx4 v[64:67], v244, s[20:23], s94 offen offset:0
v_pk_mul_f32 v[158:159], v[158:159], v[218:219]
v_cvt_pk_bf16_f32 v144, v144, v148
v_cvt_pk_bf16_f32 v148, v146, v150
ds_write_b64 v245, v[132:133] offset:576
v_cvt_pk_bf16_f32 v146, v145, v149
v_cvt_pk_bf16_f32 v150, v147, v151
s_waitcnt lgkmcnt(7)
buffer_store_dwordx4 v[68:71], v244, s[20:23], s94 offen offset:2048
ds_write_b64 v245, v[134:135] offset:864
v_cvt_pk_bf16_f32 v145, v152, v156
v_cvt_pk_bf16_f32 v147, v153, v157
v_cvt_pk_bf16_f32 v149, v154, v158
v_cvt_pk_bf16_f32 v151, v155, v159
v_accvgpr_read_b32 v192, a128
ds_write_b64 v245, v[144:145] offset:128
s_waitcnt lgkmcnt(7)
buffer_store_dwordx4 v[72:75], v244, s[20:23], s95 offen offset:0
v_accvgpr_read_b32 v193, a129
v_accvgpr_read_b32 v194, a130
v_accvgpr_read_b32 v195, a131
ds_write_b64 v245, v[146:147] offset:416
v_accvgpr_read_b32 v196, a132
v_accvgpr_read_b32 v197, a133
v_accvgpr_read_b32 v198, a134
s_waitcnt lgkmcnt(6)
buffer_store_dwordx4 v[76:79], v244, s[20:23], s95 offen offset:2048
ds_write_b64 v245, v[148:149] offset:704
v_accvgpr_read_b32 v199, a135
v_accvgpr_read_b32 v200, a136
v_accvgpr_read_b32 v201, a137
v_accvgpr_read_b32 v202, a138
ds_write_b64 v245, v[150:151] offset:992
v_accvgpr_read_b32 v203, a139
v_accvgpr_read_b32 v204, a140
v_accvgpr_read_b32 v205, a141
v_accvgpr_read_b32 v206, a142
v_accvgpr_read_b32 v207, a143
ds_read_b64_tr_b16 v[128:129], v254 offset:0
ds_read_b64_tr_b16 v[130:131], v254 offset:32
ds_read_b64_tr_b16 v[132:133], v254 offset:1152
ds_read_b64_tr_b16 v[134:135], v254 offset:1184
v_pk_mul_f32 v[192:193], v[192:193], v[220:221]
ds_read_b64_tr_b16 v[136:137], v254 offset:2304
ds_read_b64_tr_b16 v[138:139], v254 offset:2336
ds_read_b64_tr_b16 v[140:141], v254 offset:3456
v_pk_mul_f32 v[194:195], v[194:195], v[222:223]
ds_read_b64_tr_b16 v[142:143], v254 offset:3488
v_pk_mul_f32 v[196:197], v[196:197], v[220:221]
v_pk_mul_f32 v[198:199], v[198:199], v[222:223]
v_pk_mul_f32 v[200:201], v[200:201], v[220:221]
v_pk_mul_f32 v[202:203], v[202:203], v[222:223]
v_pk_mul_f32 v[204:205], v[204:205], v[220:221]
v_pk_mul_f32 v[206:207], v[206:207], v[222:223]
v_cvt_pk_bf16_f32 v192, v192, v196
v_cvt_pk_bf16_f32 v196, v194, v198
v_cvt_pk_bf16_f32 v194, v193, v197
v_cvt_pk_bf16_f32 v198, v195, v199
s_waitcnt lgkmcnt(6)
buffer_store_dwordx4 v[128:131], v244, s[20:23], s96 offen offset:0
v_cvt_pk_bf16_f32 v193, v200, v204
v_cvt_pk_bf16_f32 v195, v201, v205
v_cvt_pk_bf16_f32 v197, v202, v206
v_cvt_pk_bf16_f32 v199, v203, v207
ds_write_b64 v245, v[192:193] offset:0
ds_write_b64 v245, v[194:195] offset:288
s_waitcnt lgkmcnt(6)
buffer_store_dwordx4 v[132:135], v244, s[20:23], s96 offen offset:2048
ds_write_b64 v245, v[196:197] offset:576
v_accvgpr_read_b32 v224, a144
v_accvgpr_read_b32 v225, a145
v_accvgpr_read_b32 v226, a146
v_accvgpr_read_b32 v227, a147
v_accvgpr_read_b32 v228, a148
v_accvgpr_read_b32 v229, a149
ds_write_b64 v245, v[198:199] offset:864
s_waitcnt lgkmcnt(6)
buffer_store_dwordx4 v[136:139], v244, s[20:23], s97 offen offset:0
v_accvgpr_read_b32 v230, a150
v_accvgpr_read_b32 v231, a151
v_accvgpr_read_b32 v232, a152
v_accvgpr_read_b32 v233, a153
v_accvgpr_read_b32 v234, a154
v_accvgpr_read_b32 v235, a155
v_accvgpr_read_b32 v236, a156
v_accvgpr_read_b32 v237, a157
v_accvgpr_read_b32 v238, a158
s_waitcnt lgkmcnt(4)
buffer_store_dwordx4 v[140:143], v244, s[20:23], s97 offen offset:2048
v_accvgpr_read_b32 v239, a159
v_pk_mul_f32 v[224:225], v[224:225], v[220:221]
v_pk_mul_f32 v[226:227], v[226:227], v[222:223]
v_pk_mul_f32 v[228:229], v[228:229], v[220:221]
v_pk_mul_f32 v[230:231], v[230:231], v[222:223]
v_pk_mul_f32 v[232:233], v[232:233], v[220:221]
v_pk_mul_f32 v[234:235], v[234:235], v[222:223]
v_pk_mul_f32 v[236:237], v[236:237], v[220:221]
v_pk_mul_f32 v[238:239], v[238:239], v[222:223]
v_cvt_pk_bf16_f32 v224, v224, v228
v_cvt_pk_bf16_f32 v228, v226, v230
v_cvt_pk_bf16_f32 v226, v225, v229
v_cvt_pk_bf16_f32 v230, v227, v231
v_cvt_pk_bf16_f32 v225, v232, v236
v_cvt_pk_bf16_f32 v227, v233, v237
v_cvt_pk_bf16_f32 v229, v234, v238
v_cvt_pk_bf16_f32 v231, v235, v239
ds_write_b64 v245, v[224:225] offset:128
ds_write_b64 v245, v[226:227] offset:416
v_pk_mul_f32 v[32:33], v[32:33], v[208:209]
v_pk_mul_f32 v[34:35], v[34:35], v[210:211]
ds_write_b64 v245, v[228:229] offset:704
v_pk_mul_f32 v[36:37], v[36:37], v[208:209]
v_pk_mul_f32 v[38:39], v[38:39], v[210:211]
v_pk_mul_f32 v[40:41], v[40:41], v[208:209]
v_pk_mul_f32 v[42:43], v[42:43], v[210:211]
v_pk_mul_f32 v[44:45], v[44:45], v[208:209]
ds_write_b64 v245, v[230:231] offset:992
v_pk_mul_f32 v[46:47], v[46:47], v[210:211]
v_cvt_pk_bf16_f32 v32, v32, v36
v_cvt_pk_bf16_f32 v36, v34, v38
v_cvt_pk_bf16_f32 v34, v33, v37
v_cvt_pk_bf16_f32 v38, v35, v39
ds_read_b64_tr_b16 a[128:129], v254 offset:0
ds_read_b64_tr_b16 a[130:131], v254 offset:32
ds_read_b64_tr_b16 a[132:133], v254 offset:1152
ds_read_b64_tr_b16 a[134:135], v254 offset:1184
v_cvt_pk_bf16_f32 v33, v40, v44
ds_read_b64_tr_b16 a[136:137], v254 offset:2304
ds_read_b64_tr_b16 a[138:139], v254 offset:2336
ds_read_b64_tr_b16 a[140:141], v254 offset:3456
v_cvt_pk_bf16_f32 v35, v41, v45
ds_read_b64_tr_b16 a[142:143], v254 offset:3488
ds_write_b64 v245, v[32:33] offset:0
v_cvt_pk_bf16_f32 v37, v42, v46
v_cvt_pk_bf16_f32 v39, v43, v47
v_pk_mul_f32 v[48:49], v[48:49], v[208:209]
v_pk_mul_f32 v[50:51], v[50:51], v[210:211]
v_pk_mul_f32 v[52:53], v[52:53], v[208:209]
ds_write_b64 v245, v[34:35] offset:288
s_waitcnt lgkmcnt(8)
buffer_store_dwordx4 a[128:131], v244, s[20:23], s98 offen offset:0
v_pk_mul_f32 v[54:55], v[54:55], v[210:211]
v_pk_mul_f32 v[56:57], v[56:57], v[208:209]
v_pk_mul_f32 v[58:59], v[58:59], v[210:211]
ds_write_b64 v245, v[36:37] offset:576
v_pk_mul_f32 v[60:61], v[60:61], v[208:209]
v_pk_mul_f32 v[62:63], v[62:63], v[210:211]
s_waitcnt lgkmcnt(7)
buffer_store_dwordx4 a[132:135], v244, s[20:23], s98 offen offset:2048
ds_write_b64 v245, v[38:39] offset:864
v_cvt_pk_bf16_f32 v48, v48, v52
v_cvt_pk_bf16_f32 v52, v50, v54
v_cvt_pk_bf16_f32 v50, v49, v53
v_cvt_pk_bf16_f32 v54, v51, v55
v_cvt_pk_bf16_f32 v49, v56, v60
v_cvt_pk_bf16_f32 v51, v57, v61
v_cvt_pk_bf16_f32 v53, v58, v62
v_cvt_pk_bf16_f32 v55, v59, v63
ds_write_b64 v245, v[48:49] offset:128
s_waitcnt lgkmcnt(7)
buffer_store_dwordx4 a[136:139], v244, s[20:23], s99 offen offset:0
ds_write_b64 v245, v[50:51] offset:416
v_pk_mul_f32 v[96:97], v[96:97], v[212:213]
v_pk_mul_f32 v[98:99], v[98:99], v[214:215]
v_pk_mul_f32 v[100:101], v[100:101], v[212:213]
v_pk_mul_f32 v[102:103], v[102:103], v[214:215]
v_pk_mul_f32 v[104:105], v[104:105], v[212:213]
v_pk_mul_f32 v[106:107], v[106:107], v[214:215]
ds_write_b64 v245, v[52:53] offset:704
s_waitcnt lgkmcnt(7)
buffer_store_dwordx4 a[140:143], v244, s[20:23], s99 offen offset:2048
v_pk_mul_f32 v[108:109], v[108:109], v[212:213]
v_pk_mul_f32 v[110:111], v[110:111], v[214:215]
ds_write_b64 v245, v[54:55] offset:992
v_cvt_pk_bf16_f32 v96, v96, v100
v_cvt_pk_bf16_f32 v100, v98, v102
v_cvt_pk_bf16_f32 v98, v97, v101
v_cvt_pk_bf16_f32 v102, v99, v103
v_cvt_pk_bf16_f32 v97, v104, v108
ds_read_b64_tr_b16 v[32:33], v254 offset:0
ds_read_b64_tr_b16 v[34:35], v254 offset:32
ds_read_b64_tr_b16 v[36:37], v254 offset:1152
v_cvt_pk_bf16_f32 v99, v105, v109
ds_read_b64_tr_b16 v[38:39], v254 offset:1184
ds_read_b64_tr_b16 v[40:41], v254 offset:2304
ds_read_b64_tr_b16 v[42:43], v254 offset:2336
ds_read_b64_tr_b16 v[44:45], v254 offset:3456
v_cvt_pk_bf16_f32 v101, v106, v110
ds_read_b64_tr_b16 v[46:47], v254 offset:3488
ds_write_b64 v245, v[96:97] offset:0
v_cvt_pk_bf16_f32 v103, v107, v111
v_pk_mul_f32 v[112:113], v[112:113], v[212:213]
v_pk_mul_f32 v[114:115], v[114:115], v[214:215]
v_pk_mul_f32 v[116:117], v[116:117], v[212:213]
v_pk_mul_f32 v[118:119], v[118:119], v[214:215]
ds_write_b64 v245, v[98:99] offset:288
s_waitcnt lgkmcnt(8)
buffer_store_dwordx4 v[32:35], v244, s[20:23], s92 offen offset:256
v_pk_mul_f32 v[120:121], v[120:121], v[212:213]
v_pk_mul_f32 v[122:123], v[122:123], v[214:215]
v_pk_mul_f32 v[124:125], v[124:125], v[212:213]
ds_write_b64 v245, v[100:101] offset:576
v_pk_mul_f32 v[126:127], v[126:127], v[214:215]
v_cvt_pk_bf16_f32 v112, v112, v116
s_waitcnt lgkmcnt(7)
buffer_store_dwordx4 v[36:39], v244, s[20:23], s92 offen offset:2304
ds_write_b64 v245, v[102:103] offset:864
v_cvt_pk_bf16_f32 v116, v114, v118
v_cvt_pk_bf16_f32 v114, v113, v117
v_cvt_pk_bf16_f32 v118, v115, v119
v_cvt_pk_bf16_f32 v113, v120, v124
v_cvt_pk_bf16_f32 v115, v121, v125
v_cvt_pk_bf16_f32 v117, v122, v126
v_cvt_pk_bf16_f32 v119, v123, v127
ds_write_b64 v245, v[112:113] offset:128
s_waitcnt lgkmcnt(7)
buffer_store_dwordx4 v[40:43], v244, s[20:23], s93 offen offset:256
v_pk_mul_f32 v[160:161], v[160:161], v[216:217]
ds_write_b64 v245, v[114:115] offset:416
v_pk_mul_f32 v[162:163], v[162:163], v[218:219]
v_pk_mul_f32 v[164:165], v[164:165], v[216:217]
v_pk_mul_f32 v[166:167], v[166:167], v[218:219]
v_pk_mul_f32 v[168:169], v[168:169], v[216:217]
ds_write_b64 v245, v[116:117] offset:704
s_waitcnt lgkmcnt(7)
buffer_store_dwordx4 v[44:47], v244, s[20:23], s93 offen offset:2304
v_pk_mul_f32 v[170:171], v[170:171], v[218:219]
v_pk_mul_f32 v[172:173], v[172:173], v[216:217]
v_pk_mul_f32 v[174:175], v[174:175], v[218:219]
ds_write_b64 v245, v[118:119] offset:992
v_cvt_pk_bf16_f32 v160, v160, v164
v_cvt_pk_bf16_f32 v164, v162, v166
v_cvt_pk_bf16_f32 v162, v161, v165
v_cvt_pk_bf16_f32 v166, v163, v167
v_cvt_pk_bf16_f32 v161, v168, v172
ds_read_b64_tr_b16 v[96:97], v254 offset:0
ds_read_b64_tr_b16 v[98:99], v254 offset:32
ds_read_b64_tr_b16 v[100:101], v254 offset:1152
ds_read_b64_tr_b16 v[102:103], v254 offset:1184
v_cvt_pk_bf16_f32 v163, v169, v173
ds_read_b64_tr_b16 v[104:105], v254 offset:2304
ds_read_b64_tr_b16 v[106:107], v254 offset:2336
ds_read_b64_tr_b16 v[108:109], v254 offset:3456
v_cvt_pk_bf16_f32 v165, v170, v174
ds_read_b64_tr_b16 v[110:111], v254 offset:3488
ds_write_b64 v245, v[160:161] offset:0
v_cvt_pk_bf16_f32 v167, v171, v175
v_pk_mul_f32 v[176:177], v[176:177], v[216:217]
v_pk_mul_f32 v[178:179], v[178:179], v[218:219]
v_pk_mul_f32 v[180:181], v[180:181], v[216:217]
v_pk_mul_f32 v[182:183], v[182:183], v[218:219]
ds_write_b64 v245, v[162:163] offset:288
s_waitcnt lgkmcnt(8)
buffer_store_dwordx4 v[96:99], v244, s[20:23], s94 offen offset:256
v_pk_mul_f32 v[184:185], v[184:185], v[216:217]
v_pk_mul_f32 v[186:187], v[186:187], v[218:219]
v_pk_mul_f32 v[188:189], v[188:189], v[216:217]
ds_write_b64 v245, v[164:165] offset:576
v_pk_mul_f32 v[190:191], v[190:191], v[218:219]
v_cvt_pk_bf16_f32 v176, v176, v180
s_waitcnt lgkmcnt(7)
buffer_store_dwordx4 v[100:103], v244, s[20:23], s94 offen offset:2304
ds_write_b64 v245, v[166:167] offset:864
v_cvt_pk_bf16_f32 v180, v178, v182
v_cvt_pk_bf16_f32 v178, v177, v181
v_cvt_pk_bf16_f32 v182, v179, v183
v_cvt_pk_bf16_f32 v177, v184, v188
v_cvt_pk_bf16_f32 v179, v185, v189
v_cvt_pk_bf16_f32 v181, v186, v190
v_cvt_pk_bf16_f32 v183, v187, v191
ds_write_b64 v245, v[176:177] offset:128
s_waitcnt lgkmcnt(7)
buffer_store_dwordx4 v[104:107], v244, s[20:23], s95 offen offset:256
ds_write_b64 v245, v[178:179] offset:416
v_accvgpr_read_b32 v192, a160
v_accvgpr_read_b32 v193, a161
v_accvgpr_read_b32 v194, a162
v_accvgpr_read_b32 v195, a163
v_accvgpr_read_b32 v196, a164
v_accvgpr_read_b32 v197, a165
s_waitcnt lgkmcnt(6)
buffer_store_dwordx4 v[108:111], v244, s[20:23], s95 offen offset:2304
ds_write_b64 v245, v[180:181] offset:704
v_accvgpr_read_b32 v198, a166
v_accvgpr_read_b32 v199, a167
v_accvgpr_read_b32 v200, a168
ds_write_b64 v245, v[182:183] offset:992
v_accvgpr_read_b32 v201, a169
v_accvgpr_read_b32 v202, a170
v_accvgpr_read_b32 v203, a171
v_accvgpr_read_b32 v204, a172
v_accvgpr_read_b32 v205, a173
ds_read_b64_tr_b16 v[160:161], v254 offset:0
ds_read_b64_tr_b16 v[162:163], v254 offset:32
ds_read_b64_tr_b16 v[164:165], v254 offset:1152
ds_read_b64_tr_b16 v[166:167], v254 offset:1184
v_accvgpr_read_b32 v206, a174
ds_read_b64_tr_b16 v[168:169], v254 offset:2304
ds_read_b64_tr_b16 v[170:171], v254 offset:2336
ds_read_b64_tr_b16 v[172:173], v254 offset:3456
v_accvgpr_read_b32 v207, a175
ds_read_b64_tr_b16 v[174:175], v254 offset:3488
v_pk_mul_f32 v[192:193], v[192:193], v[220:221]
v_pk_mul_f32 v[194:195], v[194:195], v[222:223]
v_pk_mul_f32 v[196:197], v[196:197], v[220:221]
v_pk_mul_f32 v[198:199], v[198:199], v[222:223]
v_pk_mul_f32 v[200:201], v[200:201], v[220:221]
v_pk_mul_f32 v[202:203], v[202:203], v[222:223]
v_pk_mul_f32 v[204:205], v[204:205], v[220:221]
v_pk_mul_f32 v[206:207], v[206:207], v[222:223]
v_cvt_pk_bf16_f32 v192, v192, v196
v_cvt_pk_bf16_f32 v196, v194, v198
s_waitcnt lgkmcnt(6)
buffer_store_dwordx4 v[160:163], v244, s[20:23], s96 offen offset:256
v_cvt_pk_bf16_f32 v194, v193, v197
v_cvt_pk_bf16_f32 v198, v195, v199
v_cvt_pk_bf16_f32 v193, v200, v204
v_cvt_pk_bf16_f32 v195, v201, v205
v_cvt_pk_bf16_f32 v197, v202, v206
v_cvt_pk_bf16_f32 v199, v203, v207
ds_write_b64 v245, v[192:193] offset:0
ds_write_b64 v245, v[194:195] offset:288
s_waitcnt lgkmcnt(6)
buffer_store_dwordx4 v[164:167], v244, s[20:23], s96 offen offset:2304
ds_write_b64 v245, v[196:197] offset:576
v_accvgpr_read_b32 v224, a176
v_accvgpr_read_b32 v225, a177
v_accvgpr_read_b32 v226, a178
v_accvgpr_read_b32 v227, a179
v_accvgpr_read_b32 v228, a180
v_accvgpr_read_b32 v229, a181
ds_write_b64 v245, v[198:199] offset:864
s_waitcnt lgkmcnt(6)
buffer_store_dwordx4 v[168:171], v244, s[20:23], s97 offen offset:256
v_accvgpr_read_b32 v230, a182
v_accvgpr_read_b32 v231, a183
v_accvgpr_read_b32 v232, a184
v_accvgpr_read_b32 v233, a185
v_accvgpr_read_b32 v234, a186
v_accvgpr_read_b32 v235, a187
v_accvgpr_read_b32 v236, a188
v_accvgpr_read_b32 v237, a189
v_accvgpr_read_b32 v238, a190
s_waitcnt lgkmcnt(4)
buffer_store_dwordx4 v[172:175], v244, s[20:23], s97 offen offset:2304
v_accvgpr_read_b32 v239, a191
v_pk_mul_f32 v[224:225], v[224:225], v[220:221]
v_pk_mul_f32 v[226:227], v[226:227], v[222:223]
v_pk_mul_f32 v[228:229], v[228:229], v[220:221]
v_pk_mul_f32 v[230:231], v[230:231], v[222:223]
v_pk_mul_f32 v[232:233], v[232:233], v[220:221]
v_pk_mul_f32 v[234:235], v[234:235], v[222:223]
v_pk_mul_f32 v[236:237], v[236:237], v[220:221]
v_pk_mul_f32 v[238:239], v[238:239], v[222:223]
v_cvt_pk_bf16_f32 v224, v224, v228
v_cvt_pk_bf16_f32 v228, v226, v230
v_cvt_pk_bf16_f32 v226, v225, v229
v_cvt_pk_bf16_f32 v230, v227, v231
v_cvt_pk_bf16_f32 v225, v232, v236
v_cvt_pk_bf16_f32 v227, v233, v237
v_cvt_pk_bf16_f32 v229, v234, v238
v_cvt_pk_bf16_f32 v231, v235, v239
ds_write_b64 v245, v[224:225] offset:128
ds_write_b64 v245, v[226:227] offset:416
ds_write_b64 v245, v[228:229] offset:704
ds_write_b64 v245, v[230:231] offset:992
ds_read_b64_tr_b16 a[160:161], v254 offset:0
ds_read_b64_tr_b16 a[162:163], v254 offset:32
ds_read_b64_tr_b16 a[164:165], v254 offset:1152
ds_read_b64_tr_b16 a[166:167], v254 offset:1184
ds_read_b64_tr_b16 a[168:169], v254 offset:2304
ds_read_b64_tr_b16 a[170:171], v254 offset:2336
ds_read_b64_tr_b16 a[172:173], v254 offset:3456
ds_read_b64_tr_b16 a[174:175], v254 offset:3488
s_waitcnt lgkmcnt(6)
buffer_store_dwordx4 a[160:163], v244, s[20:23], s98 offen offset:256
s_waitcnt lgkmcnt(4)
buffer_store_dwordx4 a[164:167], v244, s[20:23], s98 offen offset:2304
s_waitcnt lgkmcnt(2)
buffer_store_dwordx4 a[168:171], v244, s[20:23], s99 offen offset:256
s_waitcnt lgkmcnt(0)
buffer_store_dwordx4 a[172:175], v244, s[20:23], s99 offen offset:2304
s_waitcnt vmcnt(32)
ds_read_b128 a[192:195], v240 offset:0
ds_read_b128 a[196:199], v240 offset:64
ds_read_b128 a[200:203], v240 offset:128
ds_read_b128 a[204:207], v240 offset:192
ds_read_b128 a[208:211], v240 offset:256
ds_read_b128 a[212:215], v240 offset:320
ds_read_b128 a[216:219], v240 offset:384
ds_read_b128 a[220:223], v240 offset:448
s_waitcnt lgkmcnt(8)
s_cmp_lg_u64 s[42:43], 0
s_cbranch_scc1 L_slow
s_branch L_next
L_blk3:
s_waitcnt lgkmcnt(7)
v_mfma_f32_16x16x32_bf16 v[192:195], a[192:195], a[0:3], 0
s_waitcnt lgkmcnt(6)
ds_read_b128 a[252:255], v240 offset:960
ds_read_b128 a[248:251], v240 offset:896
v_mfma_f32_16x16x32_bf16 v[192:195], a[196:199], a[4:7], v[192:195]
s_waitcnt lgkmcnt(7)
ds_read_b128 a[244:247], v240 offset:832
ds_read_b128 a[240:243], v240 offset:768
v_mfma_f32_16x16x32_bf16 v[192:195], a[200:203], a[8:11], v[192:195]
s_waitcnt lgkmcnt(8)
ds_read_b128 a[236:239], v240 offset:704
ds_read_b128 a[232:235], v240 offset:640
v_mfma_f32_16x16x32_bf16 v[192:195], a[204:207], a[12:15], v[192:195]
s_waitcnt lgkmcnt(9)
ds_read_b128 a[228:231], v240 offset:576
ds_read_b128 a[224:227], v240 offset:512
v_mfma_f32_16x16x32_bf16 v[192:195], a[208:211], a[16:19], v[192:195]
s_waitcnt lgkmcnt(10)
v_mov_b32 v250, 0
v_mov_b32 v251, 0
v_mfma_f32_16x16x32_bf16 v[192:195], a[212:215], a[20:23], v[192:195]
s_waitcnt lgkmcnt(9)
v_mov_b32 v252, 0
v_mfma_f32_16x16x32_bf16 v[192:195], a[216:219], a[24:27], v[192:195]
s_waitcnt lgkmcnt(8)
v_mfma_f32_16x16x32_bf16 v[192:195], a[220:223], a[28:31], v[192:195]
s_waitcnt lgkmcnt(7)
v_mfma_f32_16x16x32_bf16 v[208:211], a[252:255], a[28:31], 0
s_waitcnt lgkmcnt(6)
v_mfma_f32_16x16x32_bf16 v[208:211], a[248:251], a[24:27], v[208:211]
s_waitcnt lgkmcnt(5)
v_mfma_f32_16x16x32_bf16 v[208:211], a[244:247], a[20:23], v[208:211]
s_cbranch_vccz L_cw5
s_waitcnt vmcnt(20)
L_cw5:
s_waitcnt lgkmcnt(4)
v_mfma_f32_16x16x32_bf16 v[208:211], a[240:243], a[16:19], v[208:211]
s_waitcnt lgkmcnt(0)
v_max3_f32 v246, v192, v193, v194
v_max_f32 v246, v246, v195
v_mfma_f32_16x16x32_bf16 v[208:211], a[236:239], a[12:15], v[208:211]
s_barrier
v_mfma_f32_16x16x32_bf16 v[208:211], a[232:235], a[8:11], v[208:211]
s_add_u32 m0, s26, 0
v_mov_b32 v224, v246
v_mfma_f32_16x16x32_bf16 v[208:211], a[228:231], a[4:7], v[208:211]
buffer_load_dwordx4 v242, s[12:15], s29 offen offset:0 lds
v_mfma_f32_16x16x32_bf16 v[208:211], a[224:227], a[0:3], v[208:211]
s_add_u32 m0, s26, 32
v_permlane32_swap_b32 v246, v224
v_mfma_f32_16x16x32_bf16 v[212:215], a[224:227], a[32:35], 0
buffer_load_dwordx4 v242, s[12:15], s29 offen offset:1024 lds
v_mfma_f32_16x16x32_bf16 v[212:215], a[228:231], a[36:39], v[212:215]
v_max_f32 v246, v246, v224
v_mov_b32 v224, v246
v_mfma_f32_16x16x32_bf16 v[212:215], a[232:235], a[40:43], v[212:215]
s_add_u32 m0, s26, 64
v_permlane16_swap_b32 v246, v224
v_mfma_f32_16x16x32_bf16 v[212:215], a[236:239], a[44:47], v[212:215]
buffer_load_dwordx4 v242, s[12:15], s29 offen offset:2048 lds
v_mfma_f32_16x16x32_bf16 v[212:215], a[240:243], a[48:51], v[212:215]
s_cbranch_vccz L_cw6
s_waitcnt vmcnt(15)
L_cw6:
v_max_f32 v246, v246, v224
v_mul_f32 v246, s27, v246
v_mfma_f32_16x16x32_bf16 v[212:215], a[244:247], a[52:55], v[212:215]
v_fma_f32 v192, v192, s27, -v246
v_fma_f32 v193, v193, s27, -v246
v_mfma_f32_16x16x32_bf16 v[212:215], a[248:251], a[56:59], v[212:215]
s_add_u32 m0, s26, 96
v_exp_f32 v192, v192
v_mfma_f32_16x16x32_bf16 v[212:215], a[252:255], a[60:63], v[212:215]
buffer_load_dwordx4 v242, s[12:15], s29 offen offset:3072 lds
v_mfma_f32_16x16x32_bf16 v[196:199], a[220:223], a[60:63], 0
s_add_u32 s29, s29, 16384
v_fma_f32 v194, v194, s27, -v246
v_fma_f32 v195, v195, s27, -v246
v_mfma_f32_16x16x32_bf16 v[196:199], a[216:219], a[56:59], v[196:199]
s_add_u32 m0, s3, 53504
v_exp_f32 v193, v193
v_mfma_f32_16x16x32_bf16 v[196:199], a[212:215], a[52:55], v[196:199]
buffer_load_dwordx4 v242, s[16:19], s30 offen offset:0 lds
v_mfma_f32_16x16x32_bf16 v[196:199], a[208:211], a[48:51], v[196:199]
s_add_u32 m0, s3, 53520
v_add_f32 v250, v250, v192
v_add_f32 v250, v250, v193
v_mfma_f32_16x16x32_bf16 v[196:199], a[204:207], a[44:47], v[196:199]
ds_read_b128 a[64:67], v255 offset:0
buffer_load_dwordx4 v242, s[16:19], s30 offen offset:1024 lds
v_mfma_f32_16x16x32_bf16 v[196:199], a[200:203], a[40:43], v[196:199]
ds_read_b128 a[68:71], v255 offset:64
v_cvt_pk_bf16_f32 v192, v192, v193
v_mfma_f32_16x16x32_bf16 v[196:199], a[196:199], a[36:39], v[196:199]
s_add_u32 m0, s3, 53536
ds_read_b128 a[72:75], v255 offset:128
v_fma_f32 v208, v208, s27, -v246
v_mfma_f32_16x16x32_bf16 v[196:199], a[192:195], a[32:35], v[196:199]
s_waitcnt lgkmcnt(2)
ds_read_b128 a[76:79], v255 offset:192
buffer_load_dwordx4 v242, s[16:19], s30 offen offset:2048 lds
v_mfma_f32_16x16x32_bf16 v[200:203], a[192:195], a[64:67], 0
s_waitcnt lgkmcnt(2)
ds_read_b128 a[80:83], v255 offset:256
v_fma_f32 v209, v209, s27, -v246
v_mfma_f32_16x16x32_bf16 v[200:203], a[196:199], a[68:71], v[200:203]
s_waitcnt lgkmcnt(2)
ds_read_b128 a[84:87], v255 offset:320
v_fma_f32 v210, v210, s27, -v246
v_mfma_f32_16x16x32_bf16 v[200:203], a[200:203], a[72:75], v[200:203]
s_waitcnt lgkmcnt(2)
s_add_u32 m0, s3, 53552
ds_read_b128 a[88:91], v255 offset:384
v_fma_f32 v211, v211, s27, -v246
v_mfma_f32_16x16x32_bf16 v[200:203], a[204:207], a[76:79], v[200:203]
s_waitcnt lgkmcnt(2)
ds_read_b128 a[92:95], v255 offset:448
buffer_load_dwordx4 v242, s[16:19], s30 offen offset:3072 lds
v_mfma_f32_16x16x32_bf16 v[200:203], a[208:211], a[80:83], v[200:203]
s_waitcnt lgkmcnt(2)
s_add_u32 s30, s30, 16384
v_max3_f32 v247, v196, v197, v198
v_max_f32 v247, v247, v199
v_mfma_f32_16x16x32_bf16 v[200:203], a[212:215], a[84:87], v[200:203]
s_waitcnt lgkmcnt(1)
ds_read_b128 a[192:195], v240 offset:16896
v_mov_b32 v225, v247
v_mfma_f32_16x16x32_bf16 v[200:203], a[216:219], a[88:91], v[200:203]
s_waitcnt lgkmcnt(1)
v_permlane32_swap_b32 v247, v225
v_mfma_f32_16x16x32_bf16 v[200:203], a[220:223], a[92:95], v[200:203]
v_max_f32 v247, v247, v225
v_mov_b32 v225, v247
v_mfma_f32_16x16x32_bf16 v[216:219], a[252:255], a[92:95], 0
s_nop 0
v_permlane16_swap_b32 v247, v225
v_mfma_f32_16x16x32_bf16 v[216:219], a[248:251], a[88:91], v[216:219]
v_max_f32 v247, v247, v225
v_mul_f32 v247, s27, v247
v_mfma_f32_16x16x32_bf16 v[216:219], a[244:247], a[84:87], v[216:219]
v_exp_f32 v194, v194
v_mfma_f32_16x16x32_bf16 v[216:219], a[240:243], a[80:83], v[216:219]
v_max3_f32 v248, v200, v201, v202
v_max_f32 v248, v248, v203
v_mfma_f32_16x16x32_bf16 v[216:219], a[236:239], a[76:79], v[216:219]
v_mov_b32 v226, v248
v_add_f32 v250, v250, v194
v_mfma_f32_16x16x32_bf16 v[216:219], a[232:235], a[72:75], v[216:219]
v_permlane32_swap_b32 v248, v226
v_mfma_f32_16x16x32_bf16 v[216:219], a[228:231], a[68:71], v[216:219]
v_max_f32 v248, v248, v226
v_mov_b32 v226, v248
v_exp_f32 v195, v195
v_exp_f32 v208, v208
v_exp_f32 v209, v209
v_exp_f32 v210, v210
v_exp_f32 v211, v211
v_mfma_f32_16x16x32_bf16 v[216:219], a[224:227], a[64:67], v[216:219]
s_waitcnt lgkmcnt(0)
ds_read_b128 a[196:199], v240 offset:16960
ds_read_b128 a[200:203], v240 offset:17024
ds_read_b128 a[204:207], v240 offset:17088
ds_read_b128 a[208:211], v240 offset:17152
ds_read_b128 a[212:215], v240 offset:17216
ds_read_b128 a[216:219], v240 offset:17280
ds_read_b128 a[220:223], v240 offset:17344
v_permlane16_swap_b32 v248, v226
v_max_f32 v248, v248, v226
v_mul_f32 v248, s27, v248
v_add_f32 v250, v250, v195
v_cvt_pk_bf16_f32 v193, v194, v195
v_add_f32 v250, v250, v208
v_add_f32 v250, v250, v209
v_cvt_pk_bf16_f32 v194, v208, v209
v_add_f32 v250, v250, v210
v_add_f32 v250, v250, v211
v_cvt_pk_bf16_f32 v195, v210, v211
v_mfma_f32_16x16x32_bf16 v[224:227], a[192:195], a[0:3], 0
s_waitcnt lgkmcnt(6)
ds_read_b128 a[224:227], v240 offset:17408
v_fma_f32 v196, v196, s27, -v247
v_mfma_f32_16x16x32_bf16 v[224:227], a[196:199], a[4:7], v[224:227]
s_waitcnt lgkmcnt(6)
ds_read_b128 a[228:231], v240 offset:17472
v_fma_f32 v197, v197, s27, -v247
v_mfma_f32_16x16x32_bf16 v[224:227], a[200:203], a[8:11], v[224:227]
s_waitcnt lgkmcnt(6)
v_exp_f32 v196, v196
v_mfma_f32_16x16x32_bf16 v[224:227], a[204:207], a[12:15], v[224:227]
s_waitcnt lgkmcnt(5)
v_fma_f32 v198, v198, s27, -v247
v_fma_f32 v199, v199, s27, -v247
v_mfma_f32_16x16x32_bf16 v[224:227], a[208:211], a[16:19], v[224:227]
s_waitcnt lgkmcnt(4)
ds_read_b128 a[232:235], v240 offset:17536
v_add_f32 v251, v251, v196
v_mfma_f32_16x16x32_bf16 v[224:227], a[212:215], a[20:23], v[224:227]
s_waitcnt lgkmcnt(4)
v_exp_f32 v197, v197
v_mfma_f32_16x16x32_bf16 v[224:227], a[216:219], a[24:27], v[224:227]
s_waitcnt lgkmcnt(3)
v_exp_f32 v198, v198
v_mfma_f32_16x16x32_bf16 v[224:227], a[220:223], a[28:31], v[224:227]
ds_read_b128 a[236:239], v240 offset:17600
ds_read_b128 a[240:243], v240 offset:17664
v_mfma_f32_16x16x32_bf16 v[228:231], a[220:223], a[60:63], 0
s_add_u32 m0, s5, 0
v_add_f32 v251, v251, v197
v_cvt_pk_bf16_f32 v196, v196, v197
v_mfma_f32_16x16x32_bf16 v[228:231], a[216:219], a[56:59], v[228:231]
buffer_load_dwordx4 v243, s[8:11], s38 offen nt lds
v_mfma_f32_16x16x32_bf16 v[228:231], a[212:215], a[52:55], v[228:231]
s_add_u32 s38, s38, 512
v_exp_f32 v199, v199
v_mfma_f32_16x16x32_bf16 v[228:231], a[208:211], a[48:51], v[228:231]
ds_read_b128 a[244:247], v240 offset:17728
v_add_f32 v251, v251, v198
v_mfma_f32_16x16x32_bf16 v[228:231], a[204:207], a[44:47], v[228:231]
ds_read_b128 a[248:251], v240 offset:17792
v_add_f32 v251, v251, v199
v_mfma_f32_16x16x32_bf16 v[228:231], a[200:203], a[40:43], v[228:231]
v_cvt_pk_bf16_f32 v197, v198, v199
v_fma_f32 v212, v212, s27, -v247
v_mfma_f32_16x16x32_bf16 v[228:231], a[196:199], a[36:39], v[228:231]
s_add_u32 m0, s5, 8448
ds_read_b128 a[252:255], v240 offset:17856
v_fma_f32 v213, v213, s27, -v247
v_mfma_f32_16x16x32_bf16 v[228:231], a[192:195], a[32:35], v[228:231]
s_add_u32 s5, s5, 1056
buffer_load_dwordx4 v243, s[8:11], s33 offen nt lds
v_mfma_f32_16x16x32_bf16 v[232:235], a[192:195], a[64:67], 0
s_add_u32 s33, s33, 512
v_exp_f32 v212, v212
v_mfma_f32_16x16x32_bf16 v[232:235], a[196:199], a[68:71], v[232:235]
v_fma_f32 v214, v214, s27, -v247
v_fma_f32 v215, v215, s27, -v247
v_mfma_f32_16x16x32_bf16 v[232:235], a[200:203], a[72:75], v[232:235]
v_exp_f32 v213, v213
v_mfma_f32_16x16x32_bf16 v[232:235], a[204:207], a[76:79], v[232:235]
v_add_f32 v251, v251, v212
v_add_f32 v251, v251, v213
v_mfma_f32_16x16x32_bf16 v[232:235], a[208:211], a[80:83], v[232:235]
v_exp_f32 v214, v214
v_mfma_f32_16x16x32_bf16 v[232:235], a[212:215], a[84:87], v[232:235]
s_cbranch_vccz L_cw7
s_waitcnt vmcnt(10)
L_cw7:
v_cvt_pk_bf16_f32 v198, v212, v213
v_add_f32 v251, v251, v214
v_mfma_f32_16x16x32_bf16 v[232:235], a[216:219], a[88:91], v[232:235]
s_waitcnt lgkmcnt(0)
v_exp_f32 v215, v215
v_mfma_f32_16x16x32_bf16 v[232:235], a[220:223], a[92:95], v[232:235]
s_barrier
v_mfma_f32_16x16x32_bf16 v[208:211], a[224:227], a[0:3], 0
s_add_u32 m0, s26, 16896
v_add_f32 v251, v251, v215
v_cvt_pk_bf16_f32 v199, v214, v215
v_mfma_f32_16x16x32_bf16 v[208:211], a[228:231], a[4:7], v[208:211]
buffer_load_dwordx4 v242, s[12:15], s29 offen offset:0 lds
v_mfma_f32_16x16x32_bf16 v[208:211], a[232:235], a[8:11], v[208:211]
v_fma_f32 v200, v200, s27, -v248
v_fma_f32 v201, v201, s27, -v248
v_mfma_f32_16x16x32_bf16 v[208:211], a[236:239], a[12:15], v[208:211]
v_exp_f32 v200, v200
v_mfma_f32_16x16x32_bf16 v[208:211], a[240:243], a[16:19], v[208:211]
v_fma_f32 v202, v202, s27, -v248
v_fma_f32 v203, v203, s27, -v248
v_mfma_f32_16x16x32_bf16 v[208:211], a[244:247], a[20:23], v[208:211]
s_add_u32 m0, s26, 16928
v_exp_f32 v201, v201
v_mfma_f32_16x16x32_bf16 v[208:211], a[248:251], a[24:27], v[208:211]
buffer_load_dwordx4 v242, s[12:15], s29 offen offset:1024 lds
v_mfma_f32_16x16x32_bf16 v[208:211], a[252:255], a[28:31], v[208:211]
ds_read_b64_tr_b16 a[192:193], v241 offset:0
ds_read_b64_tr_b16 a[194:195], v241 offset:512
v_mfma_f32_16x16x32_bf16 v[212:215], a[252:255], a[60:63], 0
ds_read_b64_tr_b16 a[196:197], v241 offset:16
v_add_f32 v252, v252, v200
v_mfma_f32_16x16x32_bf16 v[212:215], a[248:251], a[56:59], v[212:215]
v_exp_f32 v202, v202
v_mfma_f32_16x16x32_bf16 v[212:215], a[244:247], a[52:55], v[212:215]
ds_read_b64_tr_b16 a[198:199], v241 offset:528
v_add_f32 v252, v252, v201
v_mfma_f32_16x16x32_bf16 v[212:215], a[240:243], a[48:51], v[212:215]
s_add_u32 m0, s26, 16960
ds_read_b64_tr_b16 a[200:201], v241 offset:32
v_cvt_pk_bf16_f32 v200, v200, v201
v_mfma_f32_16x16x32_bf16 v[212:215], a[236:239], a[44:47], v[212:215]
buffer_load_dwordx4 v242, s[12:15], s29 offen offset:2048 lds
v_mfma_f32_16x16x32_bf16 v[212:215], a[232:235], a[40:43], v[212:215]
v_exp_f32 v203, v203
v_mfma_f32_16x16x32_bf16 v[212:215], a[228:231], a[36:39], v[212:215]
v_fma_f32 v216, v216, s27, -v248
v_fma_f32 v217, v217, s27, -v248
v_exp_f32 v216, v216
v_fma_f32 v218, v218, s27, -v248
v_fma_f32 v219, v219, s27, -v248
v_exp_f32 v217, v217
v_exp_f32 v218, v218
v_exp_f32 v219, v219
v_mfma_f32_16x16x32_bf16 v[212:215], a[224:227], a[32:35], v[212:215]
v_add_f32 v252, v252, v202
v_add_f32 v252, v252, v203
v_cvt_pk_bf16_f32 v201, v202, v203
v_add_f32 v252, v252, v216
v_add_f32 v252, v252, v217
v_cvt_pk_bf16_f32 v202, v216, v217
v_add_f32 v252, v252, v218
v_add_f32 v252, v252, v219
v_cvt_pk_bf16_f32 v203, v218, v219
v_mfma_f32_16x16x32_bf16 v[216:219], a[224:227], a[64:67], 0
ds_read_b64_tr_b16 a[202:203], v241 offset:544
ds_read_b64_tr_b16 a[204:205], v241 offset:48
v_mfma_f32_16x16x32_bf16 v[216:219], a[228:231], a[68:71], v[216:219]
s_add_u32 m0, s26, 16992
ds_read_b64_tr_b16 a[206:207], v241 offset:560
ds_read_b64_tr_b16 a[208:209], v241 offset:64
v_mfma_f32_16x16x32_bf16 v[216:219], a[232:235], a[72:75], v[216:219]
buffer_load_dwordx4 v242, s[12:15], s29 offen offset:3072 lds
v_mfma_f32_16x16x32_bf16 v[216:219], a[236:239], a[76:79], v[216:219]
s_add_u32 s29, s29, 16384
ds_read_b64_tr_b16 a[210:211], v241 offset:576
ds_read_b64_tr_b16 a[212:213], v241 offset:80
v_mfma_f32_16x16x32_bf16 v[216:219], a[240:243], a[80:83], v[216:219]
ds_read_b64_tr_b16 a[214:215], v241 offset:592
ds_read_b64_tr_b16 a[216:217], v241 offset:96
v_mfma_f32_16x16x32_bf16 v[216:219], a[244:247], a[84:87], v[216:219]
ds_read_b64_tr_b16 a[218:219], v241 offset:608
ds_read_b64_tr_b16 a[220:221], v241 offset:112
v_mfma_f32_16x16x32_bf16 v[216:219], a[248:251], a[88:91], v[216:219]
ds_read_b64_tr_b16 a[222:223], v241 offset:624
v_mfma_f32_16x16x32_bf16 v[216:219], a[252:255], a[92:95], v[216:219]
s_waitcnt lgkmcnt(14)
v_mfma_f32_16x16x32_bf16 v[0:3], v[192:195], a[192:195], 0
ds_read_b64_tr_b16 a[224:225], v241 offset:256
v_fma_f32 v224, v224, s27, -v246
v_mfma_f32_16x16x32_bf16 v[64:67], v[196:199], a[192:195], 0
v_fma_f32 v225, v225, s27, -v246
v_mfma_f32_16x16x32_bf16 v[128:131], v[200:203], a[192:195], 0
s_waitcnt lgkmcnt(13)
v_exp_f32 v224, v224
v_mfma_f32_16x16x32_bf16 v[132:135], v[200:203], a[196:199], 0
ds_read_b64_tr_b16 a[226:227], v241 offset:768
v_fma_f32 v226, v226, s27, -v246
v_mfma_f32_16x16x32_bf16 v[68:71], v[196:199], a[196:199], 0
ds_read_b64_tr_b16 a[228:229], v241 offset:272
v_fma_f32 v227, v227, s27, -v246
v_mfma_f32_16x16x32_bf16 v[4:7], v[192:195], a[196:199], 0
s_waitcnt lgkmcnt(13)
v_exp_f32 v225, v225
v_mfma_f32_16x16x32_bf16 v[8:11], v[192:195], a[200:203], 0
ds_read_b64_tr_b16 a[230:231], v241 offset:784
v_add_f32 v250, v250, v224
v_mfma_f32_16x16x32_bf16 v[72:75], v[196:199], a[200:203], 0
v_exp_f32 v226, v226
v_mfma_f32_16x16x32_bf16 v[136:139], v[200:203], a[200:203], 0
s_waitcnt lgkmcnt(12)
ds_read_b64_tr_b16 a[232:233], v241 offset:288
v_add_f32 v250, v250, v225
v_mfma_f32_16x16x32_bf16 v[140:143], v[200:203], a[204:207], 0
ds_read_b64_tr_b16 a[234:235], v241 offset:800
v_cvt_pk_bf16_f32 v224, v224, v225
v_mfma_f32_16x16x32_bf16 v[76:79], v[196:199], a[204:207], 0
v_exp_f32 v227, v227
v_mfma_f32_16x16x32_bf16 v[12:15], v[192:195], a[204:207], 0
s_waitcnt lgkmcnt(12)
v_add_f32 v250, v250, v226
v_add_f32 v250, v250, v227
v_mfma_f32_16x16x32_bf16 v[16:19], v[192:195], a[208:211], 0
ds_read_b64_tr_b16 a[236:237], v241 offset:304
v_cvt_pk_bf16_f32 v225, v226, v227
v_mfma_f32_16x16x32_bf16 v[80:83], v[196:199], a[208:211], 0
ds_read_b64_tr_b16 a[238:239], v241 offset:816
v_fma_f32 v228, v228, s27, -v247
v_mfma_f32_16x16x32_bf16 v[144:147], v[200:203], a[208:211], 0
s_waitcnt lgkmcnt(12)
ds_read_b64_tr_b16 a[240:241], v241 offset:320
v_fma_f32 v229, v229, s27, -v247
v_mfma_f32_16x16x32_bf16 v[148:151], v[200:203], a[212:215], 0
v_exp_f32 v228, v228
v_mfma_f32_16x16x32_bf16 v[84:87], v[196:199], a[212:215], 0
v_fma_f32 v230, v230, s27, -v247
v_fma_f32 v231, v231, s27, -v247
v_mfma_f32_16x16x32_bf16 v[20:23], v[192:195], a[212:215], 0
s_waitcnt lgkmcnt(11)
v_exp_f32 v229, v229
v_mfma_f32_16x16x32_bf16 v[24:27], v[192:195], a[216:219], 0
ds_read_b64_tr_b16 a[242:243], v241 offset:832
ds_read_b64_tr_b16 a[244:245], v241 offset:336
v_mfma_f32_16x16x32_bf16 v[88:91], v[196:199], a[216:219], 0
v_add_f32 v251, v251, v228
v_add_f32 v251, v251, v229
v_mfma_f32_16x16x32_bf16 v[152:155], v[200:203], a[216:219], 0
s_waitcnt lgkmcnt(11)
v_exp_f32 v230, v230
v_mfma_f32_16x16x32_bf16 v[156:159], v[200:203], a[220:223], 0
ds_read_b64_tr_b16 a[246:247], v241 offset:848
v_cvt_pk_bf16_f32 v228, v228, v229
v_mfma_f32_16x16x32_bf16 v[92:95], v[196:199], a[220:223], 0
ds_read_b64_tr_b16 a[248:249], v241 offset:352
v_add_f32 v251, v251, v230
v_mfma_f32_16x16x32_bf16 v[28:31], v[192:195], a[220:223], 0
s_waitcnt lgkmcnt(11)
v_exp_f32 v231, v231
v_mfma_f32_16x16x32_bf16 v[32:35], v[192:195], a[224:227], 0
ds_read_b64_tr_b16 a[250:251], v241 offset:864
v_add_f32 v251, v251, v231
v_mfma_f32_16x16x32_bf16 v[96:99], v[196:199], a[224:227], 0
ds_read_b64_tr_b16 a[252:253], v241 offset:368
v_cvt_pk_bf16_f32 v229, v230, v231
v_mfma_f32_16x16x32_bf16 v[160:163], v[200:203], a[224:227], 0
s_waitcnt lgkmcnt(11)
v_fma_f32 v232, v232, s27, -v248
v_fma_f32 v233, v233, s27, -v248
v_mfma_f32_16x16x32_bf16 v[164:167], v[200:203], a[228:231], 0
v_exp_f32 v232, v232
v_mfma_f32_16x16x32_bf16 v[100:103], v[196:199], a[228:231], 0
ds_read_b64_tr_b16 a[254:255], v241 offset:880
v_fma_f32 v234, v234, s27, -v248
v_mfma_f32_16x16x32_bf16 v[36:39], v[192:195], a[228:231], 0
s_waitcnt lgkmcnt(10)
v_fma_f32 v235, v235, s27, -v248
v_add_f32 v252, v252, v232
v_mfma_f32_16x16x32_bf16 v[40:43], v[192:195], a[232:235], 0
v_exp_f32 v233, v233
v_mfma_f32_16x16x32_bf16 v[104:107], v[196:199], a[232:235], 0
v_exp_f32 v234, v234
v_mfma_f32_16x16x32_bf16 v[168:171], v[200:203], a[232:235], 0
s_waitcnt vmcnt(10) lgkmcnt(0)
v_add_f32 v252, v252, v233
v_cvt_pk_bf16_f32 v232, v232, v233
v_mfma_f32_16x16x32_bf16 v[172:175], v[200:203], a[236:239], 0
s_barrier
v_mfma_f32_16x16x32_bf16 v[108:111], v[196:199], a[236:239], 0
s_add_u32 m0, s3, 36864
v_exp_f32 v235, v235
v_mfma_f32_16x16x32_bf16 v[44:47], v[192:195], a[236:239], 0
buffer_load_dwordx4 v242, s[16:19], s30 offen offset:0 lds
v_mfma_f32_16x16x32_bf16 v[48:51], v[192:195], a[240:243], 0
v_add_f32 v252, v252, v234
v_add_f32 v252, v252, v235
v_mfma_f32_16x16x32_bf16 v[112:115], v[196:199], a[240:243], 0
s_add_u32 m0, s3, 36880
v_cvt_pk_bf16_f32 v233, v234, v235
v_fma_f32 v208, v208, s27, -v246
v_mfma_f32_16x16x32_bf16 v[176:179], v[200:203], a[240:243], 0
buffer_load_dwordx4 v242, s[16:19], s30 offen offset:1024 lds
v_mfma_f32_16x16x32_bf16 v[180:183], v[200:203], a[244:247], 0
ds_read_b128 a[192:195], v240 offset:0
v_fma_f32 v209, v209, s27, -v246
v_mfma_f32_16x16x32_bf16 v[116:119], v[196:199], a[244:247], 0
s_add_u32 m0, s3, 36896
v_exp_f32 v208, v208
v_mfma_f32_16x16x32_bf16 v[52:55], v[192:195], a[244:247], 0
buffer_load_dwordx4 v242, s[16:19], s30 offen offset:2048 lds
v_mfma_f32_16x16x32_bf16 v[56:59], v[192:195], a[248:251], 0
v_fma_f32 v210, v210, s27, -v246
v_fma_f32 v211, v211, s27, -v246
v_mfma_f32_16x16x32_bf16 v[120:123], v[196:199], a[248:251], 0
s_add_u32 m0, s3, 36912
v_exp_f32 v209, v209
v_mfma_f32_16x16x32_bf16 v[184:187], v[200:203], a[248:251], 0
buffer_load_dwordx4 v242, s[16:19], s30 offen offset:3072 lds
v_mfma_f32_16x16x32_bf16 v[188:191], v[200:203], a[252:255], 0
s_add_u32 s30, s30, 16384
ds_read_b128 a[196:199], v240 offset:64
ds_read_b128 a[200:203], v240 offset:128
v_mfma_f32_16x16x32_bf16 v[124:127], v[196:199], a[252:255], 0
v_exp_f32 v210, v210
v_exp_f32 v211, v211
v_mfma_f32_16x16x32_bf16 v[60:63], v[192:195], a[252:255], 0
ds_read_b128 a[204:207], v240 offset:192
ds_read_b128 a[208:211], v240 offset:256
ds_read_b128 a[212:215], v240 offset:320
ds_read_b128 a[216:219], v240 offset:384
ds_read_b128 a[220:223], v240 offset:448
v_add_f32 v250, v250, v208
v_add_f32 v250, v250, v209
v_cvt_pk_bf16_f32 v226, v208, v209
v_add_f32 v250, v250, v210
v_add_f32 v250, v250, v211
v_cvt_pk_bf16_f32 v227, v210, v211
.p2align 6
L_loop3:
s_waitcnt lgkmcnt(7)
v_mfma_f32_16x16x32_bf16 v[192:195], a[192:195], a[0:3], 0
s_waitcnt lgkmcnt(6)
ds_read_b128 a[224:227], v240 offset:512
v_fma_f32 v212, v212, s27, -v247
v_mfma_f32_16x16x32_bf16 v[192:195], a[196:199], a[4:7], v[192:195]
s_waitcnt lgkmcnt(6)
ds_read_b128 a[228:231], v240 offset:576
v_fma_f32 v213, v213, s27, -v247
v_mfma_f32_16x16x32_bf16 v[192:195], a[200:203], a[8:11], v[192:195]
s_waitcnt lgkmcnt(6)
v_exp_f32 v212, v212
v_mfma_f32_16x16x32_bf16 v[192:195], a[204:207], a[12:15], v[192:195]
s_waitcnt lgkmcnt(5)
ds_read_b128 a[232:235], v240 offset:640
v_fma_f32 v214, v214, s27, -v247
v_mfma_f32_16x16x32_bf16 v[192:195], a[208:211], a[16:19], v[192:195]
s_waitcnt lgkmcnt(5)
ds_read_b128 a[236:239], v240 offset:704
v_fma_f32 v215, v215, s27, -v247
v_mfma_f32_16x16x32_bf16 v[192:195], a[212:215], a[20:23], v[192:195]
s_waitcnt lgkmcnt(5)
v_exp_f32 v213, v213
v_mfma_f32_16x16x32_bf16 v[192:195], a[216:219], a[24:27], v[192:195]
s_waitcnt lgkmcnt(4)
ds_read_b128 a[240:243], v240 offset:768
v_add_f32 v251, v251, v212
v_mfma_f32_16x16x32_bf16 v[192:195], a[220:223], a[28:31], v[192:195]
v_exp_f32 v214, v214
v_mfma_f32_16x16x32_bf16 v[196:199], a[220:223], a[60:63], 0
s_add_u32 m0, s5, 0
ds_read_b128 a[244:247], v240 offset:832
v_mfma_f32_16x16x32_bf16 v[196:199], a[216:219], a[56:59], v[196:199]
buffer_load_dwordx4 v243, s[8:11], s38 offen nt lds
v_mfma_f32_16x16x32_bf16 v[196:199], a[212:215], a[52:55], v[196:199]
s_add_u32 s38, s38, 512
ds_read_b128 a[248:251], v240 offset:896
v_add_f32 v251, v251, v213
v_mfma_f32_16x16x32_bf16 v[196:199], a[208:211], a[48:51], v[196:199]
ds_read_b128 a[252:255], v240 offset:960
v_cvt_pk_bf16_f32 v230, v212, v213
v_mfma_f32_16x16x32_bf16 v[196:199], a[204:207], a[44:47], v[196:199]
v_exp_f32 v215, v215
v_mfma_f32_16x16x32_bf16 v[196:199], a[200:203], a[40:43], v[196:199]
v_add_f32 v251, v251, v214
v_add_f32 v251, v251, v215
v_mfma_f32_16x16x32_bf16 v[196:199], a[196:199], a[36:39], v[196:199]
v_cvt_pk_bf16_f32 v231, v214, v215
v_fma_f32 v216, v216, s27, -v248
v_mfma_f32_16x16x32_bf16 v[196:199], a[192:195], a[32:35], v[196:199]
v_fma_f32 v217, v217, s27, -v248
v_mfma_f32_16x16x32_bf16 v[200:203], a[192:195], a[64:67], 0
v_exp_f32 v216, v216
v_mfma_f32_16x16x32_bf16 v[200:203], a[196:199], a[68:71], v[200:203]
v_fma_f32 v218, v218, s27, -v248
v_fma_f32 v219, v219, s27, -v248
v_mfma_f32_16x16x32_bf16 v[200:203], a[200:203], a[72:75], v[200:203]
v_exp_f32 v217, v217
v_mfma_f32_16x16x32_bf16 v[200:203], a[204:207], a[76:79], v[200:203]
v_add_f32 v252, v252, v216
v_mfma_f32_16x16x32_bf16 v[200:203], a[208:211], a[80:83], v[200:203]
v_exp_f32 v218, v218
v_mfma_f32_16x16x32_bf16 v[200:203], a[212:215], a[84:87], v[200:203]
v_add_f32 v252, v252, v217
v_cvt_pk_bf16_f32 v234, v216, v217
v_mfma_f32_16x16x32_bf16 v[200:203], a[216:219], a[88:91], v[200:203]
s_waitcnt vmcnt(10) lgkmcnt(0)
v_exp_f32 v219, v219
v_mfma_f32_16x16x32_bf16 v[200:203], a[220:223], a[92:95], v[200:203]
s_barrier
v_mfma_f32_16x16x32_bf16 v[208:211], a[224:227], a[0:3], 0
s_add_u32 m0, s26, 0
ds_read_b64_tr_b16 a[192:193], v241 offset:16640
v_add_f32 v252, v252, v218
v_mfma_f32_16x16x32_bf16 v[208:211], a[228:231], a[4:7], v[208:211]
buffer_load_dwordx4 v242, s[12:15], s29 offen offset:0 lds
v_mfma_f32_16x16x32_bf16 v[208:211], a[232:235], a[8:11], v[208:211]
ds_read_b64_tr_b16 a[194:195], v241 offset:17152
v_add_f32 v252, v252, v219
v_mfma_f32_16x16x32_bf16 v[208:211], a[236:239], a[12:15], v[208:211]
ds_read_b64_tr_b16 a[196:197], v241 offset:16656
v_cvt_pk_bf16_f32 v235, v218, v219
v_mfma_f32_16x16x32_bf16 v[208:211], a[240:243], a[16:19], v[208:211]
ds_read_b64_tr_b16 a[198:199], v241 offset:17168
v_fma_f32 v192, v192, s27, -v246
v_mfma_f32_16x16x32_bf16 v[208:211], a[244:247], a[20:23], v[208:211]
s_add_u32 m0, s26, 32
ds_read_b64_tr_b16 a[200:201], v241 offset:16672
v_fma_f32 v193, v193, s27, -v246
v_mfma_f32_16x16x32_bf16 v[208:211], a[248:251], a[24:27], v[208:211]
buffer_load_dwordx4 v242, s[12:15], s29 offen offset:1024 lds
v_mfma_f32_16x16x32_bf16 v[208:211], a[252:255], a[28:31], v[208:211]
v_exp_f32 v192, v192
v_mfma_f32_16x16x32_bf16 v[212:215], a[252:255], a[60:63], 0
ds_read_b64_tr_b16 a[202:203], v241 offset:17184
v_fma_f32 v194, v194, s27, -v246
v_mfma_f32_16x16x32_bf16 v[212:215], a[248:251], a[56:59], v[212:215]
ds_read_b64_tr_b16 a[204:205], v241 offset:16688
v_fma_f32 v195, v195, s27, -v246
v_mfma_f32_16x16x32_bf16 v[212:215], a[244:247], a[52:55], v[212:215]
ds_read_b64_tr_b16 a[206:207], v241 offset:17200
v_mfma_f32_16x16x32_bf16 v[212:215], a[240:243], a[48:51], v[212:215]
s_add_u32 m0, s26, 64
v_exp_f32 v193, v193
v_mfma_f32_16x16x32_bf16 v[212:215], a[236:239], a[44:47], v[212:215]
buffer_load_dwordx4 v242, s[12:15], s29 offen offset:2048 lds
v_mfma_f32_16x16x32_bf16 v[212:215], a[232:235], a[40:43], v[212:215]
ds_read_b64_tr_b16 a[208:209], v241 offset:16704
v_add_f32 v250, v250, v192
v_mfma_f32_16x16x32_bf16 v[212:215], a[228:231], a[36:39], v[212:215]
v_exp_f32 v194, v194
v_mfma_f32_16x16x32_bf16 v[212:215], a[224:227], a[32:35], v[212:215]
ds_read_b64_tr_b16 a[210:211], v241 offset:17216
ds_read_b64_tr_b16 a[212:213], v241 offset:16720
v_mfma_f32_16x16x32_bf16 v[216:219], a[224:227], a[64:67], 0
v_add_f32 v250, v250, v193
v_cvt_pk_bf16_f32 v192, v192, v193
v_mfma_f32_16x16x32_bf16 v[216:219], a[228:231], a[68:71], v[216:219]
s_add_u32 m0, s26, 96
ds_read_b64_tr_b16 a[214:215], v241 offset:17232
v_mfma_f32_16x16x32_bf16 v[216:219], a[232:235], a[72:75], v[216:219]
buffer_load_dwordx4 v242, s[12:15], s29 offen offset:3072 lds
v_mfma_f32_16x16x32_bf16 v[216:219], a[236:239], a[76:79], v[216:219]
s_add_u32 s29, s29, 16384
ds_read_b64_tr_b16 a[216:217], v241 offset:16736
ds_read_b64_tr_b16 a[218:219], v241 offset:17248
v_mfma_f32_16x16x32_bf16 v[216:219], a[240:243], a[80:83], v[216:219]
v_exp_f32 v195, v195
v_mfma_f32_16x16x32_bf16 v[216:219], a[244:247], a[84:87], v[216:219]
ds_read_b64_tr_b16 a[220:221], v241 offset:16752
v_add_f32 v250, v250, v194
v_mfma_f32_16x16x32_bf16 v[216:219], a[248:251], a[88:91], v[216:219]
v_add_f32 v250, v250, v195
v_cvt_pk_bf16_f32 v193, v194, v195
v_mfma_f32_16x16x32_bf16 v[216:219], a[252:255], a[92:95], v[216:219]
s_waitcnt lgkmcnt(13)
ds_read_b64_tr_b16 a[222:223], v241 offset:17264
v_fma_f32 v196, v196, s27, -v247
v_mfma_f32_16x16x32_bf16 v[0:3], v[224:227], a[192:195], v[0:3]
ds_read_b64_tr_b16 a[224:225], v241 offset:16896
v_fma_f32 v197, v197, s27, -v247
v_mfma_f32_16x16x32_bf16 v[64:67], v[228:231], a[192:195], v[64:67]
v_exp_f32 v196, v196
v_mfma_f32_16x16x32_bf16 v[128:131], v[232:235], a[192:195], v[128:131]
s_waitcnt lgkmcnt(13)
ds_read_b64_tr_b16 a[226:227], v241 offset:17408
v_fma_f32 v198, v198, s27, -v247
v_mfma_f32_16x16x32_bf16 v[132:135], v[232:235], a[196:199], v[132:135]
ds_read_b64_tr_b16 a[228:229], v241 offset:16912
v_fma_f32 v199, v199, s27, -v247
v_mfma_f32_16x16x32_bf16 v[68:71], v[228:231], a[196:199], v[68:71]
v_exp_f32 v197, v197
v_mfma_f32_16x16x32_bf16 v[4:7], v[224:227], a[196:199], v[4:7]
s_waitcnt lgkmcnt(13)
ds_read_b64_tr_b16 a[230:231], v241 offset:17424
v_mfma_f32_16x16x32_bf16 v[8:11], v[224:227], a[200:203], v[8:11]
ds_read_b64_tr_b16 a[232:233], v241 offset:16928
v_add_f32 v251, v251, v196
v_mfma_f32_16x16x32_bf16 v[72:75], v[228:231], a[200:203], v[72:75]
v_exp_f32 v198, v198
v_mfma_f32_16x16x32_bf16 v[136:139], v[232:235], a[200:203], v[136:139]
s_waitcnt lgkmcnt(13)
ds_read_b64_tr_b16 a[234:235], v241 offset:17440
v_add_f32 v251, v251, v197
v_mfma_f32_16x16x32_bf16 v[140:143], v[232:235], a[204:207], v[140:143]
ds_read_b64_tr_b16 a[236:237], v241 offset:16944
v_cvt_pk_bf16_f32 v196, v196, v197
v_mfma_f32_16x16x32_bf16 v[76:79], v[228:231], a[204:207], v[76:79]
v_exp_f32 v199, v199
v_mfma_f32_16x16x32_bf16 v[12:15], v[224:227], a[204:207], v[12:15]
s_waitcnt lgkmcnt(13)
ds_read_b64_tr_b16 a[238:239], v241 offset:17456
v_mfma_f32_16x16x32_bf16 v[16:19], v[224:227], a[208:211], v[16:19]
v_add_f32 v251, v251, v198
v_add_f32 v251, v251, v199
v_mfma_f32_16x16x32_bf16 v[80:83], v[228:231], a[208:211], v[80:83]
ds_read_b64_tr_b16 a[240:241], v241 offset:16960
v_cvt_pk_bf16_f32 v197, v198, v199
v_mfma_f32_16x16x32_bf16 v[144:147], v[232:235], a[208:211], v[144:147]
s_waitcnt lgkmcnt(13)
v_fma_f32 v200, v200, s27, -v248
v_fma_f32 v201, v201, s27, -v248
v_mfma_f32_16x16x32_bf16 v[148:151], v[232:235], a[212:215], v[148:151]
ds_read_b64_tr_b16 a[242:243], v241 offset:17472
v_mfma_f32_16x16x32_bf16 v[84:87], v[228:231], a[212:215], v[84:87]
v_exp_f32 v200, v200
v_mfma_f32_16x16x32_bf16 v[20:23], v[224:227], a[212:215], v[20:23]
s_waitcnt lgkmcnt(12)
ds_read_b64_tr_b16 a[244:245], v241 offset:16976
v_fma_f32 v202, v202, s27, -v248
v_mfma_f32_16x16x32_bf16 v[24:27], v[224:227], a[216:219], v[24:27]
ds_read_b64_tr_b16 a[246:247], v241 offset:17488
v_fma_f32 v203, v203, s27, -v248
v_mfma_f32_16x16x32_bf16 v[88:91], v[228:231], a[216:219], v[88:91]
ds_read_b64_tr_b16 a[248:249], v241 offset:16992
v_mfma_f32_16x16x32_bf16 v[152:155], v[232:235], a[216:219], v[152:155]
s_waitcnt lgkmcnt(13)
v_exp_f32 v201, v201
v_mfma_f32_16x16x32_bf16 v[156:159], v[232:235], a[220:223], v[156:159]
ds_read_b64_tr_b16 a[250:251], v241 offset:17504
v_add_f32 v252, v252, v200
v_mfma_f32_16x16x32_bf16 v[92:95], v[228:231], a[220:223], v[92:95]
ds_read_b64_tr_b16 a[252:253], v241 offset:17008
v_mfma_f32_16x16x32_bf16 v[28:31], v[224:227], a[220:223], v[28:31]
s_waitcnt lgkmcnt(13)
v_exp_f32 v202, v202
v_mfma_f32_16x16x32_bf16 v[32:35], v[224:227], a[224:227], v[32:35]
ds_read_b64_tr_b16 a[254:255], v241 offset:17520
v_add_f32 v252, v252, v201
v_mfma_f32_16x16x32_bf16 v[96:99], v[228:231], a[224:227], v[96:99]
v_cvt_pk_bf16_f32 v200, v200, v201
v_add_f32 v252, v252, v202
v_mfma_f32_16x16x32_bf16 v[160:163], v[232:235], a[224:227], v[160:163]
s_waitcnt lgkmcnt(12)
v_exp_f32 v203, v203
v_mfma_f32_16x16x32_bf16 v[164:167], v[232:235], a[228:231], v[164:167]
v_add_f32 v252, v252, v203
v_cvt_pk_bf16_f32 v201, v202, v203
v_mfma_f32_16x16x32_bf16 v[100:103], v[228:231], a[228:231], v[100:103]
v_fma_f32 v208, v208, s27, -v246
v_fma_f32 v209, v209, s27, -v246
v_mfma_f32_16x16x32_bf16 v[36:39], v[224:227], a[228:231], v[36:39]
s_waitcnt lgkmcnt(10)
v_exp_f32 v208, v208
v_mfma_f32_16x16x32_bf16 v[40:43], v[224:227], a[232:235], v[40:43]
v_fma_f32 v210, v210, s27, -v246
v_fma_f32 v211, v211, s27, -v246
v_mfma_f32_16x16x32_bf16 v[104:107], v[228:231], a[232:235], v[104:107]
v_exp_f32 v209, v209
v_mfma_f32_16x16x32_bf16 v[168:171], v[232:235], a[232:235], v[168:171]
s_waitcnt vmcnt(9) lgkmcnt(0)
v_add_f32 v250, v250, v208
v_mfma_f32_16x16x32_bf16 v[172:175], v[232:235], a[236:239], v[172:175]
s_barrier
v_mfma_f32_16x16x32_bf16 v[108:111], v[228:231], a[236:239], v[108:111]
s_add_u32 m0, s3, 53504
ds_read_b128 a[192:195], v240 offset:16896
ds_read_b128 a[196:199], v240 offset:16960
v_mfma_f32_16x16x32_bf16 v[44:47], v[224:227], a[236:239], v[44:47]
buffer_load_dwordx4 v242, s[16:19], s30 offen offset:0 lds
v_mfma_f32_16x16x32_bf16 v[48:51], v[224:227], a[240:243], v[48:51]
v_exp_f32 v210, v210
v_mfma_f32_16x16x32_bf16 v[112:115], v[228:231], a[240:243], v[112:115]
s_add_u32 m0, s3, 53520
ds_read_b128 a[200:203], v240 offset:17024
ds_read_b128 a[204:207], v240 offset:17088
v_mfma_f32_16x16x32_bf16 v[176:179], v[232:235], a[240:243], v[176:179]
buffer_load_dwordx4 v242, s[16:19], s30 offen offset:1024 lds
v_mfma_f32_16x16x32_bf16 v[180:183], v[232:235], a[244:247], v[180:183]
ds_read_b128 a[208:211], v240 offset:17152
ds_read_b128 a[212:215], v240 offset:17216
v_mfma_f32_16x16x32_bf16 v[116:119], v[228:231], a[244:247], v[116:119]
s_add_u32 m0, s3, 53536
ds_read_b128 a[216:219], v240 offset:17280
v_add_f32 v250, v250, v209
v_mfma_f32_16x16x32_bf16 v[52:55], v[224:227], a[244:247], v[52:55]
buffer_load_dwordx4 v242, s[16:19], s30 offen offset:2048 lds
v_mfma_f32_16x16x32_bf16 v[56:59], v[224:227], a[248:251], v[56:59]
ds_read_b128 a[220:223], v240 offset:17344
v_cvt_pk_bf16_f32 v194, v208, v209
v_mfma_f32_16x16x32_bf16 v[120:123], v[228:231], a[248:251], v[120:123]
s_add_u32 m0, s3, 53552
v_exp_f32 v211, v211
v_mfma_f32_16x16x32_bf16 v[184:187], v[232:235], a[248:251], v[184:187]
buffer_load_dwordx4 v242, s[16:19], s30 offen offset:3072 lds
v_mfma_f32_16x16x32_bf16 v[188:191], v[232:235], a[252:255], v[188:191]
s_add_u32 s30, s30, 16384
v_add_f32 v250, v250, v210
v_add_f32 v250, v250, v211
v_mfma_f32_16x16x32_bf16 v[124:127], v[228:231], a[252:255], v[124:127]
v_cvt_pk_bf16_f32 v195, v210, v211
v_mfma_f32_16x16x32_bf16 v[60:63], v[224:227], a[252:255], v[60:63]
s_waitcnt lgkmcnt(7)
v_mfma_f32_16x16x32_bf16 v[224:227], a[192:195], a[0:3], 0
s_waitcnt lgkmcnt(6)
ds_read_b128 a[224:227], v240 offset:17408
v_fma_f32 v212, v212, s27, -v247
v_mfma_f32_16x16x32_bf16 v[224:227], a[196:199], a[4:7], v[224:227]
s_waitcnt lgkmcnt(6)
ds_read_b128 a[228:231], v240 offset:17472
v_fma_f32 v213, v213, s27, -v247
v_mfma_f32_16x16x32_bf16 v[224:227], a[200:203], a[8:11], v[224:227]
s_waitcnt lgkmcnt(6)
v_exp_f32 v212, v212
v_mfma_f32_16x16x32_bf16 v[224:227], a[204:207], a[12:15], v[224:227]
s_waitcnt lgkmcnt(5)
ds_read_b128 a[232:235], v240 offset:17536
v_fma_f32 v214, v214, s27, -v247
v_mfma_f32_16x16x32_bf16 v[224:227], a[208:211], a[16:19], v[224:227]
s_waitcnt lgkmcnt(5)
ds_read_b128 a[236:239], v240 offset:17600
v_fma_f32 v215, v215, s27, -v247
v_mfma_f32_16x16x32_bf16 v[224:227], a[212:215], a[20:23], v[224:227]
s_waitcnt lgkmcnt(5)
v_exp_f32 v213, v213
v_mfma_f32_16x16x32_bf16 v[224:227], a[216:219], a[24:27], v[224:227]
s_waitcnt lgkmcnt(4)
ds_read_b128 a[240:243], v240 offset:17664
v_add_f32 v251, v251, v212
v_mfma_f32_16x16x32_bf16 v[224:227], a[220:223], a[28:31], v[224:227]
v_exp_f32 v214, v214
v_mfma_f32_16x16x32_bf16 v[228:231], a[220:223], a[60:63], 0
s_add_u32 m0, s5, 8448
ds_read_b128 a[244:247], v240 offset:17728
v_mfma_f32_16x16x32_bf16 v[228:231], a[216:219], a[56:59], v[228:231]
s_add_u32 s5, s5, 1056
buffer_load_dwordx4 v243, s[8:11], s33 offen nt lds
v_mfma_f32_16x16x32_bf16 v[228:231], a[212:215], a[52:55], v[228:231]
s_add_u32 s33, s33, 512
ds_read_b128 a[248:251], v240 offset:17792
v_add_f32 v251, v251, v213
v_mfma_f32_16x16x32_bf16 v[228:231], a[208:211], a[48:51], v[228:231]
ds_read_b128 a[252:255], v240 offset:17856
v_cvt_pk_bf16_f32 v198, v212, v213
v_mfma_f32_16x16x32_bf16 v[228:231], a[204:207], a[44:47], v[228:231]
v_exp_f32 v215, v215
v_mfma_f32_16x16x32_bf16 v[228:231], a[200:203], a[40:43], v[228:231]
v_add_f32 v251, v251, v214
v_add_f32 v251, v251, v215
v_mfma_f32_16x16x32_bf16 v[228:231], a[196:199], a[36:39], v[228:231]
v_cvt_pk_bf16_f32 v199, v214, v215
v_fma_f32 v216, v216, s27, -v248
v_mfma_f32_16x16x32_bf16 v[228:231], a[192:195], a[32:35], v[228:231]
v_fma_f32 v217, v217, s27, -v248
v_mfma_f32_16x16x32_bf16 v[232:235], a[192:195], a[64:67], 0
v_exp_f32 v216, v216
v_mfma_f32_16x16x32_bf16 v[232:235], a[196:199], a[68:71], v[232:235]
v_fma_f32 v218, v218, s27, -v248
v_fma_f32 v219, v219, s27, -v248
v_mfma_f32_16x16x32_bf16 v[232:235], a[200:203], a[72:75], v[232:235]
v_exp_f32 v217, v217
v_mfma_f32_16x16x32_bf16 v[232:235], a[204:207], a[76:79], v[232:235]
v_add_f32 v252, v252, v216
v_mfma_f32_16x16x32_bf16 v[232:235], a[208:211], a[80:83], v[232:235]
v_exp_f32 v218, v218
v_mfma_f32_16x16x32_bf16 v[232:235], a[212:215], a[84:87], v[232:235]
v_add_f32 v252, v252, v217
v_cvt_pk_bf16_f32 v202, v216, v217
v_mfma_f32_16x16x32_bf16 v[232:235], a[216:219], a[88:91], v[232:235]
s_waitcnt vmcnt(10) lgkmcnt(0)
v_exp_f32 v219, v219
v_mfma_f32_16x16x32_bf16 v[232:235], a[220:223], a[92:95], v[232:235]
s_barrier
v_mfma_f32_16x16x32_bf16 v[208:211], a[224:227], a[0:3], 0
s_add_u32 m0, s26, 16896
ds_read_b64_tr_b16 a[192:193], v241 offset:0
v_add_f32 v252, v252, v218
v_mfma_f32_16x16x32_bf16 v[208:211], a[228:231], a[4:7], v[208:211]
buffer_load_dwordx4 v242, s[12:15], s29 offen offset:0 lds
v_mfma_f32_16x16x32_bf16 v[208:211], a[232:235], a[8:11], v[208:211]
ds_read_b64_tr_b16 a[194:195], v241 offset:512
v_add_f32 v252, v252, v219
v_mfma_f32_16x16x32_bf16 v[208:211], a[236:239], a[12:15], v[208:211]
ds_read_b64_tr_b16 a[196:197], v241 offset:16
v_cvt_pk_bf16_f32 v203, v218, v219
v_mfma_f32_16x16x32_bf16 v[208:211], a[240:243], a[16:19], v[208:211]
ds_read_b64_tr_b16 a[198:199], v241 offset:528
v_fma_f32 v224, v224, s27, -v246
v_mfma_f32_16x16x32_bf16 v[208:211], a[244:247], a[20:23], v[208:211]
s_add_u32 m0, s26, 16928
ds_read_b64_tr_b16 a[200:201], v241 offset:32
v_fma_f32 v225, v225, s27, -v246
v_mfma_f32_16x16x32_bf16 v[208:211], a[248:251], a[24:27], v[208:211]
buffer_load_dwordx4 v242, s[12:15], s29 offen offset:1024 lds
v_mfma_f32_16x16x32_bf16 v[208:211], a[252:255], a[28:31], v[208:211]
v_exp_f32 v224, v224
v_mfma_f32_16x16x32_bf16 v[212:215], a[252:255], a[60:63], 0
ds_read_b64_tr_b16 a[202:203], v241 offset:544
v_fma_f32 v226, v226, s27, -v246
v_mfma_f32_16x16x32_bf16 v[212:215], a[248:251], a[56:59], v[212:215]
ds_read_b64_tr_b16 a[204:205], v241 offset:48
v_fma_f32 v227, v227, s27, -v246
v_mfma_f32_16x16x32_bf16 v[212:215], a[244:247], a[52:55], v[212:215]
ds_read_b64_tr_b16 a[206:207], v241 offset:560
v_mfma_f32_16x16x32_bf16 v[212:215], a[240:243], a[48:51], v[212:215]
s_add_u32 m0, s26, 16960
v_exp_f32 v225, v225
v_mfma_f32_16x16x32_bf16 v[212:215], a[236:239], a[44:47], v[212:215]
buffer_load_dwordx4 v242, s[12:15], s29 offen offset:2048 lds
v_mfma_f32_16x16x32_bf16 v[212:215], a[232:235], a[40:43], v[212:215]
ds_read_b64_tr_b16 a[208:209], v241 offset:64
v_add_f32 v250, v250, v224
v_mfma_f32_16x16x32_bf16 v[212:215], a[228:231], a[36:39], v[212:215]
v_exp_f32 v226, v226
v_mfma_f32_16x16x32_bf16 v[212:215], a[224:227], a[32:35], v[212:215]
ds_read_b64_tr_b16 a[210:211], v241 offset:576
ds_read_b64_tr_b16 a[212:213], v241 offset:80
v_mfma_f32_16x16x32_bf16 v[216:219], a[224:227], a[64:67], 0
v_add_f32 v250, v250, v225
v_cvt_pk_bf16_f32 v224, v224, v225
v_mfma_f32_16x16x32_bf16 v[216:219], a[228:231], a[68:71], v[216:219]
s_add_u32 m0, s26, 16992
ds_read_b64_tr_b16 a[214:215], v241 offset:592
v_mfma_f32_16x16x32_bf16 v[216:219], a[232:235], a[72:75], v[216:219]
buffer_load_dwordx4 v242, s[12:15], s29 offen offset:3072 lds
v_mfma_f32_16x16x32_bf16 v[216:219], a[236:239], a[76:79], v[216:219]
s_add_u32 s29, s29, 16384
ds_read_b64_tr_b16 a[216:217], v241 offset:96
ds_read_b64_tr_b16 a[218:219], v241 offset:608
v_mfma_f32_16x16x32_bf16 v[216:219], a[240:243], a[80:83], v[216:219]
v_exp_f32 v227, v227
v_mfma_f32_16x16x32_bf16 v[216:219], a[244:247], a[84:87], v[216:219]
ds_read_b64_tr_b16 a[220:221], v241 offset:112
v_add_f32 v250, v250, v226
v_mfma_f32_16x16x32_bf16 v[216:219], a[248:251], a[88:91], v[216:219]
v_add_f32 v250, v250, v227
v_cvt_pk_bf16_f32 v225, v226, v227
v_mfma_f32_16x16x32_bf16 v[216:219], a[252:255], a[92:95], v[216:219]
s_waitcnt lgkmcnt(13)
ds_read_b64_tr_b16 a[222:223], v241 offset:624
v_fma_f32 v228, v228, s27, -v247
v_mfma_f32_16x16x32_bf16 v[0:3], v[192:195], a[192:195], v[0:3]
ds_read_b64_tr_b16 a[224:225], v241 offset:256
v_fma_f32 v229, v229, s27, -v247
v_mfma_f32_16x16x32_bf16 v[64:67], v[196:199], a[192:195], v[64:67]
v_exp_f32 v228, v228
v_mfma_f32_16x16x32_bf16 v[128:131], v[200:203], a[192:195], v[128:131]
s_waitcnt lgkmcnt(13)
ds_read_b64_tr_b16 a[226:227], v241 offset:768
v_fma_f32 v230, v230, s27, -v247
v_mfma_f32_16x16x32_bf16 v[132:135], v[200:203], a[196:199], v[132:135]
ds_read_b64_tr_b16 a[228:229], v241 offset:272
v_fma_f32 v231, v231, s27, -v247
v_mfma_f32_16x16x32_bf16 v[68:71], v[196:199], a[196:199], v[68:71]
v_exp_f32 v229, v229
v_mfma_f32_16x16x32_bf16 v[4:7], v[192:195], a[196:199], v[4:7]
s_waitcnt lgkmcnt(13)
ds_read_b64_tr_b16 a[230:231], v241 offset:784
v_mfma_f32_16x16x32_bf16 v[8:11], v[192:195], a[200:203], v[8:11]
ds_read_b64_tr_b16 a[232:233], v241 offset:288
v_add_f32 v251, v251, v228
v_mfma_f32_16x16x32_bf16 v[72:75], v[196:199], a[200:203], v[72:75]
v_exp_f32 v230, v230
v_mfma_f32_16x16x32_bf16 v[136:139], v[200:203], a[200:203], v[136:139]
s_waitcnt lgkmcnt(13)
ds_read_b64_tr_b16 a[234:235], v241 offset:800
v_add_f32 v251, v251, v229
v_mfma_f32_16x16x32_bf16 v[140:143], v[200:203], a[204:207], v[140:143]
ds_read_b64_tr_b16 a[236:237], v241 offset:304
v_cvt_pk_bf16_f32 v228, v228, v229
v_mfma_f32_16x16x32_bf16 v[76:79], v[196:199], a[204:207], v[76:79]
v_exp_f32 v231, v231
v_mfma_f32_16x16x32_bf16 v[12:15], v[192:195], a[204:207], v[12:15]
s_waitcnt lgkmcnt(13)
ds_read_b64_tr_b16 a[238:239], v241 offset:816
v_mfma_f32_16x16x32_bf16 v[16:19], v[192:195], a[208:211], v[16:19]
v_add_f32 v251, v251, v230
v_add_f32 v251, v251, v231
v_mfma_f32_16x16x32_bf16 v[80:83], v[196:199], a[208:211], v[80:83]
ds_read_b64_tr_b16 a[240:241], v241 offset:320
v_cvt_pk_bf16_f32 v229, v230, v231
v_mfma_f32_16x16x32_bf16 v[144:147], v[200:203], a[208:211], v[144:147]
s_waitcnt lgkmcnt(13)
v_fma_f32 v232, v232, s27, -v248
v_fma_f32 v233, v233, s27, -v248
v_mfma_f32_16x16x32_bf16 v[148:151], v[200:203], a[212:215], v[148:151]
ds_read_b64_tr_b16 a[242:243], v241 offset:832
v_mfma_f32_16x16x32_bf16 v[84:87], v[196:199], a[212:215], v[84:87]
v_exp_f32 v232, v232
v_mfma_f32_16x16x32_bf16 v[20:23], v[192:195], a[212:215], v[20:23]
s_waitcnt lgkmcnt(12)
ds_read_b64_tr_b16 a[244:245], v241 offset:336
v_fma_f32 v234, v234, s27, -v248
v_mfma_f32_16x16x32_bf16 v[24:27], v[192:195], a[216:219], v[24:27]
ds_read_b64_tr_b16 a[246:247], v241 offset:848
v_fma_f32 v235, v235, s27, -v248
v_mfma_f32_16x16x32_bf16 v[88:91], v[196:199], a[216:219], v[88:91]
ds_read_b64_tr_b16 a[248:249], v241 offset:352
v_mfma_f32_16x16x32_bf16 v[152:155], v[200:203], a[216:219], v[152:155]
s_waitcnt lgkmcnt(13)
v_exp_f32 v233, v233
v_mfma_f32_16x16x32_bf16 v[156:159], v[200:203], a[220:223], v[156:159]
ds_read_b64_tr_b16 a[250:251], v241 offset:864
v_add_f32 v252, v252, v232
v_mfma_f32_16x16x32_bf16 v[92:95], v[196:199], a[220:223], v[92:95]
ds_read_b64_tr_b16 a[252:253], v241 offset:368
v_mfma_f32_16x16x32_bf16 v[28:31], v[192:195], a[220:223], v[28:31]
s_waitcnt lgkmcnt(13)
v_exp_f32 v234, v234
v_mfma_f32_16x16x32_bf16 v[32:35], v[192:195], a[224:227], v[32:35]
ds_read_b64_tr_b16 a[254:255], v241 offset:880
v_add_f32 v252, v252, v233
v_mfma_f32_16x16x32_bf16 v[96:99], v[196:199], a[224:227], v[96:99]
v_cvt_pk_bf16_f32 v232, v232, v233
v_add_f32 v252, v252, v234
v_mfma_f32_16x16x32_bf16 v[160:163], v[200:203], a[224:227], v[160:163]
s_waitcnt lgkmcnt(12)
v_exp_f32 v235, v235
v_mfma_f32_16x16x32_bf16 v[164:167], v[200:203], a[228:231], v[164:167]
v_add_f32 v252, v252, v235
v_cvt_pk_bf16_f32 v233, v234, v235
v_mfma_f32_16x16x32_bf16 v[100:103], v[196:199], a[228:231], v[100:103]
v_fma_f32 v208, v208, s27, -v246
v_fma_f32 v209, v209, s27, -v246
v_mfma_f32_16x16x32_bf16 v[36:39], v[192:195], a[228:231], v[36:39]
s_waitcnt lgkmcnt(10)
v_exp_f32 v208, v208
v_mfma_f32_16x16x32_bf16 v[40:43], v[192:195], a[232:235], v[40:43]
v_fma_f32 v210, v210, s27, -v246
v_fma_f32 v211, v211, s27, -v246
v_mfma_f32_16x16x32_bf16 v[104:107], v[196:199], a[232:235], v[104:107]
v_exp_f32 v209, v209
v_mfma_f32_16x16x32_bf16 v[168:171], v[200:203], a[232:235], v[168:171]
s_waitcnt vmcnt(9) lgkmcnt(0)
v_add_f32 v250, v250, v208
v_mfma_f32_16x16x32_bf16 v[172:175], v[200:203], a[236:239], v[172:175]
s_barrier
v_mfma_f32_16x16x32_bf16 v[108:111], v[196:199], a[236:239], v[108:111]
s_add_u32 m0, s3, 36864
ds_read_b128 a[192:195], v240 offset:0
ds_read_b128 a[196:199], v240 offset:64
v_mfma_f32_16x16x32_bf16 v[44:47], v[192:195], a[236:239], v[44:47]
buffer_load_dwordx4 v242, s[16:19], s30 offen offset:0 lds
v_mfma_f32_16x16x32_bf16 v[48:51], v[192:195], a[240:243], v[48:51]
v_exp_f32 v210, v210
v_mfma_f32_16x16x32_bf16 v[112:115], v[196:199], a[240:243], v[112:115]
s_add_u32 m0, s3, 36880
ds_read_b128 a[200:203], v240 offset:128
ds_read_b128 a[204:207], v240 offset:192
v_mfma_f32_16x16x32_bf16 v[176:179], v[200:203], a[240:243], v[176:179]
buffer_load_dwordx4 v242, s[16:19], s30 offen offset:1024 lds
v_mfma_f32_16x16x32_bf16 v[180:183], v[200:203], a[244:247], v[180:183]
ds_read_b128 a[208:211], v240 offset:256
ds_read_b128 a[212:215], v240 offset:320
v_mfma_f32_16x16x32_bf16 v[116:119], v[196:199], a[244:247], v[116:119]
s_add_u32 m0, s3, 36896
ds_read_b128 a[216:219], v240 offset:384
v_add_f32 v250, v250, v209
v_mfma_f32_16x16x32_bf16 v[52:55], v[192:195], a[244:247], v[52:55]
buffer_load_dwordx4 v242, s[16:19], s30 offen offset:2048 lds
v_mfma_f32_16x16x32_bf16 v[56:59], v[192:195], a[248:251], v[56:59]
ds_read_b128 a[220:223], v240 offset:448
v_cvt_pk_bf16_f32 v226, v208, v209
v_mfma_f32_16x16x32_bf16 v[120:123], v[196:199], a[248:251], v[120:123]
s_add_u32 m0, s3, 36912
v_exp_f32 v211, v211
v_mfma_f32_16x16x32_bf16 v[184:187], v[200:203], a[248:251], v[184:187]
buffer_load_dwordx4 v242, s[16:19], s30 offen offset:3072 lds
v_mfma_f32_16x16x32_bf16 v[188:191], v[200:203], a[252:255], v[188:191]
s_add_u32 s30, s30, 16384
v_add_f32 v250, v250, v210
v_add_f32 v250, v250, v211
v_mfma_f32_16x16x32_bf16 v[124:127], v[196:199], a[252:255], v[124:127]
v_cvt_pk_bf16_f32 v227, v210, v211
v_mfma_f32_16x16x32_bf16 v[60:63], v[192:195], a[252:255], v[60:63]
s_sub_u32 s39, s39, 1
s_cbranch_scc0 L_loop3
s_waitcnt lgkmcnt(7)
v_mfma_f32_16x16x32_bf16 v[192:195], a[192:195], a[0:3], 0
s_waitcnt lgkmcnt(6)
ds_read_b128 a[224:227], v240 offset:512
v_fma_f32 v212, v212, s27, -v247
v_mfma_f32_16x16x32_bf16 v[192:195], a[196:199], a[4:7], v[192:195]
s_waitcnt lgkmcnt(6)
ds_read_b128 a[228:231], v240 offset:576
v_fma_f32 v213, v213, s27, -v247
v_mfma_f32_16x16x32_bf16 v[192:195], a[200:203], a[8:11], v[192:195]
s_waitcnt lgkmcnt(6)
v_exp_f32 v212, v212
v_mfma_f32_16x16x32_bf16 v[192:195], a[204:207], a[12:15], v[192:195]
s_waitcnt lgkmcnt(5)
v_fma_f32 v214, v214, s27, -v247
v_fma_f32 v215, v215, s27, -v247
v_mfma_f32_16x16x32_bf16 v[192:195], a[208:211], a[16:19], v[192:195]
s_waitcnt lgkmcnt(4)
ds_read_b128 a[232:235], v240 offset:640
v_add_f32 v251, v251, v212
v_mfma_f32_16x16x32_bf16 v[192:195], a[212:215], a[20:23], v[192:195]
s_waitcnt lgkmcnt(4)
v_exp_f32 v213, v213
v_mfma_f32_16x16x32_bf16 v[192:195], a[216:219], a[24:27], v[192:195]
s_waitcnt lgkmcnt(3)
ds_read_b128 a[236:239], v240 offset:704
ds_read_b128 a[240:243], v240 offset:768
v_mfma_f32_16x16x32_bf16 v[192:195], a[220:223], a[28:31], v[192:195]
v_exp_f32 v214, v214
v_mfma_f32_16x16x32_bf16 v[196:199], a[220:223], a[60:63], 0
s_add_u32 m0, s5, 0
v_add_f32 v251, v251, v213
v_cvt_pk_bf16_f32 v230, v212, v213
v_mfma_f32_16x16x32_bf16 v[196:199], a[216:219], a[56:59], v[196:199]
buffer_load_dwordx4 v243, s[8:11], s38 offen nt lds
v_mfma_f32_16x16x32_bf16 v[196:199], a[212:215], a[52:55], v[196:199]
s_add_u32 s38, s38, 512
ds_read_b128 a[244:247], v240 offset:832
ds_read_b128 a[248:251], v240 offset:896
v_mfma_f32_16x16x32_bf16 v[196:199], a[208:211], a[48:51], v[196:199]
v_exp_f32 v215, v215
v_mfma_f32_16x16x32_bf16 v[196:199], a[204:207], a[44:47], v[196:199]
v_add_f32 v251, v251, v214
v_add_f32 v251, v251, v215
v_mfma_f32_16x16x32_bf16 v[196:199], a[200:203], a[40:43], v[196:199]
ds_read_b128 a[252:255], v240 offset:960
v_cvt_pk_bf16_f32 v231, v214, v215
v_mfma_f32_16x16x32_bf16 v[196:199], a[196:199], a[36:39], v[196:199]
s_add_u32 m0, s5, 8448
v_fma_f32 v216, v216, s27, -v248
v_fma_f32 v217, v217, s27, -v248
v_mfma_f32_16x16x32_bf16 v[196:199], a[192:195], a[32:35], v[196:199]
s_add_u32 s5, s5, 1056
buffer_load_dwordx4 v243, s[8:11], s33 offen nt lds
v_mfma_f32_16x16x32_bf16 v[200:203], a[192:195], a[64:67], 0
s_add_u32 s33, s33, 512
v_exp_f32 v216, v216
v_mfma_f32_16x16x32_bf16 v[200:203], a[196:199], a[68:71], v[200:203]
v_fma_f32 v218, v218, s27, -v248
v_fma_f32 v219, v219, s27, -v248
v_mfma_f32_16x16x32_bf16 v[200:203], a[200:203], a[72:75], v[200:203]
v_exp_f32 v217, v217
v_mfma_f32_16x16x32_bf16 v[200:203], a[204:207], a[76:79], v[200:203]
v_add_f32 v252, v252, v216
v_add_f32 v252, v252, v217
v_mfma_f32_16x16x32_bf16 v[200:203], a[208:211], a[80:83], v[200:203]
v_exp_f32 v218, v218
v_mfma_f32_16x16x32_bf16 v[200:203], a[212:215], a[84:87], v[200:203]
v_cvt_pk_bf16_f32 v234, v216, v217
v_add_f32 v252, v252, v218
v_mfma_f32_16x16x32_bf16 v[200:203], a[216:219], a[88:91], v[200:203]
s_waitcnt vmcnt(11) lgkmcnt(0)
v_exp_f32 v219, v219
v_mfma_f32_16x16x32_bf16 v[200:203], a[220:223], a[92:95], v[200:203]
s_barrier
v_mfma_f32_16x16x32_bf16 v[208:211], a[224:227], a[0:3], 0
s_mov_b32 s29, s32
s_add_u32 m0, s26, 0
v_add_f32 v252, v252, v219
v_mfma_f32_16x16x32_bf16 v[208:211], a[228:231], a[4:7], v[208:211]
buffer_load_dwordx4 v242, s[12:15], s29 offen offset:0 lds
v_mfma_f32_16x16x32_bf16 v[208:211], a[232:235], a[8:11], v[208:211]
v_cvt_pk_bf16_f32 v235, v218, v219
v_fma_f32 v192, v192, s27, -v246
v_mfma_f32_16x16x32_bf16 v[208:211], a[236:239], a[12:15], v[208:211]
ds_read_b64_tr_b16 a[192:193], v241 offset:16640
v_fma_f32 v193, v193, s27, -v246
v_mfma_f32_16x16x32_bf16 v[208:211], a[240:243], a[16:19], v[208:211]
ds_read_b64_tr_b16 a[194:195], v241 offset:17152
ds_read_b64_tr_b16 a[196:197], v241 offset:16656
v_mfma_f32_16x16x32_bf16 v[208:211], a[244:247], a[20:23], v[208:211]
s_add_u32 m0, s26, 32
v_exp_f32 v192, v192
v_mfma_f32_16x16x32_bf16 v[208:211], a[248:251], a[24:27], v[208:211]
buffer_load_dwordx4 v242, s[12:15], s29 offen offset:1024 lds
v_mfma_f32_16x16x32_bf16 v[208:211], a[252:255], a[28:31], v[208:211]
ds_read_b64_tr_b16 a[198:199], v241 offset:17168
v_fma_f32 v194, v194, s27, -v246
v_mfma_f32_16x16x32_bf16 v[212:215], a[252:255], a[60:63], 0
ds_read_b64_tr_b16 a[200:201], v241 offset:16672
v_fma_f32 v195, v195, s27, -v246
v_mfma_f32_16x16x32_bf16 v[212:215], a[248:251], a[56:59], v[212:215]
v_exp_f32 v193, v193
v_mfma_f32_16x16x32_bf16 v[212:215], a[244:247], a[52:55], v[212:215]
ds_read_b64_tr_b16 a[202:203], v241 offset:17184
v_add_f32 v250, v250, v192
v_mfma_f32_16x16x32_bf16 v[212:215], a[240:243], a[48:51], v[212:215]
s_add_u32 m0, s26, 64
v_exp_f32 v194, v194
v_mfma_f32_16x16x32_bf16 v[212:215], a[236:239], a[44:47], v[212:215]
buffer_load_dwordx4 v242, s[12:15], s29 offen offset:2048 lds
v_mfma_f32_16x16x32_bf16 v[212:215], a[232:235], a[40:43], v[212:215]
ds_read_b64_tr_b16 a[204:205], v241 offset:16688
ds_read_b64_tr_b16 a[206:207], v241 offset:17200
v_mfma_f32_16x16x32_bf16 v[212:215], a[228:231], a[36:39], v[212:215]
ds_read_b64_tr_b16 a[208:209], v241 offset:16704
v_add_f32 v250, v250, v193
v_mfma_f32_16x16x32_bf16 v[212:215], a[224:227], a[32:35], v[212:215]
v_cvt_pk_bf16_f32 v192, v192, v193
v_add_f32 v250, v250, v194
v_mfma_f32_16x16x32_bf16 v[216:219], a[224:227], a[64:67], 0
v_exp_f32 v195, v195
v_mfma_f32_16x16x32_bf16 v[216:219], a[228:231], a[68:71], v[216:219]
s_add_u32 m0, s26, 96
ds_read_b64_tr_b16 a[210:211], v241 offset:17216
v_add_f32 v250, v250, v195
v_mfma_f32_16x16x32_bf16 v[216:219], a[232:235], a[72:75], v[216:219]
buffer_load_dwordx4 v242, s[12:15], s29 offen offset:3072 lds
v_mfma_f32_16x16x32_bf16 v[216:219], a[236:239], a[76:79], v[216:219]
s_add_u32 s29, s29, 16384
ds_read_b64_tr_b16 a[212:213], v241 offset:16720
v_cvt_pk_bf16_f32 v193, v194, v195
v_mfma_f32_16x16x32_bf16 v[216:219], a[240:243], a[80:83], v[216:219]
v_fma_f32 v196, v196, s27, -v247
v_fma_f32 v197, v197, s27, -v247
v_mfma_f32_16x16x32_bf16 v[216:219], a[244:247], a[84:87], v[216:219]
ds_read_b64_tr_b16 a[214:215], v241 offset:17232
ds_read_b64_tr_b16 a[216:217], v241 offset:16736
v_mfma_f32_16x16x32_bf16 v[216:219], a[248:251], a[88:91], v[216:219]
v_exp_f32 v196, v196
v_mfma_f32_16x16x32_bf16 v[216:219], a[252:255], a[92:95], v[216:219]
s_waitcnt lgkmcnt(11)
ds_read_b64_tr_b16 a[218:219], v241 offset:17248
v_fma_f32 v198, v198, s27, -v247
v_mfma_f32_16x16x32_bf16 v[0:3], v[224:227], a[192:195], v[0:3]
ds_read_b64_tr_b16 a[220:221], v241 offset:16752
v_fma_f32 v199, v199, s27, -v247
v_mfma_f32_16x16x32_bf16 v[64:67], v[228:231], a[192:195], v[64:67]
v_exp_f32 v197, v197
v_mfma_f32_16x16x32_bf16 v[128:131], v[232:235], a[192:195], v[128:131]
s_waitcnt lgkmcnt(11)
ds_read_b64_tr_b16 a[222:223], v241 offset:17264
v_add_f32 v251, v251, v196
v_mfma_f32_16x16x32_bf16 v[132:135], v[232:235], a[196:199], v[132:135]
ds_read_b64_tr_b16 a[224:225], v241 offset:16896
v_add_f32 v251, v251, v197
v_mfma_f32_16x16x32_bf16 v[68:71], v[228:231], a[196:199], v[68:71]
v_exp_f32 v198, v198
v_mfma_f32_16x16x32_bf16 v[4:7], v[224:227], a[196:199], v[4:7]
s_waitcnt lgkmcnt(11)
ds_read_b64_tr_b16 a[226:227], v241 offset:17408
v_cvt_pk_bf16_f32 v196, v196, v197
v_mfma_f32_16x16x32_bf16 v[8:11], v[224:227], a[200:203], v[8:11]
v_exp_f32 v199, v199
v_mfma_f32_16x16x32_bf16 v[72:75], v[228:231], a[200:203], v[72:75]
ds_read_b64_tr_b16 a[228:229], v241 offset:16912
v_add_f32 v251, v251, v198
v_mfma_f32_16x16x32_bf16 v[136:139], v[232:235], a[200:203], v[136:139]
s_waitcnt lgkmcnt(11)
ds_read_b64_tr_b16 a[230:231], v241 offset:17424
v_add_f32 v251, v251, v199
v_mfma_f32_16x16x32_bf16 v[140:143], v[232:235], a[204:207], v[140:143]
v_cvt_pk_bf16_f32 v197, v198, v199
v_fma_f32 v200, v200, s27, -v248
v_mfma_f32_16x16x32_bf16 v[76:79], v[228:231], a[204:207], v[76:79]
ds_read_b64_tr_b16 a[232:233], v241 offset:16928
v_fma_f32 v201, v201, s27, -v248
v_mfma_f32_16x16x32_bf16 v[12:15], v[224:227], a[204:207], v[12:15]
s_waitcnt lgkmcnt(11)
ds_read_b64_tr_b16 a[234:235], v241 offset:17440
v_fma_f32 v202, v202, s27, -v248
v_mfma_f32_16x16x32_bf16 v[16:19], v[224:227], a[208:211], v[16:19]
v_exp_f32 v200, v200
v_mfma_f32_16x16x32_bf16 v[80:83], v[228:231], a[208:211], v[80:83]
ds_read_b64_tr_b16 a[236:237], v241 offset:16944
v_fma_f32 v203, v203, s27, -v248
v_mfma_f32_16x16x32_bf16 v[144:147], v[232:235], a[208:211], v[144:147]
s_waitcnt lgkmcnt(11)
v_exp_f32 v201, v201
v_mfma_f32_16x16x32_bf16 v[148:151], v[232:235], a[212:215], v[148:151]
ds_read_b64_tr_b16 a[238:239], v241 offset:17456
v_add_f32 v252, v252, v200
v_mfma_f32_16x16x32_bf16 v[84:87], v[228:231], a[212:215], v[84:87]
v_exp_f32 v202, v202
v_mfma_f32_16x16x32_bf16 v[20:23], v[224:227], a[212:215], v[20:23]
s_waitcnt lgkmcnt(10)
ds_read_b64_tr_b16 a[240:241], v241 offset:16960
v_add_f32 v252, v252, v201
v_mfma_f32_16x16x32_bf16 v[24:27], v[224:227], a[216:219], v[24:27]
ds_read_b64_tr_b16 a[242:243], v241 offset:17472
v_cvt_pk_bf16_f32 v200, v200, v201
v_mfma_f32_16x16x32_bf16 v[88:91], v[228:231], a[216:219], v[88:91]
v_exp_f32 v203, v203
v_mfma_f32_16x16x32_bf16 v[152:155], v[232:235], a[216:219], v[152:155]
s_waitcnt lgkmcnt(10)
ds_read_b64_tr_b16 a[244:245], v241 offset:16976
v_add_f32 v252, v252, v202
v_mfma_f32_16x16x32_bf16 v[156:159], v[232:235], a[220:223], v[156:159]
ds_read_b64_tr_b16 a[246:247], v241 offset:17488
v_add_f32 v252, v252, v203
v_mfma_f32_16x16x32_bf16 v[92:95], v[228:231], a[220:223], v[92:95]
ds_read_b64_tr_b16 a[248:249], v241 offset:16992
v_cvt_pk_bf16_f32 v201, v202, v203
v_mfma_f32_16x16x32_bf16 v[28:31], v[224:227], a[220:223], v[28:31]
s_waitcnt lgkmcnt(11)
v_fma_f32 v208, v208, s27, -v246
v_fma_f32 v209, v209, s27, -v246
v_mfma_f32_16x16x32_bf16 v[32:35], v[224:227], a[224:227], v[32:35]
v_exp_f32 v208, v208
v_mfma_f32_16x16x32_bf16 v[96:99], v[228:231], a[224:227], v[96:99]
ds_read_b64_tr_b16 a[250:251], v241 offset:17504
ds_read_b64_tr_b16 a[252:253], v241 offset:17008
v_mfma_f32_16x16x32_bf16 v[160:163], v[232:235], a[224:227], v[160:163]
s_waitcnt lgkmcnt(11)
v_fma_f32 v210, v210, s27, -v246
v_fma_f32 v211, v211, s27, -v246
v_mfma_f32_16x16x32_bf16 v[164:167], v[232:235], a[228:231], v[164:167]
v_exp_f32 v209, v209
v_mfma_f32_16x16x32_bf16 v[100:103], v[228:231], a[228:231], v[100:103]
ds_read_b64_tr_b16 a[254:255], v241 offset:17520
v_add_f32 v250, v250, v208
v_mfma_f32_16x16x32_bf16 v[36:39], v[224:227], a[228:231], v[36:39]
s_waitcnt lgkmcnt(10)
v_exp_f32 v210, v210
v_mfma_f32_16x16x32_bf16 v[40:43], v[224:227], a[232:235], v[40:43]
v_add_f32 v250, v250, v209
v_cvt_pk_bf16_f32 v194, v208, v209
v_mfma_f32_16x16x32_bf16 v[104:107], v[228:231], a[232:235], v[104:107]
v_exp_f32 v211, v211
v_mfma_f32_16x16x32_bf16 v[168:171], v[232:235], a[232:235], v[168:171]
s_waitcnt vmcnt(10) lgkmcnt(0)
v_add_f32 v250, v250, v210
v_add_f32 v250, v250, v211
v_mfma_f32_16x16x32_bf16 v[172:175], v[232:235], a[236:239], v[172:175]
s_barrier
v_mfma_f32_16x16x32_bf16 v[108:111], v[228:231], a[236:239], v[108:111]
s_add_u32 m0, s3, 53504
v_cvt_pk_bf16_f32 v195, v210, v211
v_fma_f32 v212, v212, s27, -v247
v_mfma_f32_16x16x32_bf16 v[44:47], v[224:227], a[236:239], v[44:47]
buffer_load_dwordx4 v242, s[16:19], s30 offen offset:0 lds
v_mfma_f32_16x16x32_bf16 v[48:51], v[224:227], a[240:243], v[48:51]
v_fma_f32 v213, v213, s27, -v247
v_fma_f32 v214, v214, s27, -v247
v_mfma_f32_16x16x32_bf16 v[112:115], v[228:231], a[240:243], v[112:115]
s_add_u32 m0, s3, 53520
v_exp_f32 v212, v212
v_mfma_f32_16x16x32_bf16 v[176:179], v[232:235], a[240:243], v[176:179]
buffer_load_dwordx4 v242, s[16:19], s30 offen offset:1024 lds
v_mfma_f32_16x16x32_bf16 v[180:183], v[232:235], a[244:247], v[180:183]
ds_read_b128 a[192:195], v240 offset:16896
v_fma_f32 v215, v215, s27, -v247
v_mfma_f32_16x16x32_bf16 v[116:119], v[228:231], a[244:247], v[116:119]
s_add_u32 m0, s3, 53536
v_exp_f32 v213, v213
v_mfma_f32_16x16x32_bf16 v[52:55], v[224:227], a[244:247], v[52:55]
buffer_load_dwordx4 v242, s[16:19], s30 offen offset:2048 lds
v_mfma_f32_16x16x32_bf16 v[56:59], v[224:227], a[248:251], v[56:59]
ds_read_b128 a[196:199], v240 offset:16960
ds_read_b128 a[200:203], v240 offset:17024
v_mfma_f32_16x16x32_bf16 v[120:123], v[228:231], a[248:251], v[120:123]
s_add_u32 m0, s3, 53552
ds_read_b128 a[204:207], v240 offset:17088
v_add_f32 v251, v251, v212
v_mfma_f32_16x16x32_bf16 v[184:187], v[232:235], a[248:251], v[184:187]
buffer_load_dwordx4 v242, s[16:19], s30 offen offset:3072 lds
v_mfma_f32_16x16x32_bf16 v[188:191], v[232:235], a[252:255], v[188:191]
s_add_u32 s30, s30, 16384
ds_read_b128 a[208:211], v240 offset:17152
ds_read_b128 a[212:215], v240 offset:17216
v_mfma_f32_16x16x32_bf16 v[124:127], v[228:231], a[252:255], v[124:127]
v_exp_f32 v214, v214
v_exp_f32 v215, v215
v_mfma_f32_16x16x32_bf16 v[60:63], v[224:227], a[252:255], v[60:63]
s_waitcnt lgkmcnt(5)
ds_read_b128 a[216:219], v240 offset:17280
ds_read_b128 a[220:223], v240 offset:17344
v_add_f32 v251, v251, v213
v_cvt_pk_bf16_f32 v198, v212, v213
v_add_f32 v251, v251, v214
v_add_f32 v251, v251, v215
v_cvt_pk_bf16_f32 v199, v214, v215
v_mfma_f32_16x16x32_bf16 v[224:227], a[192:195], a[0:3], 0
s_waitcnt lgkmcnt(6)
ds_read_b128 a[224:227], v240 offset:17408
v_fma_f32 v216, v216, s27, -v248
v_mfma_f32_16x16x32_bf16 v[224:227], a[196:199], a[4:7], v[224:227]
s_waitcnt lgkmcnt(6)
ds_read_b128 a[228:231], v240 offset:17472
v_fma_f32 v217, v217, s27, -v248
v_mfma_f32_16x16x32_bf16 v[224:227], a[200:203], a[8:11], v[224:227]
s_waitcnt lgkmcnt(6)
v_exp_f32 v216, v216
v_mfma_f32_16x16x32_bf16 v[224:227], a[204:207], a[12:15], v[224:227]
s_waitcnt lgkmcnt(5)
v_fma_f32 v218, v218, s27, -v248
v_fma_f32 v219, v219, s27, -v248
v_mfma_f32_16x16x32_bf16 v[224:227], a[208:211], a[16:19], v[224:227]
s_waitcnt lgkmcnt(4)
ds_read_b128 a[232:235], v240 offset:17536
v_add_f32 v252, v252, v216
v_mfma_f32_16x16x32_bf16 v[224:227], a[212:215], a[20:23], v[224:227]
s_waitcnt lgkmcnt(4)
v_exp_f32 v217, v217
v_mfma_f32_16x16x32_bf16 v[224:227], a[216:219], a[24:27], v[224:227]
s_waitcnt lgkmcnt(3)
v_exp_f32 v218, v218
v_mfma_f32_16x16x32_bf16 v[224:227], a[220:223], a[28:31], v[224:227]
ds_read_b128 a[236:239], v240 offset:17600
ds_read_b128 a[240:243], v240 offset:17664
v_mfma_f32_16x16x32_bf16 v[228:231], a[220:223], a[60:63], 0
v_add_f32 v252, v252, v217
v_cvt_pk_bf16_f32 v202, v216, v217
v_mfma_f32_16x16x32_bf16 v[228:231], a[216:219], a[56:59], v[228:231]
v_exp_f32 v219, v219
v_mfma_f32_16x16x32_bf16 v[228:231], a[212:215], a[52:55], v[228:231]
ds_read_b128 a[244:247], v240 offset:17728
v_add_f32 v252, v252, v218
v_mfma_f32_16x16x32_bf16 v[228:231], a[208:211], a[48:51], v[228:231]
v_add_f32 v252, v252, v219
v_cvt_pk_bf16_f32 v203, v218, v219
v_mfma_f32_16x16x32_bf16 v[228:231], a[204:207], a[44:47], v[228:231]
ds_read_b128 a[248:251], v240 offset:17792
v_fma_f32 v224, v224, s27, -v246
v_mfma_f32_16x16x32_bf16 v[228:231], a[200:203], a[40:43], v[228:231]
ds_read_b128 a[252:255], v240 offset:17856
v_fma_f32 v225, v225, s27, -v246
v_mfma_f32_16x16x32_bf16 v[228:231], a[196:199], a[36:39], v[228:231]
v_exp_f32 v224, v224
v_mfma_f32_16x16x32_bf16 v[228:231], a[192:195], a[32:35], v[228:231]
v_fma_f32 v226, v226, s27, -v246
v_fma_f32 v227, v227, s27, -v246
v_mfma_f32_16x16x32_bf16 v[232:235], a[192:195], a[64:67], 0
v_exp_f32 v225, v225
v_mfma_f32_16x16x32_bf16 v[232:235], a[196:199], a[68:71], v[232:235]
v_add_f32 v250, v250, v224
v_add_f32 v250, v250, v225
v_mfma_f32_16x16x32_bf16 v[232:235], a[200:203], a[72:75], v[232:235]
v_exp_f32 v226, v226
v_mfma_f32_16x16x32_bf16 v[232:235], a[204:207], a[76:79], v[232:235]
v_cvt_pk_bf16_f32 v224, v224, v225
v_add_f32 v250, v250, v226
v_mfma_f32_16x16x32_bf16 v[232:235], a[208:211], a[80:83], v[232:235]
v_exp_f32 v227, v227
v_mfma_f32_16x16x32_bf16 v[232:235], a[212:215], a[84:87], v[232:235]
v_add_f32 v250, v250, v227
v_cvt_pk_bf16_f32 v225, v226, v227
v_mfma_f32_16x16x32_bf16 v[232:235], a[216:219], a[88:91], v[232:235]
s_waitcnt vmcnt(10) lgkmcnt(0)
v_fma_f32 v228, v228, s27, -v247
v_fma_f32 v229, v229, s27, -v247
v_mfma_f32_16x16x32_bf16 v[232:235], a[220:223], a[92:95], v[232:235]
s_barrier
v_mfma_f32_16x16x32_bf16 v[208:211], a[224:227], a[0:3], 0
s_add_u32 m0, s26, 16896
v_exp_f32 v228, v228
v_mfma_f32_16x16x32_bf16 v[208:211], a[228:231], a[4:7], v[208:211]
buffer_load_dwordx4 v242, s[12:15], s29 offen offset:0 lds
v_mfma_f32_16x16x32_bf16 v[208:211], a[232:235], a[8:11], v[208:211]
v_fma_f32 v230, v230, s27, -v247
v_fma_f32 v231, v231, s27, -v247
v_mfma_f32_16x16x32_bf16 v[208:211], a[236:239], a[12:15], v[208:211]
v_exp_f32 v229, v229
v_mfma_f32_16x16x32_bf16 v[208:211], a[240:243], a[16:19], v[208:211]
s_add_u32 m0, s26, 16928
ds_read_b64_tr_b16 a[192:193], v241 offset:0
v_add_f32 v251, v251, v228
v_mfma_f32_16x16x32_bf16 v[208:211], a[244:247], a[20:23], v[208:211]
buffer_load_dwordx4 v242, s[12:15], s29 offen offset:1024 lds
v_mfma_f32_16x16x32_bf16 v[208:211], a[248:251], a[24:27], v[208:211]
v_exp_f32 v230, v230
v_mfma_f32_16x16x32_bf16 v[208:211], a[252:255], a[28:31], v[208:211]
ds_read_b64_tr_b16 a[194:195], v241 offset:512
v_add_f32 v251, v251, v229
v_mfma_f32_16x16x32_bf16 v[212:215], a[252:255], a[60:63], 0
s_waitcnt vmcnt(10)
s_add_u32 m0, s26, 16960
v_cvt_pk_bf16_f32 v228, v228, v229
v_mfma_f32_16x16x32_bf16 v[212:215], a[248:251], a[56:59], v[212:215]
buffer_load_dwordx4 v242, s[12:15], s29 offen offset:2048 lds
v_mfma_f32_16x16x32_bf16 v[212:215], a[244:247], a[52:55], v[212:215]
v_exp_f32 v231, v231
v_mfma_f32_16x16x32_bf16 v[212:215], a[240:243], a[48:51], v[212:215]
ds_read_b64_tr_b16 a[196:197], v241 offset:16
ds_read_b64_tr_b16 a[198:199], v241 offset:528
v_mfma_f32_16x16x32_bf16 v[212:215], a[236:239], a[44:47], v[212:215]
s_add_u32 m0, s26, 16992
v_add_f32 v251, v251, v230
v_add_f32 v251, v251, v231
v_mfma_f32_16x16x32_bf16 v[212:215], a[232:235], a[40:43], v[212:215]
buffer_load_dwordx4 v242, s[12:15], s29 offen offset:3072 lds
v_mfma_f32_16x16x32_bf16 v[212:215], a[228:231], a[36:39], v[212:215]
s_add_u32 s29, s29, 16384
ds_read_b64_tr_b16 a[200:201], v241 offset:32
v_cvt_pk_bf16_f32 v229, v230, v231
v_mfma_f32_16x16x32_bf16 v[212:215], a[224:227], a[32:35], v[212:215]
ds_read_b128 a[0:3], v255 offset:0
ds_read_b64_tr_b16 a[202:203], v241 offset:544
v_mfma_f32_16x16x32_bf16 v[216:219], a[224:227], a[64:67], 0
ds_read_b128 a[4:7], v255 offset:64
ds_read_b64_tr_b16 a[204:205], v241 offset:48
v_mfma_f32_16x16x32_bf16 v[216:219], a[228:231], a[68:71], v[216:219]
ds_read_b128 a[8:11], v255 offset:128
ds_read_b128 a[12:15], v255 offset:192
v_mfma_f32_16x16x32_bf16 v[216:219], a[232:235], a[72:75], v[216:219]
ds_read_b128 a[16:19], v255 offset:256
ds_read_b64_tr_b16 a[206:207], v241 offset:560
v_mfma_f32_16x16x32_bf16 v[216:219], a[236:239], a[76:79], v[216:219]
ds_read_b128 a[20:23], v255 offset:320
ds_read_b64_tr_b16 a[208:209], v241 offset:64
v_mfma_f32_16x16x32_bf16 v[216:219], a[240:243], a[80:83], v[216:219]
ds_read_b128 a[24:27], v255 offset:384
ds_read_b64_tr_b16 a[210:211], v241 offset:576
v_mfma_f32_16x16x32_bf16 v[216:219], a[244:247], a[84:87], v[216:219]
ds_read_b128 a[28:31], v255 offset:448
ds_read_b64_tr_b16 a[212:213], v241 offset:80
v_mfma_f32_16x16x32_bf16 v[216:219], a[248:251], a[88:91], v[216:219]
v_fma_f32 v232, v232, s27, -v248
v_fma_f32 v233, v233, s27, -v248
v_mfma_f32_16x16x32_bf16 v[216:219], a[252:255], a[92:95], v[216:219]
s_waitcnt lgkmcnt(15)
v_exp_f32 v232, v232
v_mfma_f32_16x16x32_bf16 v[0:3], v[192:195], a[192:195], v[0:3]
ds_read_b64_tr_b16 a[214:215], v241 offset:592
ds_read_b64_tr_b16 a[216:217], v241 offset:96
v_mfma_f32_16x16x32_bf16 v[64:67], v[196:199], a[192:195], v[64:67]
v_fma_f32 v234, v234, s27, -v248
v_fma_f32 v235, v235, s27, -v248
v_mfma_f32_16x16x32_bf16 v[128:131], v[200:203], a[192:195], v[128:131]
s_waitcnt lgkmcnt(15)
v_exp_f32 v233, v233
v_mfma_f32_16x16x32_bf16 v[132:135], v[200:203], a[196:199], v[132:135]
ds_read_b64_tr_b16 a[218:219], v241 offset:608
v_add_f32 v252, v252, v232
v_mfma_f32_16x16x32_bf16 v[68:71], v[196:199], a[196:199], v[68:71]
s_add_u32 s38, s36, 16384
v_exp_f32 v234, v234
v_mfma_f32_16x16x32_bf16 v[4:7], v[192:195], a[196:199], v[4:7]
s_waitcnt lgkmcnt(15)
ds_read_b64_tr_b16 a[220:221], v241 offset:112
v_add_f32 v252, v252, v233
v_mfma_f32_16x16x32_bf16 v[8:11], v[192:195], a[200:203], v[8:11]
s_add_u32 m0, s4, 0
ds_read_b64_tr_b16 a[222:223], v241 offset:624
v_cvt_pk_bf16_f32 v232, v232, v233
v_mfma_f32_16x16x32_bf16 v[72:75], v[196:199], a[200:203], v[72:75]
s_waitcnt lgkmcnt(6)
buffer_load_dwordx4 v243, s[8:11], s38 offen offset:0 nt lds
v_mfma_f32_16x16x32_bf16 v[136:139], v[200:203], a[200:203], v[136:139]
v_exp_f32 v235, v235
v_mfma_f32_16x16x32_bf16 v[140:143], v[200:203], a[204:207], v[140:143]
s_add_u32 m0, s4, 544
ds_read_b64_tr_b16 a[224:225], v241 offset:256
v_add_f32 v252, v252, v234
v_mfma_f32_16x16x32_bf16 v[76:79], v[196:199], a[204:207], v[76:79]
buffer_load_dwordx4 v243, s[8:11], s38 offen offset:512 nt lds
v_mfma_f32_16x16x32_bf16 v[12:15], v[192:195], a[204:207], v[12:15]
v_add_f32 v252, v252, v235
v_cvt_pk_bf16_f32 v233, v234, v235
v_mfma_f32_16x16x32_bf16 v[16:19], v[192:195], a[208:211], v[16:19]
s_add_u32 m0, s4, 1088
ds_read_b64_tr_b16 a[226:227], v241 offset:768
v_fma_f32 v208, v208, s27, -v246
v_mfma_f32_16x16x32_bf16 v[80:83], v[196:199], a[208:211], v[80:83]
buffer_load_dwordx4 v243, s[8:11], s38 offen offset:1024 nt lds
v_mfma_f32_16x16x32_bf16 v[144:147], v[200:203], a[208:211], v[144:147]
s_waitcnt lgkmcnt(6)
ds_read_b64_tr_b16 a[228:229], v241 offset:272
v_fma_f32 v209, v209, s27, -v246
v_mfma_f32_16x16x32_bf16 v[148:151], v[200:203], a[212:215], v[148:151]
s_add_u32 m0, s4, 1632
v_exp_f32 v208, v208
v_mfma_f32_16x16x32_bf16 v[84:87], v[196:199], a[212:215], v[84:87]
buffer_load_dwordx4 v243, s[8:11], s38 offen offset:1536 nt lds
v_mfma_f32_16x16x32_bf16 v[20:23], v[192:195], a[212:215], v[20:23]
s_waitcnt lgkmcnt(5)
ds_read_b64_tr_b16 a[230:231], v241 offset:784
v_fma_f32 v210, v210, s27, -v246
v_mfma_f32_16x16x32_bf16 v[24:27], v[192:195], a[216:219], v[24:27]
ds_read_b64_tr_b16 a[232:233], v241 offset:288
v_fma_f32 v211, v211, s27, -v246
v_mfma_f32_16x16x32_bf16 v[88:91], v[196:199], a[216:219], v[88:91]
s_add_u32 m0, s4, 2176
v_exp_f32 v209, v209
v_mfma_f32_16x16x32_bf16 v[152:155], v[200:203], a[216:219], v[152:155]
s_waitcnt lgkmcnt(5)
buffer_load_dwordx4 v243, s[8:11], s38 offen offset:2048 nt lds
v_mfma_f32_16x16x32_bf16 v[156:159], v[200:203], a[220:223], v[156:159]
ds_read_b64_tr_b16 a[234:235], v241 offset:800
v_add_f32 v250, v250, v208
v_mfma_f32_16x16x32_bf16 v[92:95], v[196:199], a[220:223], v[92:95]
s_add_u32 m0, s4, 2720
ds_read_b64_tr_b16 a[236:237], v241 offset:304
ds_read_b64_tr_b16 a[238:239], v241 offset:816
v_mfma_f32_16x16x32_bf16 v[28:31], v[192:195], a[220:223], v[28:31]
s_waitcnt lgkmcnt(6)
buffer_load_dwordx4 v243, s[8:11], s38 offen offset:2560 nt lds
v_mfma_f32_16x16x32_bf16 v[32:35], v[192:195], a[224:227], v[32:35]
v_exp_f32 v210, v210
v_mfma_f32_16x16x32_bf16 v[96:99], v[196:199], a[224:227], v[96:99]
s_add_u32 m0, s4, 3264
ds_read_b64_tr_b16 a[240:241], v241 offset:320
v_add_f32 v250, v250, v209
v_mfma_f32_16x16x32_bf16 v[160:163], v[200:203], a[224:227], v[160:163]
s_waitcnt lgkmcnt(5)
buffer_load_dwordx4 v243, s[8:11], s38 offen offset:3072 nt lds
v_mfma_f32_16x16x32_bf16 v[164:167], v[200:203], a[228:231], v[164:167]
ds_read_b64_tr_b16 a[242:243], v241 offset:832
v_cvt_pk_bf16_f32 v226, v208, v209
v_mfma_f32_16x16x32_bf16 v[100:103], v[196:199], a[228:231], v[100:103]
s_add_u32 m0, s4, 3808
v_exp_f32 v211, v211
v_mfma_f32_16x16x32_bf16 v[36:39], v[192:195], a[228:231], v[36:39]
s_waitcnt lgkmcnt(4)
buffer_load_dwordx4 v243, s[8:11], s38 offen offset:3584 nt lds
v_mfma_f32_16x16x32_bf16 v[40:43], v[192:195], a[232:235], v[40:43]
ds_read_b64_tr_b16 a[244:245], v241 offset:336
v_add_f32 v250, v250, v210
v_mfma_f32_16x16x32_bf16 v[104:107], v[196:199], a[232:235], v[104:107]
ds_read_b64_tr_b16 a[246:247], v241 offset:848
v_add_f32 v250, v250, v211
v_mfma_f32_16x16x32_bf16 v[168:171], v[200:203], a[232:235], v[168:171]
s_waitcnt lgkmcnt(4)
ds_read_b64_tr_b16 a[248:249], v241 offset:352
ds_read_b64_tr_b16 a[250:251], v241 offset:864
ds_read_b64_tr_b16 a[252:253], v241 offset:368
ds_read_b64_tr_b16 a[254:255], v241 offset:880
v_mfma_f32_16x16x32_bf16 v[172:175], v[200:203], a[236:239], v[172:175]
v_cvt_pk_bf16_f32 v227, v210, v211
v_fma_f32 v212, v212, s27, -v247
v_mfma_f32_16x16x32_bf16 v[108:111], v[196:199], a[236:239], v[108:111]
v_fma_f32 v213, v213, s27, -v247
v_fma_f32 v214, v214, s27, -v247
v_mfma_f32_16x16x32_bf16 v[44:47], v[192:195], a[236:239], v[44:47]
s_waitcnt vmcnt(12) lgkmcnt(0)
v_exp_f32 v212, v212
v_mfma_f32_16x16x32_bf16 v[48:51], v[192:195], a[240:243], v[48:51]
s_barrier
v_mfma_f32_16x16x32_bf16 v[112:115], v[196:199], a[240:243], v[112:115]
v_fma_f32 v215, v215, s27, -v247
v_add_f32 v251, v251, v212
v_mfma_f32_16x16x32_bf16 v[176:179], v[200:203], a[240:243], v[176:179]
v_exp_f32 v213, v213
v_mfma_f32_16x16x32_bf16 v[180:183], v[200:203], a[244:247], v[180:183]
v_exp_f32 v214, v214
v_mfma_f32_16x16x32_bf16 v[116:119], v[196:199], a[244:247], v[116:119]
v_add_f32 v251, v251, v213
v_cvt_pk_bf16_f32 v230, v212, v213
v_mfma_f32_16x16x32_bf16 v[52:55], v[192:195], a[244:247], v[52:55]
v_exp_f32 v215, v215
v_mfma_f32_16x16x32_bf16 v[56:59], v[192:195], a[248:251], v[56:59]
v_add_f32 v251, v251, v214
v_add_f32 v251, v251, v215
v_mfma_f32_16x16x32_bf16 v[120:123], v[196:199], a[248:251], v[120:123]
v_cvt_pk_bf16_f32 v231, v214, v215
v_fma_f32 v216, v216, s27, -v248
v_mfma_f32_16x16x32_bf16 v[184:187], v[200:203], a[248:251], v[184:187]
ds_read_b64_tr_b16 a[192:193], v241 offset:16640
v_fma_f32 v217, v217, s27, -v248
v_mfma_f32_16x16x32_bf16 v[188:191], v[200:203], a[252:255], v[188:191]
ds_read_b64_tr_b16 a[194:195], v241 offset:17152
v_fma_f32 v218, v218, s27, -v248
v_mfma_f32_16x16x32_bf16 v[124:127], v[196:199], a[252:255], v[124:127]
v_exp_f32 v216, v216
v_fma_f32 v219, v219, s27, -v248
v_exp_f32 v217, v217
v_exp_f32 v218, v218
v_exp_f32 v219, v219
v_mfma_f32_16x16x32_bf16 v[60:63], v[192:195], a[252:255], v[60:63]
ds_read_b64_tr_b16 a[196:197], v241 offset:16656
ds_read_b64_tr_b16 a[198:199], v241 offset:17168
ds_read_b64_tr_b16 a[200:201], v241 offset:16672
ds_read_b64_tr_b16 a[202:203], v241 offset:17184
ds_read_b64_tr_b16 a[204:205], v241 offset:16688
ds_read_b64_tr_b16 a[206:207], v241 offset:17200
v_add_f32 v252, v252, v216
v_add_f32 v252, v252, v217
v_cvt_pk_bf16_f32 v234, v216, v217
v_add_f32 v252, v252, v218
v_add_f32 v252, v252, v219
v_cvt_pk_bf16_f32 v235, v218, v219
L_last3:
s_waitcnt lgkmcnt(6)
v_mfma_f32_16x16x32_bf16 v[0:3], v[224:227], a[192:195], v[0:3]
s_mov_b32 s30, s32
ds_read_b128 a[32:35], v255 offset:8448
v_mov_b32 v192, 1.0
v_mfma_f32_16x16x32_bf16 v[64:67], v[228:231], a[192:195], v[64:67]
ds_read_b128 a[36:39], v255 offset:8512
ds_read_b64_tr_b16 a[208:209], v241 offset:16704
v_mfma_f32_16x16x32_bf16 v[128:131], v[232:235], a[192:195], v[128:131]
s_add_u32 m0, s3, 36864
ds_read_b128 a[40:43], v255 offset:8576
ds_read_b64_tr_b16 a[210:211], v241 offset:17216
v_mfma_f32_16x16x4_f32 v[208:211], v250, v192, 0
s_add_u32 s92, s34, 0
buffer_load_dwordx4 v242, s[16:19], s30 offen offset:0 lds
v_mfma_f32_16x16x4_f32 v[212:215], v251, v192, 0
s_add_u32 m0, s3, 36880
ds_read_b128 a[44:47], v255 offset:8640
ds_read_b64_tr_b16 a[212:213], v241 offset:16720
v_mfma_f32_16x16x4_f32 v[216:219], v252, v192, 0
s_waitcnt lgkmcnt(11)
buffer_load_dwordx4 v242, s[16:19], s30 offen offset:1024 lds
v_mfma_f32_16x16x32_bf16 v[132:135], v[232:235], a[196:199], v[132:135]
s_add_u32 s93, s34, 4096
ds_read_b128 a[48:51], v255 offset:8704
ds_read_b64_tr_b16 a[214:215], v241 offset:17232
v_mfma_f32_16x16x32_bf16 v[68:71], v[228:231], a[196:199], v[68:71]
s_add_u32 s94, s34, 8192
ds_read_b128 a[52:55], v255 offset:8768
ds_read_b128 a[56:59], v255 offset:8832
v_mfma_f32_16x16x32_bf16 v[4:7], v[224:227], a[196:199], v[4:7]
s_waitcnt lgkmcnt(13)
ds_read_b128 a[60:63], v255 offset:8896
ds_read_b64_tr_b16 a[216:217], v241 offset:16736
v_mfma_f32_16x16x32_bf16 v[8:11], v[224:227], a[200:203], v[8:11]
s_add_u32 m0, s3, 36896
v_max3_f32 v193, v208, v209, v210
v_max_f32 v193, v193, v211
v_mfma_f32_16x16x32_bf16 v[72:75], v[228:231], a[200:203], v[72:75]
s_add_u32 s95, s34, 12288
buffer_load_dwordx4 v242, s[16:19], s30 offen offset:2048 lds
v_mfma_f32_16x16x32_bf16 v[136:139], v[232:235], a[200:203], v[136:139]
s_waitcnt lgkmcnt(13)
v_rcp_f32 v208, v208
v_mfma_f32_16x16x32_bf16 v[140:143], v[232:235], a[204:207], v[140:143]
s_add_u32 m0, s3, 36912
v_rcp_f32 v209, v209
v_mfma_f32_16x16x32_bf16 v[76:79], v[228:231], a[204:207], v[76:79]
s_add_u32 s96, s34, 16384
buffer_load_dwordx4 v242, s[16:19], s30 offen offset:3072 lds
v_mfma_f32_16x16x32_bf16 v[12:15], v[224:227], a[204:207], v[12:15]
s_waitcnt lgkmcnt(8)
v_rcp_f32 v210, v210
v_mfma_f32_16x16x32_bf16 v[16:19], v[224:227], a[208:211], v[16:19]
s_add_u32 s97, s34, 20480
v_rcp_f32 v211, v211
v_mfma_f32_16x16x32_bf16 v[80:83], v[228:231], a[208:211], v[80:83]
s_mov_b32 s38, s37
s_add_u32 m0, s4, 8448
v_max3_f32 v193, v193, v212, v213
v_mfma_f32_16x16x32_bf16 v[144:147], v[232:235], a[208:211], v[144:147]
s_waitcnt lgkmcnt(1)
buffer_load_dwordx4 v243, s[8:11], s38 offen offset:0 nt lds
v_mfma_f32_16x16x32_bf16 v[148:151], v[232:235], a[212:215], v[148:151]
s_add_u32 s30, s30, 16384
ds_read_b64_tr_b16 a[218:219], v241 offset:17248
v_max3_f32 v193, v193, v214, v215
v_mfma_f32_16x16x32_bf16 v[84:87], v[228:231], a[212:215], v[84:87]
s_add_u32 m0, s4, 8992
v_rcp_f32 v212, v212
v_mfma_f32_16x16x32_bf16 v[20:23], v[224:227], a[212:215], v[20:23]
s_waitcnt lgkmcnt(0)
buffer_load_dwordx4 v243, s[8:11], s38 offen offset:512 nt lds
v_mfma_f32_16x16x32_bf16 v[24:27], v[224:227], a[216:219], v[24:27]
ds_read_b64_tr_b16 a[220:221], v241 offset:16752
ds_read_b64_tr_b16 a[222:223], v241 offset:17264
v_mfma_f32_16x16x32_bf16 v[88:91], v[228:231], a[216:219], v[88:91]
v_rcp_f32 v213, v213
v_mfma_f32_16x16x32_bf16 v[152:155], v[232:235], a[216:219], v[152:155]
s_waitcnt lgkmcnt(0)
v_rcp_f32 v214, v214
v_mfma_f32_16x16x32_bf16 v[156:159], v[232:235], a[220:223], v[156:159]
s_add_u32 m0, s4, 9536
ds_read_b64_tr_b16 a[224:225], v241 offset:16896
ds_read_b64_tr_b16 a[226:227], v241 offset:17408
v_mfma_f32_16x16x32_bf16 v[92:95], v[228:231], a[220:223], v[92:95]
buffer_load_dwordx4 v243, s[8:11], s38 offen offset:1024 nt lds
v_mfma_f32_16x16x32_bf16 v[28:31], v[224:227], a[220:223], v[28:31]
s_waitcnt lgkmcnt(0)
v_rcp_f32 v215, v215
v_mfma_f32_16x16x32_bf16 v[32:35], v[224:227], a[224:227], v[32:35]
ds_read_b64_tr_b16 a[228:229], v241 offset:16912
ds_read_b64_tr_b16 a[230:231], v241 offset:17424
v_mfma_f32_16x16x32_bf16 v[96:99], v[228:231], a[224:227], v[96:99]
s_add_u32 m0, s4, 10080
v_max3_f32 v193, v193, v216, v217
v_max3_f32 v193, v193, v218, v219
v_mfma_f32_16x16x32_bf16 v[160:163], v[232:235], a[224:227], v[160:163]
s_waitcnt lgkmcnt(0)
buffer_load_dwordx4 v243, s[8:11], s38 offen offset:1536 nt lds
v_mfma_f32_16x16x32_bf16 v[164:167], v[232:235], a[228:231], v[164:167]
ds_read_b64_tr_b16 a[232:233], v241 offset:16928
ds_read_b64_tr_b16 a[234:235], v241 offset:17440
v_mfma_f32_16x16x32_bf16 v[100:103], v[228:231], a[228:231], v[100:103]
s_add_u32 m0, s4, 10624
v_rcp_f32 v216, v216
v_mfma_f32_16x16x32_bf16 v[36:39], v[224:227], a[228:231], v[36:39]
s_waitcnt lgkmcnt(0)
buffer_load_dwordx4 v243, s[8:11], s38 offen offset:2048 nt lds
v_mfma_f32_16x16x32_bf16 v[40:43], v[224:227], a[232:235], v[40:43]
ds_read_b64_tr_b16 a[236:237], v241 offset:16944
ds_read_b64_tr_b16 a[238:239], v241 offset:17456
v_mfma_f32_16x16x32_bf16 v[104:107], v[228:231], a[232:235], v[104:107]
v_rcp_f32 v217, v217
v_mfma_f32_16x16x32_bf16 v[168:171], v[232:235], a[232:235], v[168:171]
s_waitcnt lgkmcnt(0)
v_rcp_f32 v218, v218
v_mfma_f32_16x16x32_bf16 v[172:175], v[232:235], a[236:239], v[172:175]
s_add_u32 m0, s4, 11168
ds_read_b64_tr_b16 a[240:241], v241 offset:16960
ds_read_b64_tr_b16 a[242:243], v241 offset:17472
v_mfma_f32_16x16x32_bf16 v[108:111], v[228:231], a[236:239], v[108:111]
buffer_load_dwordx4 v243, s[8:11], s38 offen offset:2560 nt lds
v_mfma_f32_16x16x32_bf16 v[44:47], v[224:227], a[236:239], v[44:47]
s_waitcnt lgkmcnt(0)
v_rcp_f32 v219, v219
v_mfma_f32_16x16x32_bf16 v[48:51], v[224:227], a[240:243], v[48:51]
s_add_u32 m0, s4, 11712
ds_read_b64_tr_b16 a[244:245], v241 offset:16976
ds_read_b64_tr_b16 a[246:247], v241 offset:17488
v_mfma_f32_16x16x32_bf16 v[112:115], v[228:231], a[240:243], v[112:115]
buffer_load_dwordx4 v243, s[8:11], s38 offen offset:3072 nt lds
v_mfma_f32_16x16x32_bf16 v[176:179], v[232:235], a[240:243], v[176:179]
s_waitcnt lgkmcnt(0)
ds_read_b64_tr_b16 a[248:249], v241 offset:16992
v_cmp_nge_f32 s[42:43], s28, v193
v_mfma_f32_16x16x32_bf16 v[180:183], v[232:235], a[244:247], v[180:183]
ds_read_b64_tr_b16 a[250:251], v241 offset:17504
ds_read_b64_tr_b16 a[252:253], v241 offset:17008
v_mfma_f32_16x16x32_bf16 v[116:119], v[228:231], a[244:247], v[116:119]
s_add_u32 m0, s4, 12256
ds_read_b64_tr_b16 a[254:255], v241 offset:17520
v_mfma_f32_16x16x32_bf16 v[52:55], v[224:227], a[244:247], v[52:55]
s_waitcnt lgkmcnt(2)
buffer_load_dwordx4 v243, s[8:11], s38 offen offset:3584 nt lds
v_mfma_f32_16x16x32_bf16 v[56:59], v[224:227], a[248:251], v[56:59]
v_mfma_f32_16x16x32_bf16 v[120:123], v[228:231], a[248:251], v[120:123]
v_mfma_f32_16x16x32_bf16 v[184:187], v[232:235], a[248:251], v[184:187]
s_waitcnt lgkmcnt(0)
v_mfma_f32_16x16x32_bf16 v[188:191], v[232:235], a[252:255], v[188:191]
v_mfma_f32_16x16x32_bf16 v[124:127], v[228:231], a[252:255], v[124:127]
v_mfma_f32_16x16x32_bf16 v[60:63], v[224:227], a[252:255], v[60:63]
s_cmp_ge_u32 s24, 4
s_cbranch_scc1 L_fin3
v_pk_mul_f32 v[0:1], v[0:1], v[208:209]
v_pk_mul_f32 v[2:3], v[2:3], v[210:211]
v_pk_mul_f32 v[4:5], v[4:5], v[208:209]
v_pk_mul_f32 v[6:7], v[6:7], v[210:211]
v_pk_mul_f32 v[8:9], v[8:9], v[208:209]
v_pk_mul_f32 v[10:11], v[10:11], v[210:211]
v_pk_mul_f32 v[12:13], v[12:13], v[208:209]
v_pk_mul_f32 v[14:15], v[14:15], v[210:211]
v_cvt_pk_bf16_f32 v0, v0, v4
v_cvt_pk_bf16_f32 v4, v2, v6
v_cvt_pk_bf16_f32 v2, v1, v5
v_cvt_pk_bf16_f32 v6, v3, v7
v_cvt_pk_bf16_f32 v1, v8, v12
v_cvt_pk_bf16_f32 v3, v9, v13
v_cvt_pk_bf16_f32 v5, v10, v14
v_cvt_pk_bf16_f32 v7, v11, v15
ds_write_b64 v245, v[0:1] offset:0
ds_write_b64 v245, v[2:3] offset:288
v_pk_mul_f32 v[16:17], v[16:17], v[208:209]
v_pk_mul_f32 v[18:19], v[18:19], v[210:211]
ds_write_b64 v245, v[4:5] offset:576
v_pk_mul_f32 v[20:21], v[20:21], v[208:209]
v_pk_mul_f32 v[22:23], v[22:23], v[210:211]
v_pk_mul_f32 v[24:25], v[24:25], v[208:209]
v_pk_mul_f32 v[26:27], v[26:27], v[210:211]
v_pk_mul_f32 v[28:29], v[28:29], v[208:209]
ds_write_b64 v245, v[6:7] offset:864
v_pk_mul_f32 v[30:31], v[30:31], v[210:211]
v_cvt_pk_bf16_f32 v16, v16, v20
v_cvt_pk_bf16_f32 v20, v18, v22
v_cvt_pk_bf16_f32 v18, v17, v21
v_cvt_pk_bf16_f32 v22, v19, v23
v_cvt_pk_bf16_f32 v17, v24, v28
v_cvt_pk_bf16_f32 v19, v25, v29
v_cvt_pk_bf16_f32 v21, v26, v30
v_cvt_pk_bf16_f32 v23, v27, v31
ds_write_b64 v245, v[16:17] offset:128
v_pk_mul_f32 v[64:65], v[64:65], v[212:213]
ds_write_b64 v245, v[18:19] offset:416
v_pk_mul_f32 v[66:67], v[66:67], v[214:215]
v_pk_mul_f32 v[68:69], v[68:69], v[212:213]
v_pk_mul_f32 v[70:71], v[70:71], v[214:215]
v_pk_mul_f32 v[72:73], v[72:73], v[212:213]
ds_write_b64 v245, v[20:21] offset:704
v_pk_mul_f32 v[74:75], v[74:75], v[214:215]
v_pk_mul_f32 v[76:77], v[76:77], v[212:213]
v_pk_mul_f32 v[78:79], v[78:79], v[214:215]
v_cvt_pk_bf16_f32 v64, v64, v68
v_cvt_pk_bf16_f32 v68, v66, v70
ds_write_b64 v245, v[22:23] offset:992
v_cvt_pk_bf16_f32 v66, v65, v69
v_cvt_pk_bf16_f32 v70, v67, v71
v_cvt_pk_bf16_f32 v65, v72, v76
v_cvt_pk_bf16_f32 v67, v73, v77
v_cvt_pk_bf16_f32 v69, v74, v78
ds_read_b64_tr_b16 v[0:1], v254 offset:0
ds_read_b64_tr_b16 v[2:3], v254 offset:32
ds_read_b64_tr_b16 v[4:5], v254 offset:1152
v_cvt_pk_bf16_f32 v71, v75, v79
ds_read_b64_tr_b16 v[6:7], v254 offset:1184
ds_read_b64_tr_b16 v[8:9], v254 offset:2304
ds_read_b64_tr_b16 v[10:11], v254 offset:2336
ds_read_b64_tr_b16 v[12:13], v254 offset:3456
v_pk_mul_f32 v[80:81], v[80:81], v[212:213]
ds_read_b64_tr_b16 v[14:15], v254 offset:3488
ds_write_b64 v245, v[64:65] offset:0
v_pk_mul_f32 v[82:83], v[82:83], v[214:215]
v_pk_mul_f32 v[84:85], v[84:85], v[212:213]
v_pk_mul_f32 v[86:87], v[86:87], v[214:215]
v_pk_mul_f32 v[88:89], v[88:89], v[212:213]
v_pk_mul_f32 v[90:91], v[90:91], v[214:215]
ds_write_b64 v245, v[66:67] offset:288
s_waitcnt lgkmcnt(8)
buffer_store_dwordx4 v[0:3], v244, s[20:23], s92 offen offset:0
v_pk_mul_f32 v[92:93], v[92:93], v[212:213]
v_pk_mul_f32 v[94:95], v[94:95], v[214:215]
v_cvt_pk_bf16_f32 v80, v80, v84
ds_write_b64 v245, v[68:69] offset:576
v_cvt_pk_bf16_f32 v84, v82, v86
v_cvt_pk_bf16_f32 v82, v81, v85
s_waitcnt lgkmcnt(7)
buffer_store_dwordx4 v[4:7], v244, s[20:23], s92 offen offset:2048
ds_write_b64 v245, v[70:71] offset:864
v_cvt_pk_bf16_f32 v86, v83, v87
v_cvt_pk_bf16_f32 v81, v88, v92
v_cvt_pk_bf16_f32 v83, v89, v93
v_cvt_pk_bf16_f32 v85, v90, v94
v_cvt_pk_bf16_f32 v87, v91, v95
ds_write_b64 v245, v[80:81] offset:128
s_waitcnt lgkmcnt(7)
buffer_store_dwordx4 v[8:11], v244, s[20:23], s93 offen offset:0
v_pk_mul_f32 v[128:129], v[128:129], v[216:217]
v_pk_mul_f32 v[130:131], v[130:131], v[218:219]
v_pk_mul_f32 v[132:133], v[132:133], v[216:217]
ds_write_b64 v245, v[82:83] offset:416
v_pk_mul_f32 v[134:135], v[134:135], v[218:219]
v_pk_mul_f32 v[136:137], v[136:137], v[216:217]
v_pk_mul_f32 v[138:139], v[138:139], v[218:219]
s_waitcnt lgkmcnt(6)
buffer_store_dwordx4 v[12:15], v244, s[20:23], s93 offen offset:2048
ds_write_b64 v245, v[84:85] offset:704
v_pk_mul_f32 v[140:141], v[140:141], v[216:217]
v_pk_mul_f32 v[142:143], v[142:143], v[218:219]
v_cvt_pk_bf16_f32 v128, v128, v132
v_cvt_pk_bf16_f32 v132, v130, v134
ds_write_b64 v245, v[86:87] offset:992
v_cvt_pk_bf16_f32 v130, v129, v133
v_cvt_pk_bf16_f32 v134, v131, v135
v_cvt_pk_bf16_f32 v129, v136, v140
v_cvt_pk_bf16_f32 v131, v137, v141
v_cvt_pk_bf16_f32 v133, v138, v142
ds_read_b64_tr_b16 v[64:65], v254 offset:0
ds_read_b64_tr_b16 v[66:67], v254 offset:32
ds_read_b64_tr_b16 v[68:69], v254 offset:1152
ds_read_b64_tr_b16 v[70:71], v254 offset:1184
v_cvt_pk_bf16_f32 v135, v139, v143
ds_read_b64_tr_b16 v[72:73], v254 offset:2304
ds_read_b64_tr_b16 v[74:75], v254 offset:2336
ds_read_b64_tr_b16 v[76:77], v254 offset:3456
v_pk_mul_f32 v[144:145], v[144:145], v[216:217]
ds_read_b64_tr_b16 v[78:79], v254 offset:3488
ds_write_b64 v245, v[128:129] offset:0
v_pk_mul_f32 v[146:147], v[146:147], v[218:219]
v_pk_mul_f32 v[148:149], v[148:149], v[216:217]
v_pk_mul_f32 v[150:151], v[150:151], v[218:219]
v_pk_mul_f32 v[152:153], v[152:153], v[216:217]
v_pk_mul_f32 v[154:155], v[154:155], v[218:219]
ds_write_b64 v245, v[130:131] offset:288
s_waitcnt lgkmcnt(8)
buffer_store_dwordx4 v[64:67], v244, s[20:23], s94 offen offset:0
v_pk_mul_f32 v[156:157], v[156:157], v[216:217]
v_pk_mul_f32 v[158:159], v[158:159], v[218:219]
v_cvt_pk_bf16_f32 v144, v144, v148
ds_write_b64 v245, v[132:133] offset:576
v_cvt_pk_bf16_f32 v148, v146, v150
v_cvt_pk_bf16_f32 v146, v145, v149
s_waitcnt lgkmcnt(7)
buffer_store_dwordx4 v[68:71], v244, s[20:23], s94 offen offset:2048
ds_write_b64 v245, v[134:135] offset:864
v_cvt_pk_bf16_f32 v150, v147, v151
v_cvt_pk_bf16_f32 v145, v152, v156
v_cvt_pk_bf16_f32 v147, v153, v157
v_cvt_pk_bf16_f32 v149, v154, v158
v_cvt_pk_bf16_f32 v151, v155, v159
ds_write_b64 v245, v[144:145] offset:128
s_waitcnt lgkmcnt(7)
buffer_store_dwordx4 v[72:75], v244, s[20:23], s95 offen offset:0
v_pk_mul_f32 v[32:33], v[32:33], v[208:209]
v_pk_mul_f32 v[34:35], v[34:35], v[210:211]
ds_write_b64 v245, v[146:147] offset:416
v_pk_mul_f32 v[36:37], v[36:37], v[208:209]
v_pk_mul_f32 v[38:39], v[38:39], v[210:211]
v_pk_mul_f32 v[40:41], v[40:41], v[208:209]
v_pk_mul_f32 v[42:43], v[42:43], v[210:211]
s_waitcnt lgkmcnt(6)
buffer_store_dwordx4 v[76:79], v244, s[20:23], s95 offen offset:2048
ds_write_b64 v245, v[148:149] offset:704
v_pk_mul_f32 v[44:45], v[44:45], v[208:209]
v_pk_mul_f32 v[46:47], v[46:47], v[210:211]
v_cvt_pk_bf16_f32 v32, v32, v36
v_cvt_pk_bf16_f32 v36, v34, v38
ds_write_b64 v245, v[150:151] offset:992
v_cvt_pk_bf16_f32 v34, v33, v37
v_cvt_pk_bf16_f32 v38, v35, v39
v_cvt_pk_bf16_f32 v33, v40, v44
v_cvt_pk_bf16_f32 v35, v41, v45
ds_read_b64_tr_b16 v[128:129], v254 offset:0
ds_read_b64_tr_b16 v[130:131], v254 offset:32
ds_read_b64_tr_b16 v[132:133], v254 offset:1152
v_cvt_pk_bf16_f32 v37, v42, v46
ds_read_b64_tr_b16 v[134:135], v254 offset:1184
ds_read_b64_tr_b16 v[136:137], v254 offset:2304
ds_read_b64_tr_b16 v[138:139], v254 offset:2336
v_cvt_pk_bf16_f32 v39, v43, v47
ds_read_b64_tr_b16 v[140:141], v254 offset:3456
ds_read_b64_tr_b16 v[142:143], v254 offset:3488
ds_write_b64 v245, v[32:33] offset:0
v_pk_mul_f32 v[48:49], v[48:49], v[208:209]
v_pk_mul_f32 v[50:51], v[50:51], v[210:211]
v_pk_mul_f32 v[52:53], v[52:53], v[208:209]
v_pk_mul_f32 v[54:55], v[54:55], v[210:211]
v_pk_mul_f32 v[56:57], v[56:57], v[208:209]
v_pk_mul_f32 v[58:59], v[58:59], v[210:211]
ds_write_b64 v245, v[34:35] offset:288
s_waitcnt lgkmcnt(8)
buffer_store_dwordx4 v[128:131], v244, s[20:23], s96 offen offset:0
v_pk_mul_f32 v[60:61], v[60:61], v[208:209]
v_pk_mul_f32 v[62:63], v[62:63], v[210:211]
ds_write_b64 v245, v[36:37] offset:576
v_cvt_pk_bf16_f32 v48, v48, v52
v_cvt_pk_bf16_f32 v52, v50, v54
v_cvt_pk_bf16_f32 v50, v49, v53
s_waitcnt lgkmcnt(7)
buffer_store_dwordx4 v[132:135], v244, s[20:23], s96 offen offset:2048
ds_write_b64 v245, v[38:39] offset:864
v_cvt_pk_bf16_f32 v54, v51, v55
v_cvt_pk_bf16_f32 v49, v56, v60
v_cvt_pk_bf16_f32 v51, v57, v61
v_cvt_pk_bf16_f32 v53, v58, v62
v_cvt_pk_bf16_f32 v55, v59, v63
ds_write_b64 v245, v[48:49] offset:128
s_waitcnt lgkmcnt(7)
buffer_store_dwordx4 v[136:139], v244, s[20:23], s97 offen offset:0
v_pk_mul_f32 v[96:97], v[96:97], v[212:213]
v_pk_mul_f32 v[98:99], v[98:99], v[214:215]
ds_write_b64 v245, v[50:51] offset:416
v_pk_mul_f32 v[100:101], v[100:101], v[212:213]
v_pk_mul_f32 v[102:103], v[102:103], v[214:215]
v_pk_mul_f32 v[104:105], v[104:105], v[212:213]
v_pk_mul_f32 v[106:107], v[106:107], v[214:215]
s_waitcnt lgkmcnt(6)
buffer_store_dwordx4 v[140:143], v244, s[20:23], s97 offen offset:2048
ds_write_b64 v245, v[52:53] offset:704
v_pk_mul_f32 v[108:109], v[108:109], v[212:213]
v_pk_mul_f32 v[110:111], v[110:111], v[214:215]
v_cvt_pk_bf16_f32 v96, v96, v100
ds_write_b64 v245, v[54:55] offset:992
v_cvt_pk_bf16_f32 v100, v98, v102
v_cvt_pk_bf16_f32 v98, v97, v101
v_cvt_pk_bf16_f32 v102, v99, v103
v_cvt_pk_bf16_f32 v97, v104, v108
v_cvt_pk_bf16_f32 v99, v105, v109
ds_read_b64_tr_b16 v[32:33], v254 offset:0
ds_read_b64_tr_b16 v[34:35], v254 offset:32
ds_read_b64_tr_b16 v[36:37], v254 offset:1152
v_cvt_pk_bf16_f32 v101, v106, v110
ds_read_b64_tr_b16 v[38:39], v254 offset:1184
ds_read_b64_tr_b16 v[40:41], v254 offset:2304
ds_read_b64_tr_b16 v[42:43], v254 offset:2336
v_cvt_pk_bf16_f32 v103, v107, v111
ds_read_b64_tr_b16 v[44:45], v254 offset:3456
ds_read_b64_tr_b16 v[46:47], v254 offset:3488
ds_write_b64 v245, v[96:97] offset:0
v_pk_mul_f32 v[112:113], v[112:113], v[212:213]
v_pk_mul_f32 v[114:115], v[114:115], v[214:215]
v_pk_mul_f32 v[116:117], v[116:117], v[212:213]
v_pk_mul_f32 v[118:119], v[118:119], v[214:215]
v_pk_mul_f32 v[120:121], v[120:121], v[212:213]
v_pk_mul_f32 v[122:123], v[122:123], v[214:215]
ds_write_b64 v245, v[98:99] offset:288
s_waitcnt lgkmcnt(8)
buffer_store_dwordx4 v[32:35], v244, s[20:23], s92 offen offset:256
v_pk_mul_f32 v[124:125], v[124:125], v[212:213]
v_pk_mul_f32 v[126:127], v[126:127], v[214:215]
ds_write_b64 v245, v[100:101] offset:576
v_cvt_pk_bf16_f32 v112, v112, v116
v_cvt_pk_bf16_f32 v116, v114, v118
v_cvt_pk_bf16_f32 v114, v113, v117
s_waitcnt lgkmcnt(7)
buffer_store_dwordx4 v[36:39], v244, s[20:23], s92 offen offset:2304
ds_write_b64 v245, v[102:103] offset:864
v_cvt_pk_bf16_f32 v118, v115, v119
v_cvt_pk_bf16_f32 v113, v120, v124
v_cvt_pk_bf16_f32 v115, v121, v125
v_cvt_pk_bf16_f32 v117, v122, v126
v_cvt_pk_bf16_f32 v119, v123, v127
ds_write_b64 v245, v[112:113] offset:128
s_waitcnt lgkmcnt(7)
buffer_store_dwordx4 v[40:43], v244, s[20:23], s93 offen offset:256
v_pk_mul_f32 v[160:161], v[160:161], v[216:217]
v_pk_mul_f32 v[162:163], v[162:163], v[218:219]
ds_write_b64 v245, v[114:115] offset:416
v_pk_mul_f32 v[164:165], v[164:165], v[216:217]
v_pk_mul_f32 v[166:167], v[166:167], v[218:219]
v_pk_mul_f32 v[168:169], v[168:169], v[216:217]
v_pk_mul_f32 v[170:171], v[170:171], v[218:219]
s_waitcnt lgkmcnt(6)
buffer_store_dwordx4 v[44:47], v244, s[20:23], s93 offen offset:2304
ds_write_b64 v245, v[116:117] offset:704
v_pk_mul_f32 v[172:173], v[172:173], v[216:217]
v_pk_mul_f32 v[174:175], v[174:175], v[218:219]
v_cvt_pk_bf16_f32 v160, v160, v164
ds_write_b64 v245, v[118:119] offset:992
v_cvt_pk_bf16_f32 v164, v162, v166
v_cvt_pk_bf16_f32 v162, v161, v165
v_cvt_pk_bf16_f32 v166, v163, v167
v_cvt_pk_bf16_f32 v161, v168, v172
v_cvt_pk_bf16_f32 v163, v169, v173
ds_read_b64_tr_b16 v[96:97], v254 offset:0
ds_read_b64_tr_b16 v[98:99], v254 offset:32
ds_read_b64_tr_b16 v[100:101], v254 offset:1152
v_cvt_pk_bf16_f32 v165, v170, v174
ds_read_b64_tr_b16 v[102:103], v254 offset:1184
ds_read_b64_tr_b16 v[104:105], v254 offset:2304
ds_read_b64_tr_b16 v[106:107], v254 offset:2336
ds_read_b64_tr_b16 v[108:109], v254 offset:3456
v_cvt_pk_bf16_f32 v167, v171, v175
ds_read_b64_tr_b16 v[110:111], v254 offset:3488
ds_write_b64 v245, v[160:161] offset:0
v_pk_mul_f32 v[176:177], v[176:177], v[216:217]
v_pk_mul_f32 v[178:179], v[178:179], v[218:219]
v_pk_mul_f32 v[180:181], v[180:181], v[216:217]
v_pk_mul_f32 v[182:183], v[182:183], v[218:219]
v_pk_mul_f32 v[184:185], v[184:185], v[216:217]
ds_write_b64 v245, v[162:163] offset:288
s_waitcnt lgkmcnt(8)
buffer_store_dwordx4 v[96:99], v244, s[20:23], s94 offen offset:256
v_pk_mul_f32 v[186:187], v[186:187], v[218:219]
v_pk_mul_f32 v[188:189], v[188:189], v[216:217]
v_pk_mul_f32 v[190:191], v[190:191], v[218:219]
ds_write_b64 v245, v[164:165] offset:576
v_cvt_pk_bf16_f32 v176, v176, v180
v_cvt_pk_bf16_f32 v180, v178, v182
s_waitcnt lgkmcnt(7)
buffer_store_dwordx4 v[100:103], v244, s[20:23], s94 offen offset:2304
ds_write_b64 v245, v[166:167] offset:864
v_cvt_pk_bf16_f32 v178, v177, v181
v_cvt_pk_bf16_f32 v182, v179, v183
v_cvt_pk_bf16_f32 v177, v184, v188
v_cvt_pk_bf16_f32 v179, v185, v189
v_cvt_pk_bf16_f32 v181, v186, v190
v_cvt_pk_bf16_f32 v183, v187, v191
ds_write_b64 v245, v[176:177] offset:128
s_waitcnt lgkmcnt(7)
buffer_store_dwordx4 v[104:107], v244, s[20:23], s95 offen offset:256
ds_write_b64 v245, v[178:179] offset:416
s_waitcnt lgkmcnt(6)
buffer_store_dwordx4 v[108:111], v244, s[20:23], s95 offen offset:2304
ds_write_b64 v245, v[180:181] offset:704
ds_write_b64 v245, v[182:183] offset:992
ds_read_b64_tr_b16 v[160:161], v254 offset:0
ds_read_b64_tr_b16 v[162:163], v254 offset:32
ds_read_b64_tr_b16 v[164:165], v254 offset:1152
ds_read_b64_tr_b16 v[166:167], v254 offset:1184
ds_read_b64_tr_b16 v[168:169], v254 offset:2304
ds_read_b64_tr_b16 v[170:171], v254 offset:2336
ds_read_b64_tr_b16 v[172:173], v254 offset:3456
ds_read_b64_tr_b16 v[174:175], v254 offset:3488
s_waitcnt lgkmcnt(6)
buffer_store_dwordx4 v[160:163], v244, s[20:23], s96 offen offset:256
s_waitcnt lgkmcnt(4)
buffer_store_dwordx4 v[164:167], v244, s[20:23], s96 offen offset:2304
s_waitcnt lgkmcnt(2)
buffer_store_dwordx4 v[168:171], v244, s[20:23], s97 offen offset:256
s_waitcnt lgkmcnt(0)
buffer_store_dwordx4 v[172:175], v244, s[20:23], s97 offen offset:2304
s_waitcnt vmcnt(24)
ds_read_b128 a[192:195], v240 offset:0
ds_read_b128 a[196:199], v240 offset:64
ds_read_b128 a[200:203], v240 offset:128
ds_read_b128 a[204:207], v240 offset:192
ds_read_b128 a[208:211], v240 offset:256
ds_read_b128 a[212:215], v240 offset:320
ds_read_b128 a[216:219], v240 offset:384
ds_read_b128 a[220:223], v240 offset:448
s_waitcnt lgkmcnt(8)
s_cmp_lg_u64 s[42:43], 0
s_cbranch_scc1 L_slow
L_next:
s_mov_b64 vcc, 0
s_cmp_lt_u32 s24, 4
s_cbranch_scc1 L_blk
L_end:
s_endpgm
L_blkq:
s_waitcnt lgkmcnt(7)
v_mfma_f32_16x16x32_bf16 v[192:195], a[192:195], a[0:3], 0
s_waitcnt lgkmcnt(6)
ds_read_b128 a[252:255], v240 offset:960
ds_read_b128 a[248:251], v240 offset:896
v_mfma_f32_16x16x32_bf16 v[192:195], a[196:199], a[4:7], v[192:195]
s_waitcnt lgkmcnt(7)
ds_read_b128 a[244:247], v240 offset:832
ds_read_b128 a[240:243], v240 offset:768
v_mfma_f32_16x16x32_bf16 v[192:195], a[200:203], a[8:11], v[192:195]
s_waitcnt lgkmcnt(8)
ds_read_b128 a[236:239], v240 offset:704
ds_read_b128 a[232:235], v240 offset:640
v_mfma_f32_16x16x32_bf16 v[192:195], a[204:207], a[12:15], v[192:195]
s_waitcnt lgkmcnt(9)
ds_read_b128 a[228:231], v240 offset:576
ds_read_b128 a[224:227], v240 offset:512
v_mfma_f32_16x16x32_bf16 v[192:195], a[208:211], a[16:19], v[192:195]
s_waitcnt lgkmcnt(10)
v_mov_b32 v250, 0
v_mov_b32 v251, 0
v_mfma_f32_16x16x32_bf16 v[192:195], a[212:215], a[20:23], v[192:195]
s_waitcnt lgkmcnt(9)
v_mov_b32 v252, 0
v_mov_b32 v253, 0
v_mfma_f32_16x16x32_bf16 v[192:195], a[216:219], a[24:27], v[192:195]
s_waitcnt lgkmcnt(8)
v_mfma_f32_16x16x32_bf16 v[192:195], a[220:223], a[28:31], v[192:195]
s_waitcnt lgkmcnt(7)
v_mfma_f32_16x16x32_bf16 v[208:211], a[252:255], a[28:31], 0
s_waitcnt lgkmcnt(6)
v_mfma_f32_16x16x32_bf16 v[208:211], a[248:251], a[24:27], v[208:211]
s_waitcnt lgkmcnt(5)
v_mfma_f32_16x16x32_bf16 v[208:211], a[244:247], a[20:23], v[208:211]
s_cbranch_vccz L_cw8
s_waitcnt vmcnt(20)
L_cw8:
s_waitcnt lgkmcnt(4)
v_mfma_f32_16x16x32_bf16 v[208:211], a[240:243], a[16:19], v[208:211]
s_waitcnt lgkmcnt(0)
v_max3_f32 v246, v192, v193, v194
v_max_f32 v246, v246, v195
v_mfma_f32_16x16x32_bf16 v[208:211], a[236:239], a[12:15], v[208:211]
s_barrier
v_mfma_f32_16x16x32_bf16 v[208:211], a[232:235], a[8:11], v[208:211]
s_add_u32 m0, s26, 0
v_mov_b32 v224, v246
v_mfma_f32_16x16x32_bf16 v[208:211], a[228:231], a[4:7], v[208:211]
buffer_load_dwordx4 v242, s[12:15], s29 offen offset:0 lds
v_mfma_f32_16x16x32_bf16 v[208:211], a[224:227], a[0:3], v[208:211]
v_permlane32_swap_b32 v246, v224
v_mfma_f32_16x16x32_bf16 v[212:215], a[224:227], a[32:35], 0
v_max_f32 v246, v246, v224
v_mov_b32 v224, v246
v_mfma_f32_16x16x32_bf16 v[212:215], a[228:231], a[36:39], v[212:215]
s_add_u32 m0, s26, 32
v_permlane16_swap_b32 v246, v224
v_mfma_f32_16x16x32_bf16 v[212:215], a[232:235], a[40:43], v[212:215]
buffer_load_dwordx4 v242, s[12:15], s29 offen offset:1024 lds
v_mfma_f32_16x16x32_bf16 v[212:215], a[236:239], a[44:47], v[212:215]
v_max_f32 v246, v246, v224
v_mul_f32 v246, s27, v246
v_mfma_f32_16x16x32_bf16 v[212:215], a[240:243], a[48:51], v[212:215]
s_cbranch_vccz L_cw9
s_waitcnt vmcnt(14)
L_cw9:
v_fma_f32 v192, v192, s27, -v246
v_fma_f32 v193, v193, s27, -v246
v_mfma_f32_16x16x32_bf16 v[212:215], a[244:247], a[52:55], v[212:215]
v_exp_f32 v192, v192
v_mfma_f32_16x16x32_bf16 v[212:215], a[248:251], a[56:59], v[212:215]
v_fma_f32 v194, v194, s27, -v246
v_fma_f32 v195, v195, s27, -v246
v_mfma_f32_16x16x32_bf16 v[212:215], a[252:255], a[60:63], v[212:215]
s_add_u32 m0, s26, 64
v_exp_f32 v193, v193
v_mfma_f32_16x16x32_bf16 v[196:199], a[220:223], a[60:63], 0
buffer_load_dwordx4 v242, s[12:15], s29 offen offset:2048 lds
v_mfma_f32_16x16x32_bf16 v[196:199], a[216:219], a[56:59], v[196:199]
v_add_f32 v250, v250, v192
v_add_f32 v250, v250, v193
v_mfma_f32_16x16x32_bf16 v[196:199], a[212:215], a[52:55], v[196:199]
v_exp_f32 v194, v194
v_mfma_f32_16x16x32_bf16 v[196:199], a[208:211], a[48:51], v[196:199]
s_add_u32 m0, s26, 96
v_cvt_pk_bf16_f32 v192, v192, v193
v_add_f32 v250, v250, v194
v_mfma_f32_16x16x32_bf16 v[196:199], a[204:207], a[44:47], v[196:199]
ds_read_b128 a[64:67], v255 offset:0
buffer_load_dwordx4 v242, s[12:15], s29 offen offset:3072 lds
v_mfma_f32_16x16x32_bf16 v[196:199], a[200:203], a[40:43], v[196:199]
s_add_u32 s29, s29, 16384
ds_read_b128 a[68:71], v255 offset:64
v_fma_f32 v208, v208, s27, -v246
v_mfma_f32_16x16x32_bf16 v[196:199], a[196:199], a[36:39], v[196:199]
ds_read_b128 a[72:75], v255 offset:128
v_fma_f32 v209, v209, s27, -v246
v_mfma_f32_16x16x32_bf16 v[196:199], a[192:195], a[32:35], v[196:199]
s_waitcnt lgkmcnt(2)
ds_read_b128 a[76:79], v255 offset:192
v_fma_f32 v210, v210, s27, -v246
v_mfma_f32_16x16x32_bf16 v[200:203], a[192:195], a[64:67], 0
s_waitcnt lgkmcnt(2)
ds_read_b128 a[80:83], v255 offset:256
v_fma_f32 v211, v211, s27, -v246
v_mfma_f32_16x16x32_bf16 v[200:203], a[196:199], a[68:71], v[200:203]
s_waitcnt lgkmcnt(2)
s_add_u32 m0, s3, 53504
ds_read_b128 a[84:87], v255 offset:320
ds_read_b128 a[88:91], v255 offset:384
v_mfma_f32_16x16x32_bf16 v[200:203], a[200:203], a[72:75], v[200:203]
s_waitcnt lgkmcnt(3)
buffer_load_dwordx4 v242, s[16:19], s30 offen offset:0 lds
v_mfma_f32_16x16x32_bf16 v[200:203], a[204:207], a[76:79], v[200:203]
s_waitcnt lgkmcnt(2)
ds_read_b128 a[92:95], v255 offset:448
v_max3_f32 v247, v196, v197, v198
v_mfma_f32_16x16x32_bf16 v[200:203], a[208:211], a[80:83], v[200:203]
s_cbranch_vccz L_cw10
s_waitcnt vmcnt(9)
L_cw10:
v_max_f32 v247, v247, v199
v_mov_b32 v225, v247
s_waitcnt lgkmcnt(2)
v_mfma_f32_16x16x32_bf16 v[200:203], a[212:215], a[84:87], v[200:203]
s_waitcnt lgkmcnt(1)
v_permlane32_swap_b32 v247, v225
v_mfma_f32_16x16x32_bf16 v[200:203], a[216:219], a[88:91], v[200:203]
s_waitcnt lgkmcnt(0)
s_add_u32 m0, s3, 53520
v_max_f32 v247, v247, v225
v_mov_b32 v225, v247
v_mfma_f32_16x16x32_bf16 v[200:203], a[220:223], a[92:95], v[200:203]
buffer_load_dwordx4 v242, s[16:19], s30 offen offset:1024 lds
v_mfma_f32_16x16x32_bf16 v[216:219], a[252:255], a[92:95], 0
v_permlane16_swap_b32 v247, v225
v_mfma_f32_16x16x32_bf16 v[216:219], a[248:251], a[88:91], v[216:219]
v_max_f32 v247, v247, v225
v_mul_f32 v247, s27, v247
v_mfma_f32_16x16x32_bf16 v[216:219], a[244:247], a[84:87], v[216:219]
v_exp_f32 v195, v195
v_mfma_f32_16x16x32_bf16 v[216:219], a[240:243], a[80:83], v[216:219]
s_add_u32 m0, s3, 53536
v_max3_f32 v248, v200, v201, v202
v_max_f32 v248, v248, v203
v_mfma_f32_16x16x32_bf16 v[216:219], a[236:239], a[76:79], v[216:219]
ds_read_b128 a[96:99], v255 offset:8448
buffer_load_dwordx4 v242, s[16:19], s30 offen offset:2048 lds
v_mfma_f32_16x16x32_bf16 v[216:219], a[232:235], a[72:75], v[216:219]
ds_read_b128 a[100:103], v255 offset:8512
v_mov_b32 v226, v248
v_mfma_f32_16x16x32_bf16 v[216:219], a[228:231], a[68:71], v[216:219]
ds_read_b128 a[104:107], v255 offset:8576
v_add_f32 v250, v250, v195
v_mfma_f32_16x16x32_bf16 v[216:219], a[224:227], a[64:67], v[216:219]
s_waitcnt lgkmcnt(2)
ds_read_b128 a[108:111], v255 offset:8640
v_cvt_pk_bf16_f32 v193, v194, v195
v_mfma_f32_16x16x32_bf16 v[204:207], a[192:195], a[96:99], 0
s_waitcnt lgkmcnt(2)
s_add_u32 m0, s3, 53552
ds_read_b128 a[112:115], v255 offset:8704
v_fma_f32 v196, v196, s27, -v247
v_mfma_f32_16x16x32_bf16 v[204:207], a[196:199], a[100:103], v[204:207]
s_waitcnt lgkmcnt(2)
ds_read_b128 a[116:119], v255 offset:8768
buffer_load_dwordx4 v242, s[16:19], s30 offen offset:3072 lds
v_mfma_f32_16x16x32_bf16 v[204:207], a[200:203], a[104:107], v[204:207]
s_waitcnt lgkmcnt(2)
s_add_u32 s30, s30, 16384
ds_read_b128 a[120:123], v255 offset:8832
v_fma_f32 v197, v197, s27, -v247
v_mfma_f32_16x16x32_bf16 v[204:207], a[204:207], a[108:111], v[204:207]
s_waitcnt lgkmcnt(2)
ds_read_b128 a[124:127], v255 offset:8896
v_fma_f32 v198, v198, s27, -v247
v_mfma_f32_16x16x32_bf16 v[204:207], a[208:211], a[112:115], v[204:207]
s_waitcnt lgkmcnt(2)
v_permlane32_swap_b32 v248, v226
v_mfma_f32_16x16x32_bf16 v[204:207], a[212:215], a[116:119], v[204:207]
s_waitcnt lgkmcnt(1)
v_max_f32 v248, v248, v226
v_mov_b32 v226, v248
v_mfma_f32_16x16x32_bf16 v[204:207], a[216:219], a[120:123], v[204:207]
s_waitcnt lgkmcnt(0)
v_permlane16_swap_b32 v248, v226
v_mfma_f32_16x16x32_bf16 v[204:207], a[220:223], a[124:127], v[204:207]
v_max_f32 v248, v248, v226
v_mul_f32 v248, s27, v248
v_mfma_f32_16x16x32_bf16 v[220:223], a[252:255], a[124:127], 0
v_exp_f32 v208, v208
v_mfma_f32_16x16x32_bf16 v[220:223], a[248:251], a[120:123], v[220:223]
v_exp_f32 v209, v209
v_mfma_f32_16x16x32_bf16 v[220:223], a[244:247], a[116:119], v[220:223]
v_add_f32 v250, v250, v208
v_add_f32 v250, v250, v209
v_mfma_f32_16x16x32_bf16 v[220:223], a[240:243], a[112:115], v[220:223]
v_max3_f32 v249, v204, v205, v206
v_max_f32 v249, v249, v207
v_mfma_f32_16x16x32_bf16 v[220:223], a[236:239], a[108:111], v[220:223]
v_mov_b32 v227, v249
v_cvt_pk_bf16_f32 v194, v208, v209
v_mfma_f32_16x16x32_bf16 v[220:223], a[232:235], a[104:107], v[220:223]
v_permlane32_swap_b32 v249, v227
v_mfma_f32_16x16x32_bf16 v[220:223], a[228:231], a[100:103], v[220:223]
v_max_f32 v249, v249, v227
v_mov_b32 v227, v249
v_exp_f32 v210, v210
v_exp_f32 v211, v211
v_exp_f32 v196, v196
v_fma_f32 v199, v199, s27, -v247
v_exp_f32 v197, v197
v_exp_f32 v198, v198
v_exp_f32 v199, v199
v_mfma_f32_16x16x32_bf16 v[220:223], a[224:227], a[96:99], v[220:223]
ds_read_b128 a[192:195], v240 offset:16896
ds_read_b128 a[196:199], v240 offset:16960
ds_read_b128 a[200:203], v240 offset:17024
ds_read_b128 a[204:207], v240 offset:17088
ds_read_b128 a[208:211], v240 offset:17152
ds_read_b128 a[212:215], v240 offset:17216
ds_read_b128 a[216:219], v240 offset:17280
ds_read_b128 a[220:223], v240 offset:17344
v_permlane16_swap_b32 v249, v227
v_max_f32 v249, v249, v227
v_mul_f32 v249, s27, v249
v_add_f32 v250, v250, v210
v_add_f32 v250, v250, v211
v_cvt_pk_bf16_f32 v195, v210, v211
v_add_f32 v251, v251, v196
v_add_f32 v251, v251, v197
v_cvt_pk_bf16_f32 v196, v196, v197
v_add_f32 v251, v251, v198
v_add_f32 v251, v251, v199
v_cvt_pk_bf16_f32 v197, v198, v199
s_waitcnt lgkmcnt(7)
v_mfma_f32_16x16x32_bf16 v[236:239], a[192:195], a[96:99], 0
s_waitcnt lgkmcnt(6)
ds_read_b128 a[224:227], v240 offset:17408
v_mfma_f32_16x16x32_bf16 v[236:239], a[196:199], a[100:103], v[236:239]
s_waitcnt lgkmcnt(6)
v_mfma_f32_16x16x32_bf16 v[236:239], a[200:203], a[104:107], v[236:239]
s_waitcnt lgkmcnt(5)
ds_read_b128 a[228:231], v240 offset:17472
v_mfma_f32_16x16x32_bf16 v[236:239], a[204:207], a[108:111], v[236:239]
s_waitcnt lgkmcnt(5)
v_fma_f32 v204, v204, s27, -v249
v_fma_f32 v205, v205, s27, -v249
v_mfma_f32_16x16x32_bf16 v[236:239], a[208:211], a[112:115], v[236:239]
s_waitcnt lgkmcnt(4)
v_exp_f32 v204, v204
v_mfma_f32_16x16x32_bf16 v[236:239], a[212:215], a[116:119], v[236:239]
s_waitcnt lgkmcnt(3)
v_fma_f32 v206, v206, s27, -v249
v_fma_f32 v207, v207, s27, -v249
v_mfma_f32_16x16x32_bf16 v[236:239], a[216:219], a[120:123], v[236:239]
s_waitcnt lgkmcnt(2)
v_exp_f32 v205, v205
v_mfma_f32_16x16x32_bf16 v[236:239], a[220:223], a[124:127], v[236:239]
ds_read_b128 a[232:235], v240 offset:17536
v_add_f32 v253, v253, v204
v_mfma_f32_16x16x32_bf16 v[224:227], a[220:223], a[28:31], 0
s_add_u32 m0, s5, 0
v_exp_f32 v206, v206
v_mfma_f32_16x16x32_bf16 v[224:227], a[216:219], a[24:27], v[224:227]
buffer_load_dwordx4 v243, s[8:11], s38 offen nt lds
v_mfma_f32_16x16x32_bf16 v[224:227], a[212:215], a[20:23], v[224:227]
s_add_u32 s38, s38, 512
v_add_f32 v253, v253, v205
v_cvt_pk_bf16_f32 v204, v204, v205
v_mfma_f32_16x16x32_bf16 v[224:227], a[208:211], a[16:19], v[224:227]
v_exp_f32 v207, v207
v_mfma_f32_16x16x32_bf16 v[224:227], a[204:207], a[12:15], v[224:227]
v_add_f32 v253, v253, v206
v_add_f32 v253, v253, v207
v_mfma_f32_16x16x32_bf16 v[224:227], a[200:203], a[8:11], v[224:227]
ds_read_b128 a[236:239], v240 offset:17600
v_cvt_pk_bf16_f32 v205, v206, v207
v_mfma_f32_16x16x32_bf16 v[224:227], a[196:199], a[4:7], v[224:227]
ds_read_b128 a[240:243], v240 offset:17664
v_fma_f32 v220, v220, s27, -v249
v_mfma_f32_16x16x32_bf16 v[224:227], a[192:195], a[0:3], v[224:227]
v_fma_f32 v221, v221, s27, -v249
v_fma_f32 v222, v222, s27, -v249
v_mfma_f32_16x16x32_bf16 v[228:231], a[192:195], a[32:35], 0
v_exp_f32 v220, v220
v_mfma_f32_16x16x32_bf16 v[228:231], a[196:199], a[36:39], v[228:231]
ds_read_b128 a[244:247], v240 offset:17728
v_fma_f32 v223, v223, s27, -v249
v_mfma_f32_16x16x32_bf16 v[228:231], a[200:203], a[40:43], v[228:231]
s_add_u32 m0, s5, 8448
v_exp_f32 v221, v221
v_mfma_f32_16x16x32_bf16 v[228:231], a[204:207], a[44:47], v[228:231]
s_add_u32 s5, s5, 1056
buffer_load_dwordx4 v243, s[8:11], s33 offen nt lds
v_mfma_f32_16x16x32_bf16 v[228:231], a[208:211], a[48:51], v[228:231]
s_add_u32 s33, s33, 512
v_add_f32 v253, v253, v220
v_add_f32 v253, v253, v221
v_mfma_f32_16x16x32_bf16 v[228:231], a[212:215], a[52:55], v[228:231]
v_exp_f32 v222, v222
v_mfma_f32_16x16x32_bf16 v[228:231], a[216:219], a[56:59], v[228:231]
ds_read_b128 a[248:251], v240 offset:17792
v_cvt_pk_bf16_f32 v206, v220, v221
v_mfma_f32_16x16x32_bf16 v[228:231], a[220:223], a[60:63], v[228:231]
v_exp_f32 v223, v223
v_mfma_f32_16x16x32_bf16 v[232:235], a[220:223], a[92:95], 0
v_add_f32 v253, v253, v222
v_cvt_pk_bf16_f32 v207, v222, v223
v_mfma_f32_16x16x32_bf16 v[232:235], a[216:219], a[88:91], v[232:235]
ds_read_b128 a[252:255], v240 offset:17856
ds_write_b128 v242, v[204:207] offset:33792
v_mfma_f32_16x16x32_bf16 v[232:235], a[212:215], a[84:87], v[232:235]
v_add_f32 v253, v253, v223
v_fma_f32 v212, v212, s27, -v247
v_mfma_f32_16x16x32_bf16 v[232:235], a[208:211], a[80:83], v[232:235]
v_fma_f32 v213, v213, s27, -v247
v_fma_f32 v214, v214, s27, -v247
v_mfma_f32_16x16x32_bf16 v[232:235], a[204:207], a[76:79], v[232:235]
v_exp_f32 v212, v212
v_mfma_f32_16x16x32_bf16 v[232:235], a[200:203], a[72:75], v[232:235]
s_cbranch_vccz L_cw11
s_waitcnt vmcnt(10)
L_cw11:
v_fma_f32 v215, v215, s27, -v247
v_add_f32 v251, v251, v212
v_mfma_f32_16x16x32_bf16 v[232:235], a[196:199], a[68:71], v[232:235]
s_waitcnt lgkmcnt(0)
v_exp_f32 v213, v213
v_mfma_f32_16x16x32_bf16 v[232:235], a[192:195], a[64:67], v[232:235]
s_barrier
v_mfma_f32_16x16x32_bf16 v[220:223], a[224:227], a[96:99], 0
s_add_u32 m0, s26, 16896
v_exp_f32 v214, v214
v_mfma_f32_16x16x32_bf16 v[220:223], a[228:231], a[100:103], v[220:223]
buffer_load_dwordx4 v242, s[12:15], s29 offen offset:0 lds
v_mfma_f32_16x16x32_bf16 v[220:223], a[232:235], a[104:107], v[220:223]
v_add_f32 v251, v251, v213
v_cvt_pk_bf16_f32 v198, v212, v213
v_mfma_f32_16x16x32_bf16 v[220:223], a[236:239], a[108:111], v[220:223]
v_exp_f32 v215, v215
v_mfma_f32_16x16x32_bf16 v[220:223], a[240:243], a[112:115], v[220:223]
v_add_f32 v251, v251, v214
v_add_f32 v251, v251, v215
v_mfma_f32_16x16x32_bf16 v[220:223], a[244:247], a[116:119], v[220:223]
v_cvt_pk_bf16_f32 v199, v214, v215
v_fma_f32 v200, v200, s27, -v248
v_mfma_f32_16x16x32_bf16 v[220:223], a[248:251], a[120:123], v[220:223]
v_fma_f32 v201, v201, s27, -v248
v_fma_f32 v202, v202, s27, -v248
v_mfma_f32_16x16x32_bf16 v[220:223], a[252:255], a[124:127], v[220:223]
s_add_u32 m0, s26, 16928
v_exp_f32 v200, v200
v_mfma_f32_16x16x32_bf16 v[208:211], a[252:255], a[28:31], 0
buffer_load_dwordx4 v242, s[12:15], s29 offen offset:1024 lds
v_mfma_f32_16x16x32_bf16 v[208:211], a[248:251], a[24:27], v[208:211]
ds_read_b64_tr_b16 a[192:193], v241 offset:0
v_fma_f32 v203, v203, s27, -v248
v_mfma_f32_16x16x32_bf16 v[208:211], a[244:247], a[20:23], v[208:211]
v_exp_f32 v201, v201
v_mfma_f32_16x16x32_bf16 v[208:211], a[240:243], a[16:19], v[208:211]
ds_read_b64_tr_b16 a[194:195], v241 offset:512
v_add_f32 v252, v252, v200
v_mfma_f32_16x16x32_bf16 v[208:211], a[236:239], a[12:15], v[208:211]
v_exp_f32 v202, v202
v_mfma_f32_16x16x32_bf16 v[208:211], a[232:235], a[8:11], v[208:211]
ds_read_b64_tr_b16 a[196:197], v241 offset:16
v_add_f32 v252, v252, v201
v_mfma_f32_16x16x32_bf16 v[208:211], a[228:231], a[4:7], v[208:211]
ds_read_b64_tr_b16 a[198:199], v241 offset:528
v_cvt_pk_bf16_f32 v200, v200, v201
v_mfma_f32_16x16x32_bf16 v[208:211], a[224:227], a[0:3], v[208:211]
s_add_u32 m0, s26, 16960
v_exp_f32 v203, v203
v_mfma_f32_16x16x32_bf16 v[212:215], a[224:227], a[32:35], 0
buffer_load_dwordx4 v242, s[12:15], s29 offen offset:2048 lds
v_mfma_f32_16x16x32_bf16 v[212:215], a[228:231], a[36:39], v[212:215]
v_add_f32 v252, v252, v202
v_add_f32 v252, v252, v203
v_mfma_f32_16x16x32_bf16 v[212:215], a[232:235], a[40:43], v[212:215]
ds_read_b64_tr_b16 a[200:201], v241 offset:32
v_cvt_pk_bf16_f32 v201, v202, v203
v_mfma_f32_16x16x32_bf16 v[212:215], a[236:239], a[44:47], v[212:215]
ds_read_b64_tr_b16 a[202:203], v241 offset:544
v_fma_f32 v216, v216, s27, -v248
v_mfma_f32_16x16x32_bf16 v[212:215], a[240:243], a[48:51], v[212:215]
ds_read_b64_tr_b16 a[204:205], v241 offset:48
v_fma_f32 v217, v217, s27, -v248
v_mfma_f32_16x16x32_bf16 v[212:215], a[244:247], a[52:55], v[212:215]
v_exp_f32 v216, v216
v_mfma_f32_16x16x32_bf16 v[212:215], a[248:251], a[56:59], v[212:215]
v_fma_f32 v218, v218, s27, -v248
v_fma_f32 v219, v219, s27, -v248
v_exp_f32 v217, v217
v_exp_f32 v218, v218
v_exp_f32 v219, v219
v_mfma_f32_16x16x32_bf16 v[212:215], a[252:255], a[60:63], v[212:215]
s_add_u32 m0, s26, 16992
v_add_f32 v252, v252, v216
v_add_f32 v252, v252, v217
v_cvt_pk_bf16_f32 v202, v216, v217
v_add_f32 v252, v252, v218
v_add_f32 v252, v252, v219
v_cvt_pk_bf16_f32 v203, v218, v219
v_mfma_f32_16x16x32_bf16 v[216:219], a[252:255], a[92:95], 0
buffer_load_dwordx4 v242, s[12:15], s29 offen offset:3072 lds
v_mfma_f32_16x16x32_bf16 v[216:219], a[248:251], a[88:91], v[216:219]
s_add_u32 s29, s29, 16384
ds_read_b64_tr_b16 a[206:207], v241 offset:560
ds_read_b64_tr_b16 a[208:209], v241 offset:64
v_mfma_f32_16x16x32_bf16 v[216:219], a[244:247], a[84:87], v[216:219]
ds_read_b64_tr_b16 a[210:211], v241 offset:576
ds_read_b64_tr_b16 a[212:213], v241 offset:80
v_mfma_f32_16x16x32_bf16 v[216:219], a[240:243], a[80:83], v[216:219]
ds_read_b64_tr_b16 a[214:215], v241 offset:592
ds_read_b64_tr_b16 a[216:217], v241 offset:96
v_mfma_f32_16x16x32_bf16 v[216:219], a[236:239], a[76:79], v[216:219]
v_fma_f32 v236, v236, s27, -v249
v_fma_f32 v237, v237, s27, -v249
v_mfma_f32_16x16x32_bf16 v[216:219], a[232:235], a[72:75], v[216:219]
v_exp_f32 v236, v236
v_mfma_f32_16x16x32_bf16 v[216:219], a[228:231], a[68:71], v[216:219]
ds_read_b64_tr_b16 a[218:219], v241 offset:608
v_fma_f32 v238, v238, s27, -v249
v_mfma_f32_16x16x32_bf16 v[216:219], a[224:227], a[64:67], v[216:219]
s_waitcnt lgkmcnt(12)
ds_read_b64_tr_b16 a[220:221], v241 offset:112
v_fma_f32 v239, v239, s27, -v249
v_mfma_f32_16x16x32_bf16 v[0:3], v[192:195], a[192:195], 0
v_exp_f32 v237, v237
v_mfma_f32_16x16x32_bf16 v[64:67], v[196:199], a[192:195], 0
ds_read_b64_tr_b16 a[222:223], v241 offset:624
v_add_f32 v253, v253, v236
v_mfma_f32_16x16x32_bf16 v[128:131], v[200:203], a[192:195], 0
s_waitcnt lgkmcnt(12)
v_exp_f32 v238, v238
v_mfma_f32_16x16x32_bf16 v[132:135], v[200:203], a[196:199], 0
ds_read_b64_tr_b16 a[224:225], v241 offset:256
v_add_f32 v253, v253, v237
v_mfma_f32_16x16x32_bf16 v[68:71], v[196:199], a[196:199], 0
v_cvt_pk_bf16_f32 v236, v236, v237
v_add_f32 v253, v253, v238
v_mfma_f32_16x16x32_bf16 v[4:7], v[192:195], a[196:199], 0
s_waitcnt lgkmcnt(11)
v_exp_f32 v239, v239
v_mfma_f32_16x16x32_bf16 v[8:11], v[192:195], a[200:203], 0
ds_read_b64_tr_b16 a[226:227], v241 offset:768
v_add_f32 v253, v253, v239
v_mfma_f32_16x16x32_bf16 v[72:75], v[196:199], a[200:203], 0
ds_read_b64_tr_b16 a[228:229], v241 offset:272
v_cvt_pk_bf16_f32 v237, v238, v239
v_mfma_f32_16x16x32_bf16 v[136:139], v[200:203], a[200:203], 0
s_waitcnt lgkmcnt(11)
v_fma_f32 v224, v224, s27, -v246
v_fma_f32 v225, v225, s27, -v246
v_mfma_f32_16x16x32_bf16 v[140:143], v[200:203], a[204:207], 0
v_exp_f32 v224, v224
v_mfma_f32_16x16x32_bf16 v[76:79], v[196:199], a[204:207], 0
ds_read_b64_tr_b16 a[230:231], v241 offset:784
v_fma_f32 v226, v226, s27, -v246
v_mfma_f32_16x16x32_bf16 v[12:15], v[192:195], a[204:207], 0
s_waitcnt lgkmcnt(10)
ds_read_b64_tr_b16 a[232:233], v241 offset:288
v_fma_f32 v227, v227, s27, -v246
v_mfma_f32_16x16x32_bf16 v[16:19], v[192:195], a[208:211], 0
v_exp_f32 v225, v225
v_mfma_f32_16x16x32_bf16 v[80:83], v[196:199], a[208:211], 0
ds_read_b64_tr_b16 a[234:235], v241 offset:800
v_add_f32 v250, v250, v224
v_mfma_f32_16x16x32_bf16 v[144:147], v[200:203], a[208:211], 0
s_waitcnt lgkmcnt(10)
v_exp_f32 v226, v226
v_mfma_f32_16x16x32_bf16 v[148:151], v[200:203], a[212:215], 0
ds_read_b64_tr_b16 a[236:237], v241 offset:304
v_add_f32 v250, v250, v225
v_mfma_f32_16x16x32_bf16 v[84:87], v[196:199], a[212:215], 0
ds_read_b64_tr_b16 a[238:239], v241 offset:816
v_cvt_pk_bf16_f32 v224, v224, v225
v_mfma_f32_16x16x32_bf16 v[20:23], v[192:195], a[212:215], 0
s_waitcnt lgkmcnt(10)
v_exp_f32 v227, v227
v_mfma_f32_16x16x32_bf16 v[24:27], v[192:195], a[216:219], 0
v_add_f32 v250, v250, v226
v_add_f32 v250, v250, v227
v_mfma_f32_16x16x32_bf16 v[88:91], v[196:199], a[216:219], 0
ds_read_b64_tr_b16 a[240:241], v241 offset:320
v_cvt_pk_bf16_f32 v225, v226, v227
v_mfma_f32_16x16x32_bf16 v[152:155], v[200:203], a[216:219], 0
s_waitcnt lgkmcnt(9)
v_fma_f32 v220, v220, s27, -v249
v_fma_f32 v221, v221, s27, -v249
v_mfma_f32_16x16x32_bf16 v[156:159], v[200:203], a[220:223], 0
v_exp_f32 v220, v220
v_mfma_f32_16x16x32_bf16 v[92:95], v[196:199], a[220:223], 0
ds_read_b64_tr_b16 a[242:243], v241 offset:832
v_fma_f32 v222, v222, s27, -v249
v_mfma_f32_16x16x32_bf16 v[28:31], v[192:195], a[220:223], 0
s_waitcnt lgkmcnt(8)
ds_read_b64_tr_b16 a[244:245], v241 offset:336
v_fma_f32 v223, v223, s27, -v249
v_mfma_f32_16x16x32_bf16 v[32:35], v[192:195], a[224:227], 0
v_exp_f32 v221, v221
v_mfma_f32_16x16x32_bf16 v[96:99], v[196:199], a[224:227], 0
v_exp_f32 v222, v222
v_exp_f32 v223, v223
v_mfma_f32_16x16x32_bf16 v[160:163], v[200:203], a[224:227], 0
s_waitcnt lgkmcnt(7)
v_cvt_pk_bf16_f32 v238, v220, v221
v_cvt_pk_bf16_f32 v239, v222, v223
v_mfma_f32_16x16x32_bf16 v[164:167], v[200:203], a[228:231], 0
ds_read_b64_tr_b16 a[246:247], v241 offset:848
ds_write_b128 v242, v[236:239] offset:34816
v_mfma_f32_16x16x32_bf16 v[100:103], v[196:199], a[228:231], 0
v_add_f32 v253, v253, v220
v_add_f32 v253, v253, v221
v_mfma_f32_16x16x32_bf16 v[36:39], v[192:195], a[228:231], 0
s_waitcnt lgkmcnt(7)
ds_read_b64_tr_b16 a[248:249], v241 offset:352
ds_read_b64_tr_b16 a[250:251], v241 offset:864
ds_read_b64_tr_b16 a[252:253], v241 offset:368
ds_read_b64_tr_b16 a[254:255], v241 offset:880
v_mfma_f32_16x16x32_bf16 v[40:43], v[192:195], a[232:235], 0
v_add_f32 v253, v253, v222
v_add_f32 v253, v253, v223
v_mfma_f32_16x16x32_bf16 v[104:107], v[196:199], a[232:235], 0
v_fma_f32 v228, v228, s27, -v247
v_fma_f32 v229, v229, s27, -v247
v_mfma_f32_16x16x32_bf16 v[168:171], v[200:203], a[232:235], 0
s_waitcnt vmcnt(10) lgkmcnt(0)
v_exp_f32 v228, v228
v_mfma_f32_16x16x32_bf16 v[172:175], v[200:203], a[236:239], 0
s_barrier
v_mfma_f32_16x16x32_bf16 v[108:111], v[196:199], a[236:239], 0
s_add_u32 m0, s3, 36864
v_fma_f32 v230, v230, s27, -v247
v_fma_f32 v231, v231, s27, -v247
v_mfma_f32_16x16x32_bf16 v[44:47], v[192:195], a[236:239], 0
buffer_load_dwordx4 v242, s[16:19], s30 offen offset:0 lds
v_mfma_f32_16x16x32_bf16 v[48:51], v[192:195], a[240:243], 0
v_exp_f32 v229, v229
v_mfma_f32_16x16x32_bf16 v[112:115], v[196:199], a[240:243], 0
s_add_u32 m0, s3, 36880
v_add_f32 v251, v251, v228
v_add_f32 v251, v251, v229
v_mfma_f32_16x16x32_bf16 v[176:179], v[200:203], a[240:243], 0
buffer_load_dwordx4 v242, s[16:19], s30 offen offset:1024 lds
v_mfma_f32_16x16x32_bf16 v[180:183], v[200:203], a[244:247], 0
v_exp_f32 v230, v230
v_mfma_f32_16x16x32_bf16 v[116:119], v[196:199], a[244:247], 0
s_add_u32 m0, s3, 36896
v_cvt_pk_bf16_f32 v228, v228, v229
v_add_f32 v251, v251, v230
v_mfma_f32_16x16x32_bf16 v[52:55], v[192:195], a[244:247], 0
buffer_load_dwordx4 v242, s[16:19], s30 offen offset:2048 lds
v_mfma_f32_16x16x32_bf16 v[56:59], v[192:195], a[248:251], 0
v_exp_f32 v231, v231
v_mfma_f32_16x16x32_bf16 v[120:123], v[196:199], a[248:251], 0
s_add_u32 m0, s3, 36912
v_add_f32 v251, v251, v231
v_cvt_pk_bf16_f32 v229, v230, v231
v_mfma_f32_16x16x32_bf16 v[184:187], v[200:203], a[248:251], 0
buffer_load_dwordx4 v242, s[16:19], s30 offen offset:3072 lds
v_mfma_f32_16x16x32_bf16 v[188:191], v[200:203], a[252:255], 0
s_add_u32 s30, s30, 16384
v_fma_f32 v232, v232, s27, -v248
v_fma_f32 v233, v233, s27, -v248
v_mfma_f32_16x16x32_bf16 v[124:127], v[196:199], a[252:255], 0
v_exp_f32 v232, v232
v_fma_f32 v234, v234, s27, -v248
v_fma_f32 v235, v235, s27, -v248
v_exp_f32 v233, v233
v_exp_f32 v234, v234
v_exp_f32 v235, v235
v_mfma_f32_16x16x32_bf16 v[60:63], v[192:195], a[252:255], 0
ds_read_b128 a[192:195], v240 offset:0
ds_read_b128 a[196:199], v240 offset:64
ds_read_b128 a[200:203], v240 offset:128
ds_read_b128 a[204:207], v240 offset:192
ds_read_b128 a[208:211], v240 offset:256
ds_read_b128 a[212:215], v240 offset:320
ds_read_b128 a[216:219], v240 offset:384
ds_read_b128 a[220:223], v240 offset:448
v_add_f32 v252, v252, v232
v_add_f32 v252, v252, v233
v_cvt_pk_bf16_f32 v232, v232, v233
v_add_f32 v252, v252, v234
v_add_f32 v252, v252, v235
v_cvt_pk_bf16_f32 v233, v234, v235
.p2align 6
L_loopq:
s_waitcnt lgkmcnt(7)
v_mfma_f32_16x16x32_bf16 v[204:207], a[192:195], a[96:99], 0
s_waitcnt lgkmcnt(6)
ds_read_b128 a[224:227], v240 offset:512
v_fma_f32 v208, v208, s27, -v246
v_mfma_f32_16x16x32_bf16 v[204:207], a[196:199], a[100:103], v[204:207]
s_waitcnt lgkmcnt(6)
v_fma_f32 v209, v209, s27, -v246
v_mfma_f32_16x16x32_bf16 v[204:207], a[200:203], a[104:107], v[204:207]
s_waitcnt lgkmcnt(5)
v_exp_f32 v208, v208
v_mfma_f32_16x16x32_bf16 v[204:207], a[204:207], a[108:111], v[204:207]
s_waitcnt lgkmcnt(4)
ds_read_b128 a[228:231], v240 offset:576
v_fma_f32 v210, v210, s27, -v246
v_mfma_f32_16x16x32_bf16 v[204:207], a[208:211], a[112:115], v[204:207]
s_waitcnt lgkmcnt(4)
v_fma_f32 v211, v211, s27, -v246
v_add_f32 v250, v250, v208
v_mfma_f32_16x16x32_bf16 v[204:207], a[212:215], a[116:119], v[204:207]
s_waitcnt lgkmcnt(3)
v_exp_f32 v209, v209
v_mfma_f32_16x16x32_bf16 v[204:207], a[216:219], a[120:123], v[204:207]
s_waitcnt lgkmcnt(2)
ds_read_b128 a[232:235], v240 offset:640
v_add_f32 v250, v250, v209
v_mfma_f32_16x16x32_bf16 v[204:207], a[220:223], a[124:127], v[204:207]
v_exp_f32 v210, v210
v_mfma_f32_16x16x32_bf16 v[192:195], a[220:223], a[28:31], 0
s_add_u32 m0, s5, 0
ds_read_b128 a[236:239], v240 offset:704
v_cvt_pk_bf16_f32 v226, v208, v209
v_mfma_f32_16x16x32_bf16 v[192:195], a[216:219], a[24:27], v[192:195]
buffer_load_dwordx4 v243, s[8:11], s38 offen nt lds
v_mfma_f32_16x16x32_bf16 v[192:195], a[212:215], a[20:23], v[192:195]
s_add_u32 s38, s38, 512
v_exp_f32 v211, v211
v_mfma_f32_16x16x32_bf16 v[192:195], a[208:211], a[16:19], v[192:195]
ds_read_b128 a[240:243], v240 offset:768
v_add_f32 v250, v250, v210
v_mfma_f32_16x16x32_bf16 v[192:195], a[204:207], a[12:15], v[192:195]
v_add_f32 v250, v250, v211
v_cvt_pk_bf16_f32 v227, v210, v211
v_mfma_f32_16x16x32_bf16 v[192:195], a[200:203], a[8:11], v[192:195]
ds_read_b128 a[244:247], v240 offset:832
v_fma_f32 v212, v212, s27, -v247
v_mfma_f32_16x16x32_bf16 v[192:195], a[196:199], a[4:7], v[192:195]
v_fma_f32 v213, v213, s27, -v247
v_mfma_f32_16x16x32_bf16 v[192:195], a[192:195], a[0:3], v[192:195]
v_exp_f32 v212, v212
v_mfma_f32_16x16x32_bf16 v[196:199], a[192:195], a[32:35], 0
v_fma_f32 v214, v214, s27, -v247
v_fma_f32 v215, v215, s27, -v247
v_mfma_f32_16x16x32_bf16 v[196:199], a[196:199], a[36:39], v[196:199]
ds_read_b128 a[248:251], v240 offset:896
v_add_f32 v251, v251, v212
v_mfma_f32_16x16x32_bf16 v[196:199], a[200:203], a[40:43], v[196:199]
v_exp_f32 v213, v213
v_mfma_f32_16x16x32_bf16 v[196:199], a[204:207], a[44:47], v[196:199]
v_exp_f32 v214, v214
v_mfma_f32_16x16x32_bf16 v[196:199], a[208:211], a[48:51], v[196:199]
ds_read_b128 a[252:255], v240 offset:960
v_add_f32 v251, v251, v213
v_mfma_f32_16x16x32_bf16 v[196:199], a[212:215], a[52:55], v[196:199]
v_cvt_pk_bf16_f32 v230, v212, v213
v_add_f32 v251, v251, v214
v_mfma_f32_16x16x32_bf16 v[196:199], a[216:219], a[56:59], v[196:199]
v_exp_f32 v215, v215
v_mfma_f32_16x16x32_bf16 v[196:199], a[220:223], a[60:63], v[196:199]
v_add_f32 v251, v251, v215
v_cvt_pk_bf16_f32 v231, v214, v215
v_mfma_f32_16x16x32_bf16 v[200:203], a[220:223], a[92:95], 0
v_fma_f32 v216, v216, s27, -v248
v_fma_f32 v217, v217, s27, -v248
v_mfma_f32_16x16x32_bf16 v[200:203], a[216:219], a[88:91], v[200:203]
v_exp_f32 v216, v216
v_mfma_f32_16x16x32_bf16 v[200:203], a[212:215], a[84:87], v[200:203]
v_fma_f32 v218, v218, s27, -v248
v_fma_f32 v219, v219, s27, -v248
v_mfma_f32_16x16x32_bf16 v[200:203], a[208:211], a[80:83], v[200:203]
v_exp_f32 v217, v217
v_mfma_f32_16x16x32_bf16 v[200:203], a[204:207], a[76:79], v[200:203]
v_add_f32 v252, v252, v216
v_mfma_f32_16x16x32_bf16 v[200:203], a[200:203], a[72:75], v[200:203]
v_exp_f32 v218, v218
v_mfma_f32_16x16x32_bf16 v[200:203], a[196:199], a[68:71], v[200:203]
s_waitcnt vmcnt(10) lgkmcnt(0)
v_add_f32 v252, v252, v217
v_cvt_pk_bf16_f32 v234, v216, v217
v_mfma_f32_16x16x32_bf16 v[200:203], a[192:195], a[64:67], v[200:203]
s_barrier
v_mfma_f32_16x16x32_bf16 v[220:223], a[224:227], a[96:99], 0
s_add_u32 m0, s26, 0
v_exp_f32 v219, v219
v_mfma_f32_16x16x32_bf16 v[220:223], a[228:231], a[100:103], v[220:223]
buffer_load_dwordx4 v242, s[12:15], s29 offen offset:0 lds
v_mfma_f32_16x16x32_bf16 v[220:223], a[232:235], a[104:107], v[220:223]
ds_read_b64_tr_b16 a[192:193], v241 offset:16640
v_add_f32 v252, v252, v218
v_mfma_f32_16x16x32_bf16 v[220:223], a[236:239], a[108:111], v[220:223]
ds_read_b64_tr_b16 a[194:195], v241 offset:17152
v_add_f32 v252, v252, v219
v_mfma_f32_16x16x32_bf16 v[220:223], a[240:243], a[112:115], v[220:223]
ds_read_b64_tr_b16 a[196:197], v241 offset:16656
v_cvt_pk_bf16_f32 v235, v218, v219
v_mfma_f32_16x16x32_bf16 v[220:223], a[244:247], a[116:119], v[220:223]
v_fma_f32 v204, v204, s27, -v249
v_fma_f32 v205, v205, s27, -v249
v_mfma_f32_16x16x32_bf16 v[220:223], a[248:251], a[120:123], v[220:223]
ds_read_b64_tr_b16 a[198:199], v241 offset:17168
v_fma_f32 v206, v206, s27, -v249
v_mfma_f32_16x16x32_bf16 v[220:223], a[252:255], a[124:127], v[220:223]
s_add_u32 m0, s26, 32
v_exp_f32 v204, v204
v_mfma_f32_16x16x32_bf16 v[208:211], a[252:255], a[28:31], 0
buffer_load_dwordx4 v242, s[12:15], s29 offen offset:1024 lds
v_mfma_f32_16x16x32_bf16 v[208:211], a[248:251], a[24:27], v[208:211]
ds_read_b64_tr_b16 a[200:201], v241 offset:16672
v_fma_f32 v207, v207, s27, -v249
v_mfma_f32_16x16x32_bf16 v[208:211], a[244:247], a[20:23], v[208:211]
ds_read_b64_tr_b16 a[202:203], v241 offset:17184
ds_read_b64_tr_b16 a[204:205], v241 offset:16688
v_mfma_f32_16x16x32_bf16 v[208:211], a[240:243], a[16:19], v[208:211]
v_exp_f32 v205, v205
v_mfma_f32_16x16x32_bf16 v[208:211], a[236:239], a[12:15], v[208:211]
ds_read_b64_tr_b16 a[206:207], v241 offset:17200
v_add_f32 v253, v253, v204
v_mfma_f32_16x16x32_bf16 v[208:211], a[232:235], a[8:11], v[208:211]
v_exp_f32 v206, v206
v_mfma_f32_16x16x32_bf16 v[208:211], a[228:231], a[4:7], v[208:211]
ds_read_b64_tr_b16 a[208:209], v241 offset:16704
v_add_f32 v253, v253, v205
v_mfma_f32_16x16x32_bf16 v[208:211], a[224:227], a[0:3], v[208:211]
s_add_u32 m0, s26, 64
ds_read_b64_tr_b16 a[210:211], v241 offset:17216
v_cvt_pk_bf16_f32 v204, v204, v205
v_mfma_f32_16x16x32_bf16 v[212:215], a[224:227], a[32:35], 0
buffer_load_dwordx4 v242, s[12:15], s29 offen offset:2048 lds
v_mfma_f32_16x16x32_bf16 v[212:215], a[228:231], a[36:39], v[212:215]
v_exp_f32 v207, v207
v_mfma_f32_16x16x32_bf16 v[212:215], a[232:235], a[40:43], v[212:215]
ds_read_b64_tr_b16 a[212:213], v241 offset:16720
v_add_f32 v253, v253, v206
v_mfma_f32_16x16x32_bf16 v[212:215], a[236:239], a[44:47], v[212:215]
ds_read_b64_tr_b16 a[214:215], v241 offset:17232
v_add_f32 v253, v253, v207
v_mfma_f32_16x16x32_bf16 v[212:215], a[240:243], a[48:51], v[212:215]
v_cvt_pk_bf16_f32 v205, v206, v207
v_fma_f32 v192, v192, s27, -v246
v_mfma_f32_16x16x32_bf16 v[212:215], a[244:247], a[52:55], v[212:215]
ds_read_b64_tr_b16 a[216:217], v241 offset:16736
v_fma_f32 v193, v193, s27, -v246
v_mfma_f32_16x16x32_bf16 v[212:215], a[248:251], a[56:59], v[212:215]
v_exp_f32 v192, v192
v_mfma_f32_16x16x32_bf16 v[212:215], a[252:255], a[60:63], v[212:215]
s_add_u32 m0, s26, 96
ds_read_b64_tr_b16 a[218:219], v241 offset:17248
v_fma_f32 v194, v194, s27, -v246
v_mfma_f32_16x16x32_bf16 v[216:219], a[252:255], a[92:95], 0
buffer_load_dwordx4 v242, s[12:15], s29 offen offset:3072 lds
v_mfma_f32_16x16x32_bf16 v[216:219], a[248:251], a[88:91], v[216:219]
s_add_u32 s29, s29, 16384
ds_read_b64_tr_b16 a[220:221], v241 offset:16752
v_fma_f32 v195, v195, s27, -v246
v_mfma_f32_16x16x32_bf16 v[216:219], a[244:247], a[84:87], v[216:219]
v_exp_f32 v193, v193
v_mfma_f32_16x16x32_bf16 v[216:219], a[240:243], a[80:83], v[216:219]
ds_read_b64_tr_b16 a[222:223], v241 offset:17264
v_add_f32 v250, v250, v192
v_mfma_f32_16x16x32_bf16 v[216:219], a[236:239], a[76:79], v[216:219]
v_exp_f32 v194, v194
v_mfma_f32_16x16x32_bf16 v[216:219], a[232:235], a[72:75], v[216:219]
v_add_f32 v250, v250, v193
v_cvt_pk_bf16_f32 v192, v192, v193
v_mfma_f32_16x16x32_bf16 v[216:219], a[228:231], a[68:71], v[216:219]
v_exp_f32 v195, v195
v_mfma_f32_16x16x32_bf16 v[216:219], a[224:227], a[64:67], v[216:219]
s_waitcnt lgkmcnt(14)
ds_read_b64_tr_b16 a[224:225], v241 offset:16896
ds_read_b64_tr_b16 a[226:227], v241 offset:17408
v_mfma_f32_16x16x32_bf16 v[0:3], v[224:227], a[192:195], v[0:3]
ds_read_b64_tr_b16 a[228:229], v241 offset:16912
v_add_f32 v250, v250, v194
v_mfma_f32_16x16x32_bf16 v[64:67], v[228:231], a[192:195], v[64:67]
v_add_f32 v250, v250, v195
v_cvt_pk_bf16_f32 v193, v194, v195
v_mfma_f32_16x16x32_bf16 v[128:131], v[232:235], a[192:195], v[128:131]
s_waitcnt lgkmcnt(15)
ds_read_b64_tr_b16 a[230:231], v241 offset:17424
v_fma_f32 v220, v220, s27, -v249
v_mfma_f32_16x16x32_bf16 v[132:135], v[232:235], a[196:199], v[132:135]
ds_read_b64_tr_b16 a[232:233], v241 offset:16928
v_fma_f32 v221, v221, s27, -v249
v_mfma_f32_16x16x32_bf16 v[68:71], v[228:231], a[196:199], v[68:71]
v_exp_f32 v220, v220
v_mfma_f32_16x16x32_bf16 v[4:7], v[224:227], a[196:199], v[4:7]
s_waitcnt lgkmcnt(15)
ds_read_b64_tr_b16 a[234:235], v241 offset:17440
v_fma_f32 v222, v222, s27, -v249
v_mfma_f32_16x16x32_bf16 v[8:11], v[224:227], a[200:203], v[8:11]
v_fma_f32 v223, v223, s27, -v249
v_mfma_f32_16x16x32_bf16 v[72:75], v[228:231], a[200:203], v[72:75]
ds_read_b64_tr_b16 a[236:237], v241 offset:16944
v_mfma_f32_16x16x32_bf16 v[136:139], v[232:235], a[200:203], v[136:139]
s_waitcnt lgkmcnt(15)
v_exp_f32 v221, v221
v_mfma_f32_16x16x32_bf16 v[140:143], v[232:235], a[204:207], v[140:143]
ds_read_b64_tr_b16 a[238:239], v241 offset:17456
v_add_f32 v253, v253, v220
v_mfma_f32_16x16x32_bf16 v[76:79], v[228:231], a[204:207], v[76:79]
v_exp_f32 v222, v222
v_mfma_f32_16x16x32_bf16 v[12:15], v[224:227], a[204:207], v[12:15]
s_waitcnt lgkmcnt(14)
ds_read_b64_tr_b16 a[240:241], v241 offset:16960
v_add_f32 v253, v253, v221
v_mfma_f32_16x16x32_bf16 v[16:19], v[224:227], a[208:211], v[16:19]
ds_read_b64_tr_b16 a[242:243], v241 offset:17472
v_cvt_pk_bf16_f32 v206, v220, v221
v_mfma_f32_16x16x32_bf16 v[80:83], v[228:231], a[208:211], v[80:83]
v_exp_f32 v223, v223
v_mfma_f32_16x16x32_bf16 v[144:147], v[232:235], a[208:211], v[144:147]
s_waitcnt lgkmcnt(14)
v_add_f32 v253, v253, v222
v_add_f32 v253, v253, v223
v_mfma_f32_16x16x32_bf16 v[148:151], v[232:235], a[212:215], v[148:151]
ds_read_b64_tr_b16 a[244:245], v241 offset:16976
v_cvt_pk_bf16_f32 v207, v222, v223
v_mfma_f32_16x16x32_bf16 v[84:87], v[228:231], a[212:215], v[84:87]
ds_read_b64_tr_b16 a[246:247], v241 offset:17488
ds_write_b128 v242, v[204:207] offset:33792
v_mfma_f32_16x16x32_bf16 v[20:23], v[224:227], a[212:215], v[20:23]
s_waitcnt lgkmcnt(15)
v_fma_f32 v196, v196, s27, -v247
v_fma_f32 v197, v197, s27, -v247
v_mfma_f32_16x16x32_bf16 v[24:27], v[224:227], a[216:219], v[24:27]
ds_read_b64_tr_b16 a[248:249], v241 offset:16992
v_mfma_f32_16x16x32_bf16 v[88:91], v[228:231], a[216:219], v[88:91]
v_exp_f32 v196, v196
v_mfma_f32_16x16x32_bf16 v[152:155], v[232:235], a[216:219], v[152:155]
s_waitcnt lgkmcnt(14)
ds_read_b64_tr_b16 a[250:251], v241 offset:17504
v_fma_f32 v198, v198, s27, -v247
v_mfma_f32_16x16x32_bf16 v[156:159], v[232:235], a[220:223], v[156:159]
ds_read_b64_tr_b16 a[252:253], v241 offset:17008
v_fma_f32 v199, v199, s27, -v247
v_mfma_f32_16x16x32_bf16 v[92:95], v[228:231], a[220:223], v[92:95]
v_exp_f32 v197, v197
v_mfma_f32_16x16x32_bf16 v[28:31], v[224:227], a[220:223], v[28:31]
s_waitcnt lgkmcnt(14)
ds_read_b64_tr_b16 a[254:255], v241 offset:17520
v_add_f32 v251, v251, v196
v_mfma_f32_16x16x32_bf16 v[32:35], v[224:227], a[224:227], v[32:35]
v_exp_f32 v198, v198
v_mfma_f32_16x16x32_bf16 v[96:99], v[228:231], a[224:227], v[96:99]
v_add_f32 v251, v251, v197
v_cvt_pk_bf16_f32 v196, v196, v197
v_mfma_f32_16x16x32_bf16 v[160:163], v[232:235], a[224:227], v[160:163]
s_waitcnt lgkmcnt(13)
v_exp_f32 v199, v199
v_mfma_f32_16x16x32_bf16 v[164:167], v[232:235], a[228:231], v[164:167]
v_add_f32 v251, v251, v198
v_add_f32 v251, v251, v199
v_mfma_f32_16x16x32_bf16 v[100:103], v[228:231], a[228:231], v[100:103]
v_cvt_pk_bf16_f32 v197, v198, v199
v_fma_f32 v200, v200, s27, -v248
v_mfma_f32_16x16x32_bf16 v[36:39], v[224:227], a[228:231], v[36:39]
s_waitcnt lgkmcnt(11)
v_fma_f32 v201, v201, s27, -v248
v_mfma_f32_16x16x32_bf16 v[40:43], v[224:227], a[232:235], v[40:43]
v_exp_f32 v200, v200
v_mfma_f32_16x16x32_bf16 v[104:107], v[228:231], a[232:235], v[104:107]
v_fma_f32 v202, v202, s27, -v248
v_fma_f32 v203, v203, s27, -v248
v_mfma_f32_16x16x32_bf16 v[168:171], v[232:235], a[232:235], v[168:171]
s_waitcnt vmcnt(9) lgkmcnt(0)
v_exp_f32 v201, v201
v_mfma_f32_16x16x32_bf16 v[172:175], v[232:235], a[236:239], v[172:175]
s_barrier
v_mfma_f32_16x16x32_bf16 v[108:111], v[228:231], a[236:239], v[108:111]
s_add_u32 m0, s3, 53504
ds_read_b128 a[192:195], v240 offset:16896
v_add_f32 v252, v252, v200
v_mfma_f32_16x16x32_bf16 v[44:47], v[224:227], a[236:239], v[44:47]
buffer_load_dwordx4 v242, s[16:19], s30 offen offset:0 lds
v_mfma_f32_16x16x32_bf16 v[48:51], v[224:227], a[240:243], v[48:51]
ds_read_b128 a[196:199], v240 offset:16960
ds_read_b128 a[200:203], v240 offset:17024
v_mfma_f32_16x16x32_bf16 v[112:115], v[228:231], a[240:243], v[112:115]
s_add_u32 m0, s3, 53520
ds_read_b128 a[204:207], v240 offset:17088
ds_read_b128 a[208:211], v240 offset:17152
v_mfma_f32_16x16x32_bf16 v[176:179], v[232:235], a[240:243], v[176:179]
buffer_load_dwordx4 v242, s[16:19], s30 offen offset:1024 lds
v_mfma_f32_16x16x32_bf16 v[180:183], v[232:235], a[244:247], v[180:183]
v_exp_f32 v202, v202
v_mfma_f32_16x16x32_bf16 v[116:119], v[228:231], a[244:247], v[116:119]
s_add_u32 m0, s3, 53536
ds_read_b128 a[212:215], v240 offset:17216
ds_read_b128 a[216:219], v240 offset:17280
v_mfma_f32_16x16x32_bf16 v[52:55], v[224:227], a[244:247], v[52:55]
buffer_load_dwordx4 v242, s[16:19], s30 offen offset:2048 lds
v_mfma_f32_16x16x32_bf16 v[56:59], v[224:227], a[248:251], v[56:59]
ds_read_b128 a[220:223], v240 offset:17344
v_add_f32 v252, v252, v201
v_mfma_f32_16x16x32_bf16 v[120:123], v[228:231], a[248:251], v[120:123]
s_add_u32 m0, s3, 53552
v_cvt_pk_bf16_f32 v200, v200, v201
v_mfma_f32_16x16x32_bf16 v[184:187], v[232:235], a[248:251], v[184:187]
buffer_load_dwordx4 v242, s[16:19], s30 offen offset:3072 lds
v_mfma_f32_16x16x32_bf16 v[188:191], v[232:235], a[252:255], v[188:191]
s_add_u32 s30, s30, 16384
v_exp_f32 v203, v203
v_mfma_f32_16x16x32_bf16 v[124:127], v[228:231], a[252:255], v[124:127]
v_add_f32 v252, v252, v202
v_add_f32 v252, v252, v203
v_mfma_f32_16x16x32_bf16 v[60:63], v[224:227], a[252:255], v[60:63]
s_waitcnt lgkmcnt(7)
v_cvt_pk_bf16_f32 v201, v202, v203
v_mfma_f32_16x16x32_bf16 v[236:239], a[192:195], a[96:99], 0
s_waitcnt lgkmcnt(6)
ds_read_b128 a[224:227], v240 offset:17408
v_fma_f32 v208, v208, s27, -v246
v_mfma_f32_16x16x32_bf16 v[236:239], a[196:199], a[100:103], v[236:239]
s_waitcnt lgkmcnt(6)
v_fma_f32 v209, v209, s27, -v246
v_mfma_f32_16x16x32_bf16 v[236:239], a[200:203], a[104:107], v[236:239]
s_waitcnt lgkmcnt(5)
v_exp_f32 v208, v208
v_mfma_f32_16x16x32_bf16 v[236:239], a[204:207], a[108:111], v[236:239]
s_waitcnt lgkmcnt(4)
ds_read_b128 a[228:231], v240 offset:17472
v_fma_f32 v210, v210, s27, -v246
v_mfma_f32_16x16x32_bf16 v[236:239], a[208:211], a[112:115], v[236:239]
s_waitcnt lgkmcnt(4)
v_fma_f32 v211, v211, s27, -v246
v_add_f32 v250, v250, v208
v_mfma_f32_16x16x32_bf16 v[236:239], a[212:215], a[116:119], v[236:239]
s_waitcnt lgkmcnt(3)
v_exp_f32 v209, v209
v_mfma_f32_16x16x32_bf16 v[236:239], a[216:219], a[120:123], v[236:239]
s_waitcnt lgkmcnt(2)
ds_read_b128 a[232:235], v240 offset:17536
v_add_f32 v250, v250, v209
v_mfma_f32_16x16x32_bf16 v[236:239], a[220:223], a[124:127], v[236:239]
v_exp_f32 v210, v210
v_mfma_f32_16x16x32_bf16 v[224:227], a[220:223], a[28:31], 0
s_add_u32 m0, s5, 8448
ds_read_b128 a[236:239], v240 offset:17600
v_cvt_pk_bf16_f32 v194, v208, v209
v_mfma_f32_16x16x32_bf16 v[224:227], a[216:219], a[24:27], v[224:227]
s_add_u32 s5, s5, 1056
buffer_load_dwordx4 v243, s[8:11], s33 offen nt lds
v_mfma_f32_16x16x32_bf16 v[224:227], a[212:215], a[20:23], v[224:227]
s_add_u32 s33, s33, 512
v_exp_f32 v211, v211
v_mfma_f32_16x16x32_bf16 v[224:227], a[208:211], a[16:19], v[224:227]
ds_read_b128 a[240:243], v240 offset:17664
v_add_f32 v250, v250, v210
v_mfma_f32_16x16x32_bf16 v[224:227], a[204:207], a[12:15], v[224:227]
v_add_f32 v250, v250, v211
v_cvt_pk_bf16_f32 v195, v210, v211
v_mfma_f32_16x16x32_bf16 v[224:227], a[200:203], a[8:11], v[224:227]
ds_read_b128 a[244:247], v240 offset:17728
v_fma_f32 v212, v212, s27, -v247
v_mfma_f32_16x16x32_bf16 v[224:227], a[196:199], a[4:7], v[224:227]
v_fma_f32 v213, v213, s27, -v247
v_mfma_f32_16x16x32_bf16 v[224:227], a[192:195], a[0:3], v[224:227]
v_exp_f32 v212, v212
v_mfma_f32_16x16x32_bf16 v[228:231], a[192:195], a[32:35], 0
v_fma_f32 v214, v214, s27, -v247
v_fma_f32 v215, v215, s27, -v247
v_mfma_f32_16x16x32_bf16 v[228:231], a[196:199], a[36:39], v[228:231]
ds_read_b128 a[248:251], v240 offset:17792
v_add_f32 v251, v251, v212
v_mfma_f32_16x16x32_bf16 v[228:231], a[200:203], a[40:43], v[228:231]
v_exp_f32 v213, v213
v_mfma_f32_16x16x32_bf16 v[228:231], a[204:207], a[44:47], v[228:231]
v_exp_f32 v214, v214
v_mfma_f32_16x16x32_bf16 v[228:231], a[208:211], a[48:51], v[228:231]
ds_read_b128 a[252:255], v240 offset:17856
v_add_f32 v251, v251, v213
v_mfma_f32_16x16x32_bf16 v[228:231], a[212:215], a[52:55], v[228:231]
v_cvt_pk_bf16_f32 v198, v212, v213
v_add_f32 v251, v251, v214
v_mfma_f32_16x16x32_bf16 v[228:231], a[216:219], a[56:59], v[228:231]
v_exp_f32 v215, v215
v_mfma_f32_16x16x32_bf16 v[228:231], a[220:223], a[60:63], v[228:231]
v_add_f32 v251, v251, v215
v_cvt_pk_bf16_f32 v199, v214, v215
v_mfma_f32_16x16x32_bf16 v[232:235], a[220:223], a[92:95], 0
v_fma_f32 v216, v216, s27, -v248
v_fma_f32 v217, v217, s27, -v248
v_mfma_f32_16x16x32_bf16 v[232:235], a[216:219], a[88:91], v[232:235]
v_exp_f32 v216, v216
v_mfma_f32_16x16x32_bf16 v[232:235], a[212:215], a[84:87], v[232:235]
v_fma_f32 v218, v218, s27, -v248
v_fma_f32 v219, v219, s27, -v248
v_mfma_f32_16x16x32_bf16 v[232:235], a[208:211], a[80:83], v[232:235]
v_exp_f32 v217, v217
v_mfma_f32_16x16x32_bf16 v[232:235], a[204:207], a[76:79], v[232:235]
v_add_f32 v252, v252, v216
v_mfma_f32_16x16x32_bf16 v[232:235], a[200:203], a[72:75], v[232:235]
v_exp_f32 v218, v218
v_mfma_f32_16x16x32_bf16 v[232:235], a[196:199], a[68:71], v[232:235]
s_waitcnt vmcnt(10) lgkmcnt(0)
v_add_f32 v252, v252, v217
v_cvt_pk_bf16_f32 v202, v216, v217
v_mfma_f32_16x16x32_bf16 v[232:235], a[192:195], a[64:67], v[232:235]
s_barrier
v_mfma_f32_16x16x32_bf16 v[220:223], a[224:227], a[96:99], 0
s_add_u32 m0, s26, 16896
v_exp_f32 v219, v219
v_mfma_f32_16x16x32_bf16 v[220:223], a[228:231], a[100:103], v[220:223]
buffer_load_dwordx4 v242, s[12:15], s29 offen offset:0 lds
v_mfma_f32_16x16x32_bf16 v[220:223], a[232:235], a[104:107], v[220:223]
ds_read_b64_tr_b16 a[192:193], v241 offset:0
v_add_f32 v252, v252, v218
v_mfma_f32_16x16x32_bf16 v[220:223], a[236:239], a[108:111], v[220:223]
ds_read_b64_tr_b16 a[194:195], v241 offset:512
v_add_f32 v252, v252, v219
v_mfma_f32_16x16x32_bf16 v[220:223], a[240:243], a[112:115], v[220:223]
ds_read_b64_tr_b16 a[196:197], v241 offset:16
v_cvt_pk_bf16_f32 v203, v218, v219
v_mfma_f32_16x16x32_bf16 v[220:223], a[244:247], a[116:119], v[220:223]
v_fma_f32 v236, v236, s27, -v249
v_fma_f32 v237, v237, s27, -v249
v_mfma_f32_16x16x32_bf16 v[220:223], a[248:251], a[120:123], v[220:223]
ds_read_b64_tr_b16 a[198:199], v241 offset:528
v_fma_f32 v238, v238, s27, -v249
v_mfma_f32_16x16x32_bf16 v[220:223], a[252:255], a[124:127], v[220:223]
s_add_u32 m0, s26, 16928
v_exp_f32 v236, v236
v_mfma_f32_16x16x32_bf16 v[208:211], a[252:255], a[28:31], 0
buffer_load_dwordx4 v242, s[12:15], s29 offen offset:1024 lds
v_mfma_f32_16x16x32_bf16 v[208:211], a[248:251], a[24:27], v[208:211]
ds_read_b64_tr_b16 a[200:201], v241 offset:32
v_fma_f32 v239, v239, s27, -v249
v_mfma_f32_16x16x32_bf16 v[208:211], a[244:247], a[20:23], v[208:211]
ds_read_b64_tr_b16 a[202:203], v241 offset:544
ds_read_b64_tr_b16 a[204:205], v241 offset:48
v_mfma_f32_16x16x32_bf16 v[208:211], a[240:243], a[16:19], v[208:211]
v_exp_f32 v237, v237
v_mfma_f32_16x16x32_bf16 v[208:211], a[236:239], a[12:15], v[208:211]
ds_read_b64_tr_b16 a[206:207], v241 offset:560
v_add_f32 v253, v253, v236
v_mfma_f32_16x16x32_bf16 v[208:211], a[232:235], a[8:11], v[208:211]
v_exp_f32 v238, v238
v_mfma_f32_16x16x32_bf16 v[208:211], a[228:231], a[4:7], v[208:211]
ds_read_b64_tr_b16 a[208:209], v241 offset:64
v_add_f32 v253, v253, v237
v_mfma_f32_16x16x32_bf16 v[208:211], a[224:227], a[0:3], v[208:211]
s_add_u32 m0, s26, 16960
ds_read_b64_tr_b16 a[210:211], v241 offset:576
v_cvt_pk_bf16_f32 v236, v236, v237
v_mfma_f32_16x16x32_bf16 v[212:215], a[224:227], a[32:35], 0
buffer_load_dwordx4 v242, s[12:15], s29 offen offset:2048 lds
v_mfma_f32_16x16x32_bf16 v[212:215], a[228:231], a[36:39], v[212:215]
v_exp_f32 v239, v239
v_mfma_f32_16x16x32_bf16 v[212:215], a[232:235], a[40:43], v[212:215]
ds_read_b64_tr_b16 a[212:213], v241 offset:80
v_add_f32 v253, v253, v238
v_mfma_f32_16x16x32_bf16 v[212:215], a[236:239], a[44:47], v[212:215]
ds_read_b64_tr_b16 a[214:215], v241 offset:592
v_add_f32 v253, v253, v239
v_mfma_f32_16x16x32_bf16 v[212:215], a[240:243], a[48:51], v[212:215]
v_cvt_pk_bf16_f32 v237, v238, v239
v_fma_f32 v224, v224, s27, -v246
v_mfma_f32_16x16x32_bf16 v[212:215], a[244:247], a[52:55], v[212:215]
ds_read_b64_tr_b16 a[216:217], v241 offset:96
v_fma_f32 v225, v225, s27, -v246
v_mfma_f32_16x16x32_bf16 v[212:215], a[248:251], a[56:59], v[212:215]
v_exp_f32 v224, v224
v_mfma_f32_16x16x32_bf16 v[212:215], a[252:255], a[60:63], v[212:215]
s_add_u32 m0, s26, 16992
ds_read_b64_tr_b16 a[218:219], v241 offset:608
v_fma_f32 v226, v226, s27, -v246
v_mfma_f32_16x16x32_bf16 v[216:219], a[252:255], a[92:95], 0
buffer_load_dwordx4 v242, s[12:15], s29 offen offset:3072 lds
v_mfma_f32_16x16x32_bf16 v[216:219], a[248:251], a[88:91], v[216:219]
s_add_u32 s29, s29, 16384
ds_read_b64_tr_b16 a[220:221], v241 offset:112
v_fma_f32 v227, v227, s27, -v246
v_mfma_f32_16x16x32_bf16 v[216:219], a[244:247], a[84:87], v[216:219]
v_exp_f32 v225, v225
v_mfma_f32_16x16x32_bf16 v[216:219], a[240:243], a[80:83], v[216:219]
ds_read_b64_tr_b16 a[222:223], v241 offset:624
v_add_f32 v250, v250, v224
v_mfma_f32_16x16x32_bf16 v[216:219], a[236:239], a[76:79], v[216:219]
v_exp_f32 v226, v226
v_mfma_f32_16x16x32_bf16 v[216:219], a[232:235], a[72:75], v[216:219]
v_add_f32 v250, v250, v225
v_cvt_pk_bf16_f32 v224, v224, v225
v_mfma_f32_16x16x32_bf16 v[216:219], a[228:231], a[68:71], v[216:219]
v_exp_f32 v227, v227
v_mfma_f32_16x16x32_bf16 v[216:219], a[224:227], a[64:67], v[216:219]
s_waitcnt lgkmcnt(14)
ds_read_b64_tr_b16 a[224:225], v241 offset:256
ds_read_b64_tr_b16 a[226:227], v241 offset:768
v_mfma_f32_16x16x32_bf16 v[0:3], v[192:195], a[192:195], v[0:3]
ds_read_b64_tr_b16 a[228:229], v241 offset:272
v_add_f32 v250, v250, v226
v_mfma_f32_16x16x32_bf16 v[64:67], v[196:199], a[192:195], v[64:67]
v_add_f32 v250, v250, v227
v_cvt_pk_bf16_f32 v225, v226, v227
v_mfma_f32_16x16x32_bf16 v[128:131], v[200:203], a[192:195], v[128:131]
s_waitcnt lgkmcnt(15)
ds_read_b64_tr_b16 a[230:231], v241 offset:784
v_fma_f32 v220, v220, s27, -v249
v_mfma_f32_16x16x32_bf16 v[132:135], v[200:203], a[196:199], v[132:135]
ds_read_b64_tr_b16 a[232:233], v241 offset:288
v_fma_f32 v221, v221, s27, -v249
v_mfma_f32_16x16x32_bf16 v[68:71], v[196:199], a[196:199], v[68:71]
v_exp_f32 v220, v220
v_mfma_f32_16x16x32_bf16 v[4:7], v[192:195], a[196:199], v[4:7]
s_waitcnt lgkmcnt(15)
ds_read_b64_tr_b16 a[234:235], v241 offset:800
v_fma_f32 v222, v222, s27, -v249
v_mfma_f32_16x16x32_bf16 v[8:11], v[192:195], a[200:203], v[8:11]
v_fma_f32 v223, v223, s27, -v249
v_mfma_f32_16x16x32_bf16 v[72:75], v[196:199], a[200:203], v[72:75]
ds_read_b64_tr_b16 a[236:237], v241 offset:304
v_mfma_f32_16x16x32_bf16 v[136:139], v[200:203], a[200:203], v[136:139]
s_waitcnt lgkmcnt(15)
v_exp_f32 v221, v221
v_mfma_f32_16x16x32_bf16 v[140:143], v[200:203], a[204:207], v[140:143]
ds_read_b64_tr_b16 a[238:239], v241 offset:816
v_add_f32 v253, v253, v220
v_mfma_f32_16x16x32_bf16 v[76:79], v[196:199], a[204:207], v[76:79]
v_exp_f32 v222, v222
v_mfma_f32_16x16x32_bf16 v[12:15], v[192:195], a[204:207], v[12:15]
s_waitcnt lgkmcnt(14)
ds_read_b64_tr_b16 a[240:241], v241 offset:320
v_add_f32 v253, v253, v221
v_mfma_f32_16x16x32_bf16 v[16:19], v[192:195], a[208:211], v[16:19]
ds_read_b64_tr_b16 a[242:243], v241 offset:832
v_cvt_pk_bf16_f32 v238, v220, v221
v_mfma_f32_16x16x32_bf16 v[80:83], v[196:199], a[208:211], v[80:83]
v_exp_f32 v223, v223
v_mfma_f32_16x16x32_bf16 v[144:147], v[200:203], a[208:211], v[144:147]
s_waitcnt lgkmcnt(14)
v_add_f32 v253, v253, v222
v_add_f32 v253, v253, v223
v_mfma_f32_16x16x32_bf16 v[148:151], v[200:203], a[212:215], v[148:151]
ds_read_b64_tr_b16 a[244:245], v241 offset:336
v_cvt_pk_bf16_f32 v239, v222, v223
v_mfma_f32_16x16x32_bf16 v[84:87], v[196:199], a[212:215], v[84:87]
ds_read_b64_tr_b16 a[246:247], v241 offset:848
ds_write_b128 v242, v[236:239] offset:34816
v_mfma_f32_16x16x32_bf16 v[20:23], v[192:195], a[212:215], v[20:23]
s_waitcnt lgkmcnt(15)
v_fma_f32 v228, v228, s27, -v247
v_fma_f32 v229, v229, s27, -v247
v_mfma_f32_16x16x32_bf16 v[24:27], v[192:195], a[216:219], v[24:27]
ds_read_b64_tr_b16 a[248:249], v241 offset:352
v_mfma_f32_16x16x32_bf16 v[88:91], v[196:199], a[216:219], v[88:91]
v_exp_f32 v228, v228
v_mfma_f32_16x16x32_bf16 v[152:155], v[200:203], a[216:219], v[152:155]
s_waitcnt lgkmcnt(14)
ds_read_b64_tr_b16 a[250:251], v241 offset:864
v_fma_f32 v230, v230, s27, -v247
v_mfma_f32_16x16x32_bf16 v[156:159], v[200:203], a[220:223], v[156:159]
ds_read_b64_tr_b16 a[252:253], v241 offset:368
v_fma_f32 v231, v231, s27, -v247
v_mfma_f32_16x16x32_bf16 v[92:95], v[196:199], a[220:223], v[92:95]
v_exp_f32 v229, v229
v_mfma_f32_16x16x32_bf16 v[28:31], v[192:195], a[220:223], v[28:31]
s_waitcnt lgkmcnt(14)
ds_read_b64_tr_b16 a[254:255], v241 offset:880
v_add_f32 v251, v251, v228
v_mfma_f32_16x16x32_bf16 v[32:35], v[192:195], a[224:227], v[32:35]
v_exp_f32 v230, v230
v_mfma_f32_16x16x32_bf16 v[96:99], v[196:199], a[224:227], v[96:99]
v_add_f32 v251, v251, v229
v_cvt_pk_bf16_f32 v228, v228, v229
v_mfma_f32_16x16x32_bf16 v[160:163], v[200:203], a[224:227], v[160:163]
s_waitcnt lgkmcnt(13)
v_exp_f32 v231, v231
v_mfma_f32_16x16x32_bf16 v[164:167], v[200:203], a[228:231], v[164:167]
v_add_f32 v251, v251, v230
v_add_f32 v251, v251, v231
v_mfma_f32_16x16x32_bf16 v[100:103], v[196:199], a[228:231], v[100:103]
v_cvt_pk_bf16_f32 v229, v230, v231
v_fma_f32 v232, v232, s27, -v248
v_mfma_f32_16x16x32_bf16 v[36:39], v[192:195], a[228:231], v[36:39]
s_waitcnt lgkmcnt(11)
v_fma_f32 v233, v233, s27, -v248
v_mfma_f32_16x16x32_bf16 v[40:43], v[192:195], a[232:235], v[40:43]
v_exp_f32 v232, v232
v_mfma_f32_16x16x32_bf16 v[104:107], v[196:199], a[232:235], v[104:107]
v_fma_f32 v234, v234, s27, -v248
v_fma_f32 v235, v235, s27, -v248
v_mfma_f32_16x16x32_bf16 v[168:171], v[200:203], a[232:235], v[168:171]
s_waitcnt vmcnt(9) lgkmcnt(0)
v_exp_f32 v233, v233
v_mfma_f32_16x16x32_bf16 v[172:175], v[200:203], a[236:239], v[172:175]
s_barrier
v_mfma_f32_16x16x32_bf16 v[108:111], v[196:199], a[236:239], v[108:111]
s_add_u32 m0, s3, 36864
ds_read_b128 a[192:195], v240 offset:0
v_add_f32 v252, v252, v232
v_mfma_f32_16x16x32_bf16 v[44:47], v[192:195], a[236:239], v[44:47]
buffer_load_dwordx4 v242, s[16:19], s30 offen offset:0 lds
v_mfma_f32_16x16x32_bf16 v[48:51], v[192:195], a[240:243], v[48:51]
ds_read_b128 a[196:199], v240 offset:64
ds_read_b128 a[200:203], v240 offset:128
v_mfma_f32_16x16x32_bf16 v[112:115], v[196:199], a[240:243], v[112:115]
s_add_u32 m0, s3, 36880
ds_read_b128 a[204:207], v240 offset:192
ds_read_b128 a[208:211], v240 offset:256
v_mfma_f32_16x16x32_bf16 v[176:179], v[200:203], a[240:243], v[176:179]
buffer_load_dwordx4 v242, s[16:19], s30 offen offset:1024 lds
v_mfma_f32_16x16x32_bf16 v[180:183], v[200:203], a[244:247], v[180:183]
v_exp_f32 v234, v234
v_mfma_f32_16x16x32_bf16 v[116:119], v[196:199], a[244:247], v[116:119]
s_add_u32 m0, s3, 36896
ds_read_b128 a[212:215], v240 offset:320
ds_read_b128 a[216:219], v240 offset:384
v_mfma_f32_16x16x32_bf16 v[52:55], v[192:195], a[244:247], v[52:55]
buffer_load_dwordx4 v242, s[16:19], s30 offen offset:2048 lds
v_mfma_f32_16x16x32_bf16 v[56:59], v[192:195], a[248:251], v[56:59]
ds_read_b128 a[220:223], v240 offset:448
v_add_f32 v252, v252, v233
v_mfma_f32_16x16x32_bf16 v[120:123], v[196:199], a[248:251], v[120:123]
s_add_u32 m0, s3, 36912
v_cvt_pk_bf16_f32 v232, v232, v233
v_mfma_f32_16x16x32_bf16 v[184:187], v[200:203], a[248:251], v[184:187]
buffer_load_dwordx4 v242, s[16:19], s30 offen offset:3072 lds
v_mfma_f32_16x16x32_bf16 v[188:191], v[200:203], a[252:255], v[188:191]
s_add_u32 s30, s30, 16384
v_exp_f32 v235, v235
v_mfma_f32_16x16x32_bf16 v[124:127], v[196:199], a[252:255], v[124:127]
v_add_f32 v252, v252, v234
v_add_f32 v252, v252, v235
v_mfma_f32_16x16x32_bf16 v[60:63], v[192:195], a[252:255], v[60:63]
s_sub_u32 s39, s39, 1
v_cvt_pk_bf16_f32 v233, v234, v235
s_cbranch_scc0 L_loopq
s_waitcnt lgkmcnt(7)
v_mfma_f32_16x16x32_bf16 v[204:207], a[192:195], a[96:99], 0
s_waitcnt lgkmcnt(6)
ds_read_b128 a[224:227], v240 offset:512
v_fma_f32 v208, v208, s27, -v246
v_mfma_f32_16x16x32_bf16 v[204:207], a[196:199], a[100:103], v[204:207]
s_waitcnt lgkmcnt(6)
v_fma_f32 v209, v209, s27, -v246
v_fma_f32 v210, v210, s27, -v246
v_mfma_f32_16x16x32_bf16 v[204:207], a[200:203], a[104:107], v[204:207]
s_waitcnt lgkmcnt(5)
v_exp_f32 v208, v208
v_mfma_f32_16x16x32_bf16 v[204:207], a[204:207], a[108:111], v[204:207]
s_waitcnt lgkmcnt(4)
ds_read_b128 a[228:231], v240 offset:576
v_fma_f32 v211, v211, s27, -v246
v_mfma_f32_16x16x32_bf16 v[204:207], a[208:211], a[112:115], v[204:207]
s_waitcnt lgkmcnt(4)
v_exp_f32 v209, v209
v_mfma_f32_16x16x32_bf16 v[204:207], a[212:215], a[116:119], v[204:207]
s_waitcnt lgkmcnt(3)
ds_read_b128 a[232:235], v240 offset:640
v_add_f32 v250, v250, v208
v_mfma_f32_16x16x32_bf16 v[204:207], a[216:219], a[120:123], v[204:207]
s_waitcnt lgkmcnt(3)
v_exp_f32 v210, v210
v_mfma_f32_16x16x32_bf16 v[204:207], a[220:223], a[124:127], v[204:207]
v_add_f32 v250, v250, v209
v_cvt_pk_bf16_f32 v226, v208, v209
v_mfma_f32_16x16x32_bf16 v[192:195], a[220:223], a[28:31], 0
s_add_u32 m0, s5, 0
v_exp_f32 v211, v211
v_mfma_f32_16x16x32_bf16 v[192:195], a[216:219], a[24:27], v[192:195]
buffer_load_dwordx4 v243, s[8:11], s38 offen nt lds
v_mfma_f32_16x16x32_bf16 v[192:195], a[212:215], a[20:23], v[192:195]
s_add_u32 s38, s38, 512
ds_read_b128 a[236:239], v240 offset:704
v_add_f32 v250, v250, v210
v_mfma_f32_16x16x32_bf16 v[192:195], a[208:211], a[16:19], v[192:195]
ds_read_b128 a[240:243], v240 offset:768
v_add_f32 v250, v250, v211
v_mfma_f32_16x16x32_bf16 v[192:195], a[204:207], a[12:15], v[192:195]
v_cvt_pk_bf16_f32 v227, v210, v211
v_fma_f32 v212, v212, s27, -v247
v_mfma_f32_16x16x32_bf16 v[192:195], a[200:203], a[8:11], v[192:195]
ds_read_b128 a[244:247], v240 offset:832
v_fma_f32 v213, v213, s27, -v247
v_mfma_f32_16x16x32_bf16 v[192:195], a[196:199], a[4:7], v[192:195]
v_exp_f32 v212, v212
v_mfma_f32_16x16x32_bf16 v[192:195], a[192:195], a[0:3], v[192:195]
v_fma_f32 v214, v214, s27, -v247
v_fma_f32 v215, v215, s27, -v247
v_mfma_f32_16x16x32_bf16 v[196:199], a[192:195], a[32:35], 0
v_exp_f32 v213, v213
v_mfma_f32_16x16x32_bf16 v[196:199], a[196:199], a[36:39], v[196:199]
ds_read_b128 a[248:251], v240 offset:896
v_add_f32 v251, v251, v212
v_mfma_f32_16x16x32_bf16 v[196:199], a[200:203], a[40:43], v[196:199]
s_add_u32 m0, s5, 8448
v_exp_f32 v214, v214
v_mfma_f32_16x16x32_bf16 v[196:199], a[204:207], a[44:47], v[196:199]
s_add_u32 s5, s5, 1056
buffer_load_dwordx4 v243, s[8:11], s33 offen nt lds
v_mfma_f32_16x16x32_bf16 v[196:199], a[208:211], a[48:51], v[196:199]
s_add_u32 s33, s33, 512
ds_read_b128 a[252:255], v240 offset:960
v_add_f32 v251, v251, v213
v_mfma_f32_16x16x32_bf16 v[196:199], a[212:215], a[52:55], v[196:199]
v_cvt_pk_bf16_f32 v230, v212, v213
v_add_f32 v251, v251, v214
v_mfma_f32_16x16x32_bf16 v[196:199], a[216:219], a[56:59], v[196:199]
v_exp_f32 v215, v215
v_mfma_f32_16x16x32_bf16 v[196:199], a[220:223], a[60:63], v[196:199]
v_add_f32 v251, v251, v215
v_cvt_pk_bf16_f32 v231, v214, v215
v_mfma_f32_16x16x32_bf16 v[200:203], a[220:223], a[92:95], 0
v_fma_f32 v216, v216, s27, -v248
v_fma_f32 v217, v217, s27, -v248
v_mfma_f32_16x16x32_bf16 v[200:203], a[216:219], a[88:91], v[200:203]
v_exp_f32 v216, v216
v_mfma_f32_16x16x32_bf16 v[200:203], a[212:215], a[84:87], v[200:203]
v_fma_f32 v218, v218, s27, -v248
v_fma_f32 v219, v219, s27, -v248
v_mfma_f32_16x16x32_bf16 v[200:203], a[208:211], a[80:83], v[200:203]
v_exp_f32 v217, v217
v_mfma_f32_16x16x32_bf16 v[200:203], a[204:207], a[76:79], v[200:203]
v_add_f32 v252, v252, v216
v_add_f32 v252, v252, v217
v_mfma_f32_16x16x32_bf16 v[200:203], a[200:203], a[72:75], v[200:203]
v_exp_f32 v218, v218
v_mfma_f32_16x16x32_bf16 v[200:203], a[196:199], a[68:71], v[200:203]
s_waitcnt vmcnt(11) lgkmcnt(0)
v_cvt_pk_bf16_f32 v234, v216, v217
v_add_f32 v252, v252, v218
v_mfma_f32_16x16x32_bf16 v[200:203], a[192:195], a[64:67], v[200:203]
s_barrier
v_mfma_f32_16x16x32_bf16 v[220:223], a[224:227], a[96:99], 0
s_mov_b32 s29, s32
s_add_u32 m0, s26, 0
v_fma_f32 v204, v204, s27, -v249
v_mfma_f32_16x16x32_bf16 v[220:223], a[228:231], a[100:103], v[220:223]
buffer_load_dwordx4 v242, s[12:15], s29 offen offset:0 lds
v_mfma_f32_16x16x32_bf16 v[220:223], a[232:235], a[104:107], v[220:223]
v_exp_f32 v219, v219
v_mfma_f32_16x16x32_bf16 v[220:223], a[236:239], a[108:111], v[220:223]
v_add_f32 v252, v252, v219
v_cvt_pk_bf16_f32 v235, v218, v219
v_mfma_f32_16x16x32_bf16 v[220:223], a[240:243], a[112:115], v[220:223]
ds_read_b64_tr_b16 a[192:193], v241 offset:16640
v_fma_f32 v205, v205, s27, -v249
v_mfma_f32_16x16x32_bf16 v[220:223], a[244:247], a[116:119], v[220:223]
ds_read_b64_tr_b16 a[194:195], v241 offset:17152
ds_read_b64_tr_b16 a[196:197], v241 offset:16656
v_mfma_f32_16x16x32_bf16 v[220:223], a[248:251], a[120:123], v[220:223]
v_exp_f32 v204, v204
v_mfma_f32_16x16x32_bf16 v[220:223], a[252:255], a[124:127], v[220:223]
s_add_u32 m0, s26, 32
v_fma_f32 v206, v206, s27, -v249
v_fma_f32 v207, v207, s27, -v249
v_mfma_f32_16x16x32_bf16 v[208:211], a[252:255], a[28:31], 0
buffer_load_dwordx4 v242, s[12:15], s29 offen offset:1024 lds
v_mfma_f32_16x16x32_bf16 v[208:211], a[248:251], a[24:27], v[208:211]
v_exp_f32 v205, v205
v_mfma_f32_16x16x32_bf16 v[208:211], a[244:247], a[20:23], v[208:211]
ds_read_b64_tr_b16 a[198:199], v241 offset:17168
v_add_f32 v253, v253, v204
v_mfma_f32_16x16x32_bf16 v[208:211], a[240:243], a[16:19], v[208:211]
v_exp_f32 v206, v206
v_mfma_f32_16x16x32_bf16 v[208:211], a[236:239], a[12:15], v[208:211]
ds_read_b64_tr_b16 a[200:201], v241 offset:16672
ds_read_b64_tr_b16 a[202:203], v241 offset:17184
v_mfma_f32_16x16x32_bf16 v[208:211], a[232:235], a[8:11], v[208:211]
v_add_f32 v253, v253, v205
v_cvt_pk_bf16_f32 v204, v204, v205
v_mfma_f32_16x16x32_bf16 v[208:211], a[228:231], a[4:7], v[208:211]
ds_read_b64_tr_b16 a[204:205], v241 offset:16688
v_add_f32 v253, v253, v206
v_mfma_f32_16x16x32_bf16 v[208:211], a[224:227], a[0:3], v[208:211]
s_add_u32 m0, s26, 64
v_exp_f32 v207, v207
v_mfma_f32_16x16x32_bf16 v[212:215], a[224:227], a[32:35], 0
buffer_load_dwordx4 v242, s[12:15], s29 offen offset:2048 lds
v_mfma_f32_16x16x32_bf16 v[212:215], a[228:231], a[36:39], v[212:215]
ds_read_b64_tr_b16 a[206:207], v241 offset:17200
v_add_f32 v253, v253, v207
v_mfma_f32_16x16x32_bf16 v[212:215], a[232:235], a[40:43], v[212:215]
v_cvt_pk_bf16_f32 v205, v206, v207
v_fma_f32 v192, v192, s27, -v246
v_mfma_f32_16x16x32_bf16 v[212:215], a[236:239], a[44:47], v[212:215]
ds_read_b64_tr_b16 a[208:209], v241 offset:16704
v_fma_f32 v193, v193, s27, -v246
v_mfma_f32_16x16x32_bf16 v[212:215], a[240:243], a[48:51], v[212:215]
ds_read_b64_tr_b16 a[210:211], v241 offset:17216
v_fma_f32 v194, v194, s27, -v246
v_mfma_f32_16x16x32_bf16 v[212:215], a[244:247], a[52:55], v[212:215]
v_exp_f32 v192, v192
v_mfma_f32_16x16x32_bf16 v[212:215], a[248:251], a[56:59], v[212:215]
ds_read_b64_tr_b16 a[212:213], v241 offset:16720
v_fma_f32 v195, v195, s27, -v246
v_mfma_f32_16x16x32_bf16 v[212:215], a[252:255], a[60:63], v[212:215]
s_add_u32 m0, s26, 96
ds_read_b64_tr_b16 a[214:215], v241 offset:17232
v_add_f32 v250, v250, v192
v_mfma_f32_16x16x32_bf16 v[216:219], a[252:255], a[92:95], 0
buffer_load_dwordx4 v242, s[12:15], s29 offen offset:3072 lds
v_mfma_f32_16x16x32_bf16 v[216:219], a[248:251], a[88:91], v[216:219]
s_add_u32 s29, s29, 16384
v_exp_f32 v193, v193
v_mfma_f32_16x16x32_bf16 v[216:219], a[244:247], a[84:87], v[216:219]
ds_read_b64_tr_b16 a[216:217], v241 offset:16736
v_add_f32 v250, v250, v193
v_mfma_f32_16x16x32_bf16 v[216:219], a[240:243], a[80:83], v[216:219]
v_exp_f32 v194, v194
v_mfma_f32_16x16x32_bf16 v[216:219], a[236:239], a[76:79], v[216:219]
ds_read_b64_tr_b16 a[218:219], v241 offset:17248
v_cvt_pk_bf16_f32 v192, v192, v193
v_mfma_f32_16x16x32_bf16 v[216:219], a[232:235], a[72:75], v[216:219]
v_exp_f32 v195, v195
v_mfma_f32_16x16x32_bf16 v[216:219], a[228:231], a[68:71], v[216:219]
ds_read_b64_tr_b16 a[220:221], v241 offset:16752
v_add_f32 v250, v250, v194
v_mfma_f32_16x16x32_bf16 v[216:219], a[224:227], a[64:67], v[216:219]
s_waitcnt lgkmcnt(13)
ds_read_b64_tr_b16 a[222:223], v241 offset:17264
v_add_f32 v250, v250, v195
v_mfma_f32_16x16x32_bf16 v[0:3], v[224:227], a[192:195], v[0:3]
v_cvt_pk_bf16_f32 v193, v194, v195
v_fma_f32 v220, v220, s27, -v249
v_mfma_f32_16x16x32_bf16 v[64:67], v[228:231], a[192:195], v[64:67]
ds_read_b64_tr_b16 a[224:225], v241 offset:16896
v_fma_f32 v221, v221, s27, -v249
v_mfma_f32_16x16x32_bf16 v[128:131], v[232:235], a[192:195], v[128:131]
s_waitcnt lgkmcnt(13)
v_exp_f32 v220, v220
v_mfma_f32_16x16x32_bf16 v[132:135], v[232:235], a[196:199], v[132:135]
ds_read_b64_tr_b16 a[226:227], v241 offset:17408
v_fma_f32 v222, v222, s27, -v249
v_mfma_f32_16x16x32_bf16 v[68:71], v[228:231], a[196:199], v[68:71]
ds_read_b64_tr_b16 a[228:229], v241 offset:16912
v_fma_f32 v223, v223, s27, -v249
v_mfma_f32_16x16x32_bf16 v[4:7], v[224:227], a[196:199], v[4:7]
s_waitcnt lgkmcnt(13)
v_exp_f32 v221, v221
v_mfma_f32_16x16x32_bf16 v[8:11], v[224:227], a[200:203], v[8:11]
ds_read_b64_tr_b16 a[230:231], v241 offset:17424
v_add_f32 v253, v253, v220
v_mfma_f32_16x16x32_bf16 v[72:75], v[228:231], a[200:203], v[72:75]
v_exp_f32 v222, v222
v_mfma_f32_16x16x32_bf16 v[136:139], v[232:235], a[200:203], v[136:139]
s_waitcnt lgkmcnt(12)
v_add_f32 v253, v253, v221
v_cvt_pk_bf16_f32 v206, v220, v221
v_mfma_f32_16x16x32_bf16 v[140:143], v[232:235], a[204:207], v[140:143]
ds_read_b64_tr_b16 a[232:233], v241 offset:16928
v_add_f32 v253, v253, v222
v_mfma_f32_16x16x32_bf16 v[76:79], v[228:231], a[204:207], v[76:79]
v_exp_f32 v223, v223
v_mfma_f32_16x16x32_bf16 v[12:15], v[224:227], a[204:207], v[12:15]
s_waitcnt lgkmcnt(11)
ds_read_b64_tr_b16 a[234:235], v241 offset:17440
v_add_f32 v253, v253, v223
v_mfma_f32_16x16x32_bf16 v[16:19], v[224:227], a[208:211], v[16:19]
ds_read_b64_tr_b16 a[236:237], v241 offset:16944
v_cvt_pk_bf16_f32 v207, v222, v223
v_mfma_f32_16x16x32_bf16 v[80:83], v[228:231], a[208:211], v[80:83]
ds_write_b128 v242, v[204:207] offset:33792
v_fma_f32 v196, v196, s27, -v247
v_mfma_f32_16x16x32_bf16 v[144:147], v[232:235], a[208:211], v[144:147]
s_waitcnt lgkmcnt(12)
ds_read_b64_tr_b16 a[238:239], v241 offset:17456
v_fma_f32 v197, v197, s27, -v247
v_mfma_f32_16x16x32_bf16 v[148:151], v[232:235], a[212:215], v[148:151]
v_exp_f32 v196, v196
v_mfma_f32_16x16x32_bf16 v[84:87], v[228:231], a[212:215], v[84:87]
ds_read_b64_tr_b16 a[240:241], v241 offset:16960
v_fma_f32 v198, v198, s27, -v247
v_mfma_f32_16x16x32_bf16 v[20:23], v[224:227], a[212:215], v[20:23]
s_waitcnt lgkmcnt(12)
ds_read_b64_tr_b16 a[242:243], v241 offset:17472
v_fma_f32 v199, v199, s27, -v247
v_mfma_f32_16x16x32_bf16 v[24:27], v[224:227], a[216:219], v[24:27]
v_exp_f32 v197, v197
v_mfma_f32_16x16x32_bf16 v[88:91], v[228:231], a[216:219], v[88:91]
ds_read_b64_tr_b16 a[244:245], v241 offset:16976
v_add_f32 v251, v251, v196
v_mfma_f32_16x16x32_bf16 v[152:155], v[232:235], a[216:219], v[152:155]
s_waitcnt lgkmcnt(12)
v_exp_f32 v198, v198
v_mfma_f32_16x16x32_bf16 v[156:159], v[232:235], a[220:223], v[156:159]
ds_read_b64_tr_b16 a[246:247], v241 offset:17488
v_add_f32 v251, v251, v197
v_mfma_f32_16x16x32_bf16 v[92:95], v[228:231], a[220:223], v[92:95]
ds_read_b64_tr_b16 a[248:249], v241 offset:16992
v_cvt_pk_bf16_f32 v196, v196, v197
v_mfma_f32_16x16x32_bf16 v[28:31], v[224:227], a[220:223], v[28:31]
s_waitcnt lgkmcnt(12)
v_exp_f32 v199, v199
v_mfma_f32_16x16x32_bf16 v[32:35], v[224:227], a[224:227], v[32:35]
v_add_f32 v251, v251, v198
v_add_f32 v251, v251, v199
v_mfma_f32_16x16x32_bf16 v[96:99], v[228:231], a[224:227], v[96:99]
ds_read_b64_tr_b16 a[250:251], v241 offset:17504
v_cvt_pk_bf16_f32 v197, v198, v199
v_mfma_f32_16x16x32_bf16 v[160:163], v[232:235], a[224:227], v[160:163]
s_waitcnt lgkmcnt(11)
v_fma_f32 v200, v200, s27, -v248
v_fma_f32 v201, v201, s27, -v248
v_mfma_f32_16x16x32_bf16 v[164:167], v[232:235], a[228:231], v[164:167]
v_exp_f32 v200, v200
v_mfma_f32_16x16x32_bf16 v[100:103], v[228:231], a[228:231], v[100:103]
ds_read_b64_tr_b16 a[252:253], v241 offset:17008
v_fma_f32 v202, v202, s27, -v248
v_mfma_f32_16x16x32_bf16 v[36:39], v[224:227], a[228:231], v[36:39]
s_waitcnt lgkmcnt(10)
ds_read_b64_tr_b16 a[254:255], v241 offset:17520
v_fma_f32 v203, v203, s27, -v248
v_mfma_f32_16x16x32_bf16 v[40:43], v[224:227], a[232:235], v[40:43]
v_exp_f32 v201, v201
v_mfma_f32_16x16x32_bf16 v[104:107], v[228:231], a[232:235], v[104:107]
v_add_f32 v252, v252, v200
v_add_f32 v252, v252, v201
v_mfma_f32_16x16x32_bf16 v[168:171], v[232:235], a[232:235], v[168:171]
s_waitcnt vmcnt(10) lgkmcnt(0)
v_exp_f32 v202, v202
v_mfma_f32_16x16x32_bf16 v[172:175], v[232:235], a[236:239], v[172:175]
s_barrier
v_mfma_f32_16x16x32_bf16 v[108:111], v[228:231], a[236:239], v[108:111]
s_add_u32 m0, s3, 53504
v_cvt_pk_bf16_f32 v200, v200, v201
v_add_f32 v252, v252, v202
v_mfma_f32_16x16x32_bf16 v[44:47], v[224:227], a[236:239], v[44:47]
buffer_load_dwordx4 v242, s[16:19], s30 offen offset:0 lds
v_mfma_f32_16x16x32_bf16 v[48:51], v[224:227], a[240:243], v[48:51]
v_exp_f32 v203, v203
v_mfma_f32_16x16x32_bf16 v[112:115], v[228:231], a[240:243], v[112:115]
s_add_u32 m0, s3, 53520
v_add_f32 v252, v252, v203
v_cvt_pk_bf16_f32 v201, v202, v203
v_mfma_f32_16x16x32_bf16 v[176:179], v[232:235], a[240:243], v[176:179]
buffer_load_dwordx4 v242, s[16:19], s30 offen offset:1024 lds
v_mfma_f32_16x16x32_bf16 v[180:183], v[232:235], a[244:247], v[180:183]
v_fma_f32 v208, v208, s27, -v246
v_fma_f32 v209, v209, s27, -v246
v_mfma_f32_16x16x32_bf16 v[116:119], v[228:231], a[244:247], v[116:119]
s_add_u32 m0, s3, 53536
v_exp_f32 v208, v208
v_mfma_f32_16x16x32_bf16 v[52:55], v[224:227], a[244:247], v[52:55]
buffer_load_dwordx4 v242, s[16:19], s30 offen offset:2048 lds
v_mfma_f32_16x16x32_bf16 v[56:59], v[224:227], a[248:251], v[56:59]
v_fma_f32 v210, v210, s27, -v246
v_fma_f32 v211, v211, s27, -v246
v_mfma_f32_16x16x32_bf16 v[120:123], v[228:231], a[248:251], v[120:123]
s_add_u32 m0, s3, 53552
ds_read_b128 a[192:195], v240 offset:16896
ds_read_b128 a[196:199], v240 offset:16960
v_mfma_f32_16x16x32_bf16 v[184:187], v[232:235], a[248:251], v[184:187]
buffer_load_dwordx4 v242, s[16:19], s30 offen offset:3072 lds
v_mfma_f32_16x16x32_bf16 v[188:191], v[232:235], a[252:255], v[188:191]
s_add_u32 s30, s30, 16384
v_exp_f32 v209, v209
v_mfma_f32_16x16x32_bf16 v[124:127], v[228:231], a[252:255], v[124:127]
v_exp_f32 v210, v210
v_exp_f32 v211, v211
v_mfma_f32_16x16x32_bf16 v[60:63], v[224:227], a[252:255], v[60:63]
s_waitcnt lgkmcnt(1)
ds_read_b128 a[200:203], v240 offset:17024
ds_read_b128 a[204:207], v240 offset:17088
ds_read_b128 a[208:211], v240 offset:17152
ds_read_b128 a[212:215], v240 offset:17216
ds_read_b128 a[216:219], v240 offset:17280
ds_read_b128 a[220:223], v240 offset:17344
v_add_f32 v250, v250, v208
v_add_f32 v250, v250, v209
v_cvt_pk_bf16_f32 v194, v208, v209
v_add_f32 v250, v250, v210
v_add_f32 v250, v250, v211
v_cvt_pk_bf16_f32 v195, v210, v211
v_mfma_f32_16x16x32_bf16 v[236:239], a[192:195], a[96:99], 0
s_waitcnt lgkmcnt(6)
ds_read_b128 a[224:227], v240 offset:17408
v_fma_f32 v212, v212, s27, -v247
v_mfma_f32_16x16x32_bf16 v[236:239], a[196:199], a[100:103], v[236:239]
s_waitcnt lgkmcnt(6)
v_fma_f32 v213, v213, s27, -v247
v_fma_f32 v214, v214, s27, -v247
v_mfma_f32_16x16x32_bf16 v[236:239], a[200:203], a[104:107], v[236:239]
s_waitcnt lgkmcnt(5)
v_exp_f32 v212, v212
v_mfma_f32_16x16x32_bf16 v[236:239], a[204:207], a[108:111], v[236:239]
s_waitcnt lgkmcnt(4)
ds_read_b128 a[228:231], v240 offset:17472
v_fma_f32 v215, v215, s27, -v247
v_mfma_f32_16x16x32_bf16 v[236:239], a[208:211], a[112:115], v[236:239]
s_waitcnt lgkmcnt(4)
v_exp_f32 v213, v213
v_mfma_f32_16x16x32_bf16 v[236:239], a[212:215], a[116:119], v[236:239]
s_waitcnt lgkmcnt(3)
v_add_f32 v251, v251, v212
v_add_f32 v251, v251, v213
v_mfma_f32_16x16x32_bf16 v[236:239], a[216:219], a[120:123], v[236:239]
s_waitcnt lgkmcnt(2)
v_exp_f32 v214, v214
v_mfma_f32_16x16x32_bf16 v[236:239], a[220:223], a[124:127], v[236:239]
ds_read_b128 a[232:235], v240 offset:17536
v_cvt_pk_bf16_f32 v198, v212, v213
v_mfma_f32_16x16x32_bf16 v[224:227], a[220:223], a[28:31], 0
v_exp_f32 v215, v215
v_mfma_f32_16x16x32_bf16 v[224:227], a[216:219], a[24:27], v[224:227]
v_add_f32 v251, v251, v214
v_add_f32 v251, v251, v215
v_mfma_f32_16x16x32_bf16 v[224:227], a[212:215], a[20:23], v[224:227]
ds_read_b128 a[236:239], v240 offset:17600
v_cvt_pk_bf16_f32 v199, v214, v215
v_mfma_f32_16x16x32_bf16 v[224:227], a[208:211], a[16:19], v[224:227]
v_fma_f32 v216, v216, s27, -v248
v_fma_f32 v217, v217, s27, -v248
v_mfma_f32_16x16x32_bf16 v[224:227], a[204:207], a[12:15], v[224:227]
v_exp_f32 v216, v216
v_mfma_f32_16x16x32_bf16 v[224:227], a[200:203], a[8:11], v[224:227]
ds_read_b128 a[240:243], v240 offset:17664
v_fma_f32 v218, v218, s27, -v248
v_mfma_f32_16x16x32_bf16 v[224:227], a[196:199], a[4:7], v[224:227]
v_fma_f32 v219, v219, s27, -v248
v_add_f32 v252, v252, v216
v_mfma_f32_16x16x32_bf16 v[224:227], a[192:195], a[0:3], v[224:227]
v_exp_f32 v217, v217
v_mfma_f32_16x16x32_bf16 v[228:231], a[192:195], a[32:35], 0
v_exp_f32 v218, v218
v_mfma_f32_16x16x32_bf16 v[228:231], a[196:199], a[36:39], v[228:231]
ds_read_b128 a[244:247], v240 offset:17728
v_add_f32 v252, v252, v217
v_mfma_f32_16x16x32_bf16 v[228:231], a[200:203], a[40:43], v[228:231]
v_cvt_pk_bf16_f32 v202, v216, v217
v_add_f32 v252, v252, v218
v_mfma_f32_16x16x32_bf16 v[228:231], a[204:207], a[44:47], v[228:231]
v_exp_f32 v219, v219
v_mfma_f32_16x16x32_bf16 v[228:231], a[208:211], a[48:51], v[228:231]
ds_read_b128 a[248:251], v240 offset:17792
v_add_f32 v252, v252, v219
v_mfma_f32_16x16x32_bf16 v[228:231], a[212:215], a[52:55], v[228:231]
v_cvt_pk_bf16_f32 v203, v218, v219
v_fma_f32 v236, v236, s27, -v249
v_mfma_f32_16x16x32_bf16 v[228:231], a[216:219], a[56:59], v[228:231]
v_fma_f32 v237, v237, s27, -v249
v_fma_f32 v238, v238, s27, -v249
v_mfma_f32_16x16x32_bf16 v[228:231], a[220:223], a[60:63], v[228:231]
v_exp_f32 v236, v236
v_mfma_f32_16x16x32_bf16 v[232:235], a[220:223], a[92:95], 0
ds_read_b128 a[252:255], v240 offset:17856
v_fma_f32 v239, v239, s27, -v249
v_mfma_f32_16x16x32_bf16 v[232:235], a[216:219], a[88:91], v[232:235]
v_exp_f32 v237, v237
v_mfma_f32_16x16x32_bf16 v[232:235], a[212:215], a[84:87], v[232:235]
v_add_f32 v253, v253, v236
v_add_f32 v253, v253, v237
v_mfma_f32_16x16x32_bf16 v[232:235], a[208:211], a[80:83], v[232:235]
v_exp_f32 v238, v238
v_mfma_f32_16x16x32_bf16 v[232:235], a[204:207], a[76:79], v[232:235]
v_cvt_pk_bf16_f32 v236, v236, v237
v_add_f32 v253, v253, v238
v_mfma_f32_16x16x32_bf16 v[232:235], a[200:203], a[72:75], v[232:235]
v_exp_f32 v239, v239
v_mfma_f32_16x16x32_bf16 v[232:235], a[196:199], a[68:71], v[232:235]
s_waitcnt vmcnt(10) lgkmcnt(0)
v_add_f32 v253, v253, v239
v_cvt_pk_bf16_f32 v237, v238, v239
v_mfma_f32_16x16x32_bf16 v[232:235], a[192:195], a[64:67], v[232:235]
s_barrier
v_mfma_f32_16x16x32_bf16 v[220:223], a[224:227], a[96:99], 0
s_add_u32 m0, s26, 16896
v_fma_f32 v224, v224, s27, -v246
v_fma_f32 v225, v225, s27, -v246
v_mfma_f32_16x16x32_bf16 v[220:223], a[228:231], a[100:103], v[220:223]
buffer_load_dwordx4 v242, s[12:15], s29 offen offset:0 lds
v_mfma_f32_16x16x32_bf16 v[220:223], a[232:235], a[104:107], v[220:223]
v_exp_f32 v224, v224
v_mfma_f32_16x16x32_bf16 v[220:223], a[236:239], a[108:111], v[220:223]
v_fma_f32 v226, v226, s27, -v246
v_fma_f32 v227, v227, s27, -v246
v_mfma_f32_16x16x32_bf16 v[220:223], a[240:243], a[112:115], v[220:223]
v_exp_f32 v225, v225
v_mfma_f32_16x16x32_bf16 v[220:223], a[244:247], a[116:119], v[220:223]
s_add_u32 m0, s26, 16928
v_add_f32 v250, v250, v224
v_add_f32 v250, v250, v225
v_mfma_f32_16x16x32_bf16 v[220:223], a[248:251], a[120:123], v[220:223]
buffer_load_dwordx4 v242, s[12:15], s29 offen offset:1024 lds
v_mfma_f32_16x16x32_bf16 v[220:223], a[252:255], a[124:127], v[220:223]
v_exp_f32 v226, v226
v_mfma_f32_16x16x32_bf16 v[208:211], a[252:255], a[28:31], 0
v_cvt_pk_bf16_f32 v224, v224, v225
v_add_f32 v250, v250, v226
v_mfma_f32_16x16x32_bf16 v[208:211], a[248:251], a[24:27], v[208:211]
v_exp_f32 v227, v227
v_mfma_f32_16x16x32_bf16 v[208:211], a[244:247], a[20:23], v[208:211]
s_add_u32 m0, s26, 16960
v_add_f32 v250, v250, v227
v_cvt_pk_bf16_f32 v225, v226, v227
v_mfma_f32_16x16x32_bf16 v[208:211], a[240:243], a[16:19], v[208:211]
buffer_load_dwordx4 v242, s[12:15], s29 offen offset:2048 lds
v_mfma_f32_16x16x32_bf16 v[208:211], a[236:239], a[12:15], v[208:211]
ds_read_b64_tr_b16 a[192:193], v241 offset:0
v_fma_f32 v220, v220, s27, -v249
v_mfma_f32_16x16x32_bf16 v[208:211], a[232:235], a[8:11], v[208:211]
ds_read_b64_tr_b16 a[194:195], v241 offset:512
v_fma_f32 v221, v221, s27, -v249
v_mfma_f32_16x16x32_bf16 v[208:211], a[228:231], a[4:7], v[208:211]
v_exp_f32 v220, v220
v_mfma_f32_16x16x32_bf16 v[208:211], a[224:227], a[0:3], v[208:211]
s_add_u32 m0, s26, 16992
ds_read_b64_tr_b16 a[196:197], v241 offset:16
v_fma_f32 v222, v222, s27, -v249
v_mfma_f32_16x16x32_bf16 v[212:215], a[224:227], a[32:35], 0
s_waitcnt vmcnt(11)
buffer_load_dwordx4 v242, s[12:15], s29 offen offset:3072 lds
v_mfma_f32_16x16x32_bf16 v[212:215], a[228:231], a[36:39], v[212:215]
s_add_u32 s29, s29, 16384
ds_read_b64_tr_b16 a[198:199], v241 offset:528
v_fma_f32 v223, v223, s27, -v249
v_mfma_f32_16x16x32_bf16 v[212:215], a[232:235], a[40:43], v[212:215]
v_exp_f32 v221, v221
v_mfma_f32_16x16x32_bf16 v[212:215], a[236:239], a[44:47], v[212:215]
ds_read_b64_tr_b16 a[200:201], v241 offset:32
v_add_f32 v253, v253, v220
v_mfma_f32_16x16x32_bf16 v[212:215], a[240:243], a[48:51], v[212:215]
v_exp_f32 v222, v222
v_mfma_f32_16x16x32_bf16 v[212:215], a[244:247], a[52:55], v[212:215]
v_add_f32 v253, v253, v221
v_cvt_pk_bf16_f32 v238, v220, v221
v_mfma_f32_16x16x32_bf16 v[212:215], a[248:251], a[56:59], v[212:215]
ds_read_b64_tr_b16 a[202:203], v241 offset:544
ds_read_b64_tr_b16 a[204:205], v241 offset:48
v_mfma_f32_16x16x32_bf16 v[212:215], a[252:255], a[60:63], v[212:215]
v_exp_f32 v223, v223
v_mfma_f32_16x16x32_bf16 v[216:219], a[252:255], a[92:95], 0
v_add_f32 v253, v253, v222
v_add_f32 v253, v253, v223
v_mfma_f32_16x16x32_bf16 v[216:219], a[248:251], a[88:91], v[216:219]
ds_read_b64_tr_b16 a[206:207], v241 offset:560
v_cvt_pk_bf16_f32 v239, v222, v223
v_mfma_f32_16x16x32_bf16 v[216:219], a[244:247], a[84:87], v[216:219]
ds_write_b128 v242, v[236:239] offset:34816
ds_write_b32 v242, v253 offset:35840
v_mfma_f32_16x16x32_bf16 v[216:219], a[240:243], a[80:83], v[216:219]
v_fma_f32 v228, v228, s27, -v247
v_fma_f32 v229, v229, s27, -v247
v_mfma_f32_16x16x32_bf16 v[216:219], a[236:239], a[76:79], v[216:219]
ds_read_b128 a[0:3], v255 offset:0
ds_read_b64_tr_b16 a[208:209], v241 offset:64
v_mfma_f32_16x16x32_bf16 v[216:219], a[232:235], a[72:75], v[216:219]
ds_read_b128 a[4:7], v255 offset:64
ds_read_b64_tr_b16 a[210:211], v241 offset:576
v_mfma_f32_16x16x32_bf16 v[216:219], a[228:231], a[68:71], v[216:219]
ds_read_b128 a[8:11], v255 offset:128
ds_read_b128 a[12:15], v255 offset:192
v_mfma_f32_16x16x32_bf16 v[216:219], a[224:227], a[64:67], v[216:219]
s_waitcnt lgkmcnt(14)
ds_read_b128 a[16:19], v255 offset:256
ds_read_b64_tr_b16 a[212:213], v241 offset:80
v_mfma_f32_16x16x32_bf16 v[0:3], v[192:195], a[192:195], v[0:3]
ds_read_b128 a[20:23], v255 offset:320
ds_read_b64_tr_b16 a[214:215], v241 offset:592
v_mfma_f32_16x16x32_bf16 v[64:67], v[196:199], a[192:195], v[64:67]
ds_read_b128 a[24:27], v255 offset:384
ds_read_b64_tr_b16 a[216:217], v241 offset:96
v_mfma_f32_16x16x32_bf16 v[128:131], v[200:203], a[192:195], v[128:131]
s_waitcnt lgkmcnt(15)
ds_read_b128 a[28:31], v255 offset:448
v_fma_f32 v230, v230, s27, -v247
v_mfma_f32_16x16x32_bf16 v[132:135], v[200:203], a[196:199], v[132:135]
v_exp_f32 v228, v228
v_mfma_f32_16x16x32_bf16 v[68:71], v[196:199], a[196:199], v[68:71]
s_add_u32 s38, s36, 16384
ds_read_b64_tr_b16 a[218:219], v241 offset:608
v_fma_f32 v231, v231, s27, -v247
v_mfma_f32_16x16x32_bf16 v[4:7], v[192:195], a[196:199], v[4:7]
s_waitcnt lgkmcnt(15)
v_exp_f32 v229, v229
v_mfma_f32_16x16x32_bf16 v[8:11], v[192:195], a[200:203], v[8:11]
s_add_u32 m0, s4, 0
ds_read_b64_tr_b16 a[220:221], v241 offset:112
v_add_f32 v251, v251, v228
v_mfma_f32_16x16x32_bf16 v[72:75], v[196:199], a[200:203], v[72:75]
s_waitcnt lgkmcnt(2)
buffer_load_dwordx4 v243, s[8:11], s38 offen offset:0 nt lds
v_mfma_f32_16x16x32_bf16 v[136:139], v[200:203], a[200:203], v[136:139]
v_exp_f32 v230, v230
v_mfma_f32_16x16x32_bf16 v[140:143], v[200:203], a[204:207], v[140:143]
s_add_u32 m0, s4, 544
v_add_f32 v251, v251, v229
v_cvt_pk_bf16_f32 v228, v228, v229
v_mfma_f32_16x16x32_bf16 v[76:79], v[196:199], a[204:207], v[76:79]
buffer_load_dwordx4 v243, s[8:11], s38 offen offset:512 nt lds
v_mfma_f32_16x16x32_bf16 v[12:15], v[192:195], a[204:207], v[12:15]
v_exp_f32 v231, v231
v_mfma_f32_16x16x32_bf16 v[16:19], v[192:195], a[208:211], v[16:19]
s_add_u32 m0, s4, 1088
ds_read_b64_tr_b16 a[222:223], v241 offset:624
v_add_f32 v251, v251, v230
v_mfma_f32_16x16x32_bf16 v[80:83], v[196:199], a[208:211], v[80:83]
buffer_load_dwordx4 v243, s[8:11], s38 offen offset:1024 nt lds
v_mfma_f32_16x16x32_bf16 v[144:147], v[200:203], a[208:211], v[144:147]
v_add_f32 v251, v251, v231
v_cvt_pk_bf16_f32 v229, v230, v231
v_mfma_f32_16x16x32_bf16 v[148:151], v[200:203], a[212:215], v[148:151]
s_add_u32 m0, s4, 1632
ds_read_b64_tr_b16 a[224:225], v241 offset:256
v_fma_f32 v232, v232, s27, -v248
v_mfma_f32_16x16x32_bf16 v[84:87], v[196:199], a[212:215], v[84:87]
buffer_load_dwordx4 v243, s[8:11], s38 offen offset:1536 nt lds
v_mfma_f32_16x16x32_bf16 v[20:23], v[192:195], a[212:215], v[20:23]
s_waitcnt lgkmcnt(3)
ds_read_b64_tr_b16 a[226:227], v241 offset:768
v_fma_f32 v233, v233, s27, -v248
v_mfma_f32_16x16x32_bf16 v[24:27], v[192:195], a[216:219], v[24:27]
v_exp_f32 v232, v232
v_mfma_f32_16x16x32_bf16 v[88:91], v[196:199], a[216:219], v[88:91]
s_add_u32 m0, s4, 2176
v_fma_f32 v234, v234, s27, -v248
v_fma_f32 v235, v235, s27, -v248
v_mfma_f32_16x16x32_bf16 v[152:155], v[200:203], a[216:219], v[152:155]
s_waitcnt lgkmcnt(2)
buffer_load_dwordx4 v243, s[8:11], s38 offen offset:2048 nt lds
v_mfma_f32_16x16x32_bf16 v[156:159], v[200:203], a[220:223], v[156:159]
v_exp_f32 v233, v233
v_mfma_f32_16x16x32_bf16 v[92:95], v[196:199], a[220:223], v[92:95]
s_add_u32 m0, s4, 2720
ds_read_b64_tr_b16 a[228:229], v241 offset:272
v_add_f32 v252, v252, v232
v_mfma_f32_16x16x32_bf16 v[28:31], v[192:195], a[220:223], v[28:31]
s_waitcnt lgkmcnt(1)
buffer_load_dwordx4 v243, s[8:11], s38 offen offset:2560 nt lds
v_mfma_f32_16x16x32_bf16 v[32:35], v[192:195], a[224:227], v[32:35]
ds_read_b64_tr_b16 a[230:231], v241 offset:784
v_add_f32 v252, v252, v233
v_mfma_f32_16x16x32_bf16 v[96:99], v[196:199], a[224:227], v[96:99]
s_add_u32 m0, s4, 3264
v_exp_f32 v234, v234
v_mfma_f32_16x16x32_bf16 v[160:163], v[200:203], a[224:227], v[160:163]
s_waitcnt lgkmcnt(0)
buffer_load_dwordx4 v243, s[8:11], s38 offen offset:3072 nt lds
v_mfma_f32_16x16x32_bf16 v[164:167], v[200:203], a[228:231], v[164:167]
ds_read_b64_tr_b16 a[232:233], v241 offset:288
ds_read_b64_tr_b16 a[234:235], v241 offset:800
v_mfma_f32_16x16x32_bf16 v[100:103], v[196:199], a[228:231], v[100:103]
s_add_u32 m0, s4, 3808
v_cvt_pk_bf16_f32 v232, v232, v233
v_add_f32 v252, v252, v234
v_mfma_f32_16x16x32_bf16 v[36:39], v[192:195], a[228:231], v[36:39]
s_waitcnt lgkmcnt(0)
buffer_load_dwordx4 v243, s[8:11], s38 offen offset:3584 nt lds
v_mfma_f32_16x16x32_bf16 v[40:43], v[192:195], a[232:235], v[40:43]
ds_read_b64_tr_b16 a[236:237], v241 offset:304
ds_read_b64_tr_b16 a[238:239], v241 offset:816
v_mfma_f32_16x16x32_bf16 v[104:107], v[196:199], a[232:235], v[104:107]
v_exp_f32 v235, v235
v_mfma_f32_16x16x32_bf16 v[168:171], v[200:203], a[232:235], v[168:171]
s_waitcnt lgkmcnt(0)
ds_read_b64_tr_b16 a[240:241], v241 offset:320
ds_read_b64_tr_b16 a[242:243], v241 offset:832
ds_read_b64_tr_b16 a[244:245], v241 offset:336
ds_read_b64_tr_b16 a[246:247], v241 offset:848
ds_read_b64_tr_b16 a[248:249], v241 offset:352
ds_read_b64_tr_b16 a[250:251], v241 offset:864
ds_read_b64_tr_b16 a[252:253], v241 offset:368
ds_read_b64_tr_b16 a[254:255], v241 offset:880
v_mfma_f32_16x16x32_bf16 v[172:175], v[200:203], a[236:239], v[172:175]
v_add_f32 v252, v252, v235
v_cvt_pk_bf16_f32 v233, v234, v235
v_mfma_f32_16x16x32_bf16 v[108:111], v[196:199], a[236:239], v[108:111]
v_fma_f32 v208, v208, s27, -v246
v_fma_f32 v209, v209, s27, -v246
v_mfma_f32_16x16x32_bf16 v[44:47], v[192:195], a[236:239], v[44:47]
s_waitcnt vmcnt(12) lgkmcnt(0)
v_exp_f32 v208, v208
v_mfma_f32_16x16x32_bf16 v[48:51], v[192:195], a[240:243], v[48:51]
s_barrier
v_mfma_f32_16x16x32_bf16 v[112:115], v[196:199], a[240:243], v[112:115]
v_fma_f32 v210, v210, s27, -v246
v_fma_f32 v211, v211, s27, -v246
v_mfma_f32_16x16x32_bf16 v[176:179], v[200:203], a[240:243], v[176:179]
v_exp_f32 v209, v209
v_mfma_f32_16x16x32_bf16 v[180:183], v[200:203], a[244:247], v[180:183]
v_add_f32 v250, v250, v208
v_add_f32 v250, v250, v209
v_mfma_f32_16x16x32_bf16 v[116:119], v[196:199], a[244:247], v[116:119]
v_exp_f32 v210, v210
v_mfma_f32_16x16x32_bf16 v[52:55], v[192:195], a[244:247], v[52:55]
v_cvt_pk_bf16_f32 v226, v208, v209
v_add_f32 v250, v250, v210
v_mfma_f32_16x16x32_bf16 v[56:59], v[192:195], a[248:251], v[56:59]
v_exp_f32 v211, v211
v_mfma_f32_16x16x32_bf16 v[120:123], v[196:199], a[248:251], v[120:123]
v_add_f32 v250, v250, v211
v_cvt_pk_bf16_f32 v227, v210, v211
v_mfma_f32_16x16x32_bf16 v[184:187], v[200:203], a[248:251], v[184:187]
v_fma_f32 v212, v212, s27, -v247
v_fma_f32 v213, v213, s27, -v247
v_mfma_f32_16x16x32_bf16 v[188:191], v[200:203], a[252:255], v[188:191]
v_exp_f32 v212, v212
v_mfma_f32_16x16x32_bf16 v[124:127], v[196:199], a[252:255], v[124:127]
v_fma_f32 v214, v214, s27, -v247
v_fma_f32 v215, v215, s27, -v247
v_exp_f32 v213, v213
v_exp_f32 v214, v214
v_exp_f32 v215, v215
v_fma_f32 v216, v216, s27, -v248
v_fma_f32 v217, v217, s27, -v248
v_exp_f32 v216, v216
v_fma_f32 v218, v218, s27, -v248
v_fma_f32 v219, v219, s27, -v248
v_exp_f32 v217, v217
v_exp_f32 v218, v218
v_exp_f32 v219, v219
v_mfma_f32_16x16x32_bf16 v[60:63], v[192:195], a[252:255], v[60:63]
ds_read_b64_tr_b16 a[192:193], v241 offset:16640
ds_read_b64_tr_b16 a[194:195], v241 offset:17152
ds_read_b64_tr_b16 a[196:197], v241 offset:16656
ds_read_b64_tr_b16 a[198:199], v241 offset:17168
ds_read_b64_tr_b16 a[200:201], v241 offset:16672
ds_read_b64_tr_b16 a[202:203], v241 offset:17184
ds_read_b64_tr_b16 a[204:205], v241 offset:16688
ds_read_b64_tr_b16 a[206:207], v241 offset:17200
v_add_f32 v251, v251, v212
v_add_f32 v251, v251, v213
v_cvt_pk_bf16_f32 v230, v212, v213
v_add_f32 v251, v251, v214
v_add_f32 v251, v251, v215
v_cvt_pk_bf16_f32 v231, v214, v215
v_add_f32 v252, v252, v216
v_add_f32 v252, v252, v217
v_cvt_pk_bf16_f32 v234, v216, v217
v_add_f32 v252, v252, v218
v_add_f32 v252, v252, v219
v_cvt_pk_bf16_f32 v235, v218, v219
s_branch L_last3
L_blkp:
s_waitcnt lgkmcnt(7)
v_mfma_f32_16x16x32_bf16 v[192:195], a[192:195], a[0:3], 0
s_waitcnt lgkmcnt(6)
ds_read_b128 a[252:255], v240 offset:960
ds_read_b128 a[248:251], v240 offset:896
v_mfma_f32_16x16x32_bf16 v[192:195], a[196:199], a[4:7], v[192:195]
s_waitcnt lgkmcnt(7)
ds_read_b128 a[244:247], v240 offset:832
ds_read_b128 a[240:243], v240 offset:768
v_mfma_f32_16x16x32_bf16 v[192:195], a[200:203], a[8:11], v[192:195]
s_waitcnt lgkmcnt(8)
ds_read_b128 a[236:239], v240 offset:704
ds_read_b128 a[232:235], v240 offset:640
v_mfma_f32_16x16x32_bf16 v[192:195], a[204:207], a[12:15], v[192:195]
s_waitcnt lgkmcnt(9)
ds_read_b128 a[228:231], v240 offset:576
ds_read_b128 a[224:227], v240 offset:512
v_mfma_f32_16x16x32_bf16 v[192:195], a[208:211], a[16:19], v[192:195]
s_waitcnt lgkmcnt(10)
v_mov_b32 v250, 0
v_mov_b32 v251, 0
v_mfma_f32_16x16x32_bf16 v[192:195], a[212:215], a[20:23], v[192:195]
s_waitcnt lgkmcnt(9)
v_mov_b32 v252, 0
v_mfma_f32_16x16x32_bf16 v[192:195], a[216:219], a[24:27], v[192:195]
s_waitcnt lgkmcnt(8)
v_mfma_f32_16x16x32_bf16 v[192:195], a[220:223], a[28:31], v[192:195]
s_waitcnt lgkmcnt(7)
v_mfma_f32_16x16x32_bf16 v[208:211], a[252:255], a[28:31], 0
s_waitcnt lgkmcnt(6)
v_mfma_f32_16x16x32_bf16 v[208:211], a[248:251], a[24:27], v[208:211]
s_waitcnt lgkmcnt(5)
v_mfma_f32_16x16x32_bf16 v[208:211], a[244:247], a[20:23], v[208:211]
s_cbranch_vccz L_cw12
s_waitcnt vmcnt(20)
L_cw12:
s_waitcnt lgkmcnt(4)
v_mfma_f32_16x16x32_bf16 v[208:211], a[240:243], a[16:19], v[208:211]
s_waitcnt lgkmcnt(0)
v_max3_f32 v246, v192, v193, v194
v_max_f32 v246, v246, v195
v_mfma_f32_16x16x32_bf16 v[208:211], a[236:239], a[12:15], v[208:211]
s_barrier
v_mfma_f32_16x16x32_bf16 v[208:211], a[232:235], a[8:11], v[208:211]
s_add_u32 m0, s26, 0
v_mov_b32 v224, v246
v_mfma_f32_16x16x32_bf16 v[208:211], a[228:231], a[4:7], v[208:211]
buffer_load_dwordx4 v242, s[12:15], s29 offen offset:0 lds
v_mfma_f32_16x16x32_bf16 v[208:211], a[224:227], a[0:3], v[208:211]
s_add_u32 m0, s26, 32
v_permlane32_swap_b32 v246, v224
v_mfma_f32_16x16x32_bf16 v[212:215], a[224:227], a[32:35], 0
buffer_load_dwordx4 v242, s[12:15], s29 offen offset:1024 lds
v_mfma_f32_16x16x32_bf16 v[212:215], a[228:231], a[36:39], v[212:215]
v_max_f32 v246, v246, v224
v_mov_b32 v224, v246
v_mfma_f32_16x16x32_bf16 v[212:215], a[232:235], a[40:43], v[212:215]
s_add_u32 m0, s26, 64
v_permlane16_swap_b32 v246, v224
v_mfma_f32_16x16x32_bf16 v[212:215], a[236:239], a[44:47], v[212:215]
buffer_load_dwordx4 v242, s[12:15], s29 offen offset:2048 lds
v_mfma_f32_16x16x32_bf16 v[212:215], a[240:243], a[48:51], v[212:215]
s_cbranch_vccz L_cw13
s_waitcnt vmcnt(15)
L_cw13:
v_max_f32 v246, v246, v224
v_mul_f32 v246, s27, v246
v_mfma_f32_16x16x32_bf16 v[212:215], a[244:247], a[52:55], v[212:215]
v_fma_f32 v192, v192, s27, -v246
v_fma_f32 v193, v193, s27, -v246
v_mfma_f32_16x16x32_bf16 v[212:215], a[248:251], a[56:59], v[212:215]
s_add_u32 m0, s26, 96
v_exp_f32 v192, v192
v_mfma_f32_16x16x32_bf16 v[212:215], a[252:255], a[60:63], v[212:215]
buffer_load_dwordx4 v242, s[12:15], s29 offen offset:3072 lds
v_mfma_f32_16x16x32_bf16 v[196:199], a[220:223], a[60:63], 0
s_add_u32 s29, s29, 16384
v_fma_f32 v194, v194, s27, -v246
v_fma_f32 v195, v195, s27, -v246
v_mfma_f32_16x16x32_bf16 v[196:199], a[216:219], a[56:59], v[196:199]
s_add_u32 m0, s3, 53504
v_exp_f32 v193, v193
v_mfma_f32_16x16x32_bf16 v[196:199], a[212:215], a[52:55], v[196:199]
buffer_load_dwordx4 v242, s[16:19], s30 offen offset:0 lds
v_mfma_f32_16x16x32_bf16 v[196:199], a[208:211], a[48:51], v[196:199]
s_add_u32 m0, s3, 53520
v_add_f32 v250, v250, v192
v_add_f32 v250, v250, v193
v_mfma_f32_16x16x32_bf16 v[196:199], a[204:207], a[44:47], v[196:199]
ds_read_b128 a[64:67], v255 offset:0
buffer_load_dwordx4 v242, s[16:19], s30 offen offset:1024 lds
v_mfma_f32_16x16x32_bf16 v[196:199], a[200:203], a[40:43], v[196:199]
ds_read_b128 a[68:71], v255 offset:64
v_cvt_pk_bf16_f32 v192, v192, v193
v_mfma_f32_16x16x32_bf16 v[196:199], a[196:199], a[36:39], v[196:199]
s_add_u32 m0, s3, 53536
ds_read_b128 a[72:75], v255 offset:128
v_fma_f32 v208, v208, s27, -v246
v_mfma_f32_16x16x32_bf16 v[196:199], a[192:195], a[32:35], v[196:199]
s_waitcnt lgkmcnt(2)
ds_read_b128 a[76:79], v255 offset:192
buffer_load_dwordx4 v242, s[16:19], s30 offen offset:2048 lds
v_mfma_f32_16x16x32_bf16 v[200:203], a[192:195], a[64:67], 0
s_waitcnt lgkmcnt(2)
ds_read_b128 a[80:83], v255 offset:256
v_fma_f32 v209, v209, s27, -v246
v_mfma_f32_16x16x32_bf16 v[200:203], a[196:199], a[68:71], v[200:203]
s_waitcnt lgkmcnt(2)
ds_read_b128 a[84:87], v255 offset:320
v_fma_f32 v210, v210, s27, -v246
v_mfma_f32_16x16x32_bf16 v[200:203], a[200:203], a[72:75], v[200:203]
s_waitcnt lgkmcnt(2)
s_add_u32 m0, s3, 53552
ds_read_b128 a[88:91], v255 offset:384
v_fma_f32 v211, v211, s27, -v246
v_mfma_f32_16x16x32_bf16 v[200:203], a[204:207], a[76:79], v[200:203]
s_waitcnt lgkmcnt(2)
ds_read_b128 a[92:95], v255 offset:448
buffer_load_dwordx4 v242, s[16:19], s30 offen offset:3072 lds
v_mfma_f32_16x16x32_bf16 v[200:203], a[208:211], a[80:83], v[200:203]
s_waitcnt lgkmcnt(2)
s_add_u32 s30, s30, 16384
v_max3_f32 v247, v196, v197, v198
v_max_f32 v247, v247, v199
v_mfma_f32_16x16x32_bf16 v[200:203], a[212:215], a[84:87], v[200:203]
s_waitcnt lgkmcnt(1)
ds_read_b128 a[192:195], v240 offset:16896
v_mov_b32 v225, v247
v_mfma_f32_16x16x32_bf16 v[200:203], a[216:219], a[88:91], v[200:203]
s_waitcnt lgkmcnt(1)
v_permlane32_swap_b32 v247, v225
v_mfma_f32_16x16x32_bf16 v[200:203], a[220:223], a[92:95], v[200:203]
v_max_f32 v247, v247, v225
v_mov_b32 v225, v247
v_mfma_f32_16x16x32_bf16 v[216:219], a[252:255], a[92:95], 0
s_nop 0
v_permlane16_swap_b32 v247, v225
v_mfma_f32_16x16x32_bf16 v[216:219], a[248:251], a[88:91], v[216:219]
v_max_f32 v247, v247, v225
v_mul_f32 v247, s27, v247
v_mfma_f32_16x16x32_bf16 v[216:219], a[244:247], a[84:87], v[216:219]
v_exp_f32 v194, v194
v_mfma_f32_16x16x32_bf16 v[216:219], a[240:243], a[80:83], v[216:219]
v_max3_f32 v248, v200, v201, v202
v_max_f32 v248, v248, v203
v_mfma_f32_16x16x32_bf16 v[216:219], a[236:239], a[76:79], v[216:219]
v_mov_b32 v226, v248
v_add_f32 v250, v250, v194
v_mfma_f32_16x16x32_bf16 v[216:219], a[232:235], a[72:75], v[216:219]
v_permlane32_swap_b32 v248, v226
v_mfma_f32_16x16x32_bf16 v[216:219], a[228:231], a[68:71], v[216:219]
v_max_f32 v248, v248, v226
v_mov_b32 v226, v248
v_exp_f32 v195, v195
v_exp_f32 v208, v208
v_exp_f32 v209, v209
v_exp_f32 v210, v210
v_exp_f32 v211, v211
v_mfma_f32_16x16x32_bf16 v[216:219], a[224:227], a[64:67], v[216:219]
s_waitcnt lgkmcnt(0)
ds_read_b128 a[196:199], v240 offset:16960
ds_read_b128 a[200:203], v240 offset:17024
ds_read_b128 a[204:207], v240 offset:17088
ds_read_b128 a[208:211], v240 offset:17152
ds_read_b128 a[212:215], v240 offset:17216
ds_read_b128 a[216:219], v240 offset:17280
ds_read_b128 a[220:223], v240 offset:17344
v_permlane16_swap_b32 v248, v226
v_max_f32 v248, v248, v226
v_mul_f32 v248, s27, v248
v_add_f32 v250, v250, v195
v_cvt_pk_bf16_f32 v193, v194, v195
v_add_f32 v250, v250, v208
v_add_f32 v250, v250, v209
v_cvt_pk_bf16_f32 v194, v208, v209
v_add_f32 v250, v250, v210
v_add_f32 v250, v250, v211
v_cvt_pk_bf16_f32 v195, v210, v211
v_mfma_f32_16x16x32_bf16 v[224:227], a[192:195], a[0:3], 0
s_waitcnt lgkmcnt(6)
ds_read_b128 a[224:227], v240 offset:17408
v_fma_f32 v196, v196, s27, -v247
v_mfma_f32_16x16x32_bf16 v[224:227], a[196:199], a[4:7], v[224:227]
s_waitcnt lgkmcnt(6)
ds_read_b128 a[228:231], v240 offset:17472
v_fma_f32 v197, v197, s27, -v247
v_mfma_f32_16x16x32_bf16 v[224:227], a[200:203], a[8:11], v[224:227]
s_waitcnt lgkmcnt(6)
v_exp_f32 v196, v196
v_mfma_f32_16x16x32_bf16 v[224:227], a[204:207], a[12:15], v[224:227]
s_waitcnt lgkmcnt(5)
ds_read_b128 a[232:235], v240 offset:17536
v_fma_f32 v198, v198, s27, -v247
v_mfma_f32_16x16x32_bf16 v[224:227], a[208:211], a[16:19], v[224:227]
s_waitcnt lgkmcnt(5)
ds_read_b128 a[236:239], v240 offset:17600
v_fma_f32 v199, v199, s27, -v247
v_mfma_f32_16x16x32_bf16 v[224:227], a[212:215], a[20:23], v[224:227]
s_waitcnt lgkmcnt(5)
v_exp_f32 v197, v197
v_mfma_f32_16x16x32_bf16 v[224:227], a[216:219], a[24:27], v[224:227]
s_waitcnt lgkmcnt(4)
ds_read_b128 a[240:243], v240 offset:17664
v_add_f32 v251, v251, v196
v_mfma_f32_16x16x32_bf16 v[224:227], a[220:223], a[28:31], v[224:227]
v_exp_f32 v198, v198
v_mfma_f32_16x16x32_bf16 v[228:231], a[220:223], a[60:63], 0
s_add_u32 m0, s5, 0
ds_read_b128 a[244:247], v240 offset:17728
v_add_f32 v251, v251, v197
v_mfma_f32_16x16x32_bf16 v[228:231], a[216:219], a[56:59], v[228:231]
buffer_load_dwordx4 v243, s[8:11], s38 offen nt lds
v_mfma_f32_16x16x32_bf16 v[228:231], a[212:215], a[52:55], v[228:231]
s_add_u32 s38, s38, 512
ds_read_b128 a[248:251], v240 offset:17792
v_cvt_pk_bf16_f32 v196, v196, v197
v_mfma_f32_16x16x32_bf16 v[228:231], a[208:211], a[48:51], v[228:231]
v_exp_f32 v199, v199
v_mfma_f32_16x16x32_bf16 v[228:231], a[204:207], a[44:47], v[228:231]
ds_read_b128 a[252:255], v240 offset:17856
v_add_f32 v251, v251, v198
v_mfma_f32_16x16x32_bf16 v[228:231], a[200:203], a[40:43], v[228:231]
v_add_f32 v251, v251, v199
v_cvt_pk_bf16_f32 v197, v198, v199
v_mfma_f32_16x16x32_bf16 v[228:231], a[196:199], a[36:39], v[228:231]
s_add_u32 m0, s5, 8448
v_fma_f32 v212, v212, s27, -v247
v_mfma_f32_16x16x32_bf16 v[228:231], a[192:195], a[32:35], v[228:231]
s_add_u32 s5, s5, 1056
buffer_load_dwordx4 v243, s[8:11], s33 offen nt lds
v_mfma_f32_16x16x32_bf16 v[232:235], a[192:195], a[64:67], 0
s_add_u32 s33, s33, 512
v_fma_f32 v213, v213, s27, -v247
v_fma_f32 v214, v214, s27, -v247
v_mfma_f32_16x16x32_bf16 v[232:235], a[196:199], a[68:71], v[232:235]
v_exp_f32 v212, v212
v_mfma_f32_16x16x32_bf16 v[232:235], a[200:203], a[72:75], v[232:235]
v_fma_f32 v215, v215, s27, -v247
v_add_f32 v251, v251, v212
v_mfma_f32_16x16x32_bf16 v[232:235], a[204:207], a[76:79], v[232:235]
v_exp_f32 v213, v213
v_mfma_f32_16x16x32_bf16 v[232:235], a[208:211], a[80:83], v[232:235]
v_exp_f32 v214, v214
v_mfma_f32_16x16x32_bf16 v[232:235], a[212:215], a[84:87], v[232:235]
s_cbranch_vccz L_cw14
s_waitcnt vmcnt(10)
L_cw14:
v_add_f32 v251, v251, v213
v_cvt_pk_bf16_f32 v198, v212, v213
v_mfma_f32_16x16x32_bf16 v[232:235], a[216:219], a[88:91], v[232:235]
s_waitcnt lgkmcnt(0)
v_exp_f32 v215, v215
v_mfma_f32_16x16x32_bf16 v[232:235], a[220:223], a[92:95], v[232:235]
s_barrier
v_mfma_f32_16x16x32_bf16 v[208:211], a[224:227], a[0:3], 0
s_add_u32 m0, s26, 16896
v_add_f32 v251, v251, v214
v_add_f32 v251, v251, v215
v_mfma_f32_16x16x32_bf16 v[208:211], a[228:231], a[4:7], v[208:211]
buffer_load_dwordx4 v242, s[12:15], s29 offen offset:0 lds
v_mfma_f32_16x16x32_bf16 v[208:211], a[232:235], a[8:11], v[208:211]
ds_read_b128 v[204:207], v242 offset:29696
ds_read_b64_tr_b16 a[192:193], v241 offset:0
v_mfma_f32_16x16x32_bf16 v[208:211], a[236:239], a[12:15], v[208:211]
ds_read_b64_tr_b16 a[194:195], v241 offset:512
v_cvt_pk_bf16_f32 v199, v214, v215
v_mfma_f32_16x16x32_bf16 v[208:211], a[240:243], a[16:19], v[208:211]
ds_read_b64_tr_b16 a[196:197], v241 offset:16
v_fma_f32 v200, v200, s27, -v248
v_mfma_f32_16x16x32_bf16 v[208:211], a[244:247], a[20:23], v[208:211]
s_add_u32 m0, s26, 16928
ds_read_b64_tr_b16 a[198:199], v241 offset:528
v_fma_f32 v201, v201, s27, -v248
v_mfma_f32_16x16x32_bf16 v[208:211], a[248:251], a[24:27], v[208:211]
buffer_load_dwordx4 v242, s[12:15], s29 offen offset:1024 lds
v_mfma_f32_16x16x32_bf16 v[208:211], a[252:255], a[28:31], v[208:211]
v_exp_f32 v200, v200
v_mfma_f32_16x16x32_bf16 v[212:215], a[252:255], a[60:63], 0
ds_read_b64_tr_b16 a[200:201], v241 offset:32
v_fma_f32 v202, v202, s27, -v248
v_mfma_f32_16x16x32_bf16 v[212:215], a[248:251], a[56:59], v[212:215]
ds_read_b64_tr_b16 a[202:203], v241 offset:544
v_fma_f32 v203, v203, s27, -v248
v_mfma_f32_16x16x32_bf16 v[212:215], a[244:247], a[52:55], v[212:215]
v_exp_f32 v201, v201
v_mfma_f32_16x16x32_bf16 v[212:215], a[240:243], a[48:51], v[212:215]
s_add_u32 m0, s26, 16960
ds_read_b64_tr_b16 a[204:205], v241 offset:48
v_add_f32 v252, v252, v200
v_mfma_f32_16x16x32_bf16 v[212:215], a[236:239], a[44:47], v[212:215]
buffer_load_dwordx4 v242, s[12:15], s29 offen offset:2048 lds
v_mfma_f32_16x16x32_bf16 v[212:215], a[232:235], a[40:43], v[212:215]
v_exp_f32 v202, v202
v_mfma_f32_16x16x32_bf16 v[212:215], a[228:231], a[36:39], v[212:215]
v_exp_f32 v203, v203
v_fma_f32 v216, v216, s27, -v248
v_fma_f32 v217, v217, s27, -v248
v_exp_f32 v216, v216
v_fma_f32 v218, v218, s27, -v248
v_fma_f32 v219, v219, s27, -v248
v_exp_f32 v217, v217
v_exp_f32 v218, v218
v_exp_f32 v219, v219
v_mfma_f32_16x16x32_bf16 v[212:215], a[224:227], a[32:35], v[212:215]
v_add_f32 v252, v252, v201
v_cvt_pk_bf16_f32 v200, v200, v201
v_add_f32 v252, v252, v202
v_add_f32 v252, v252, v203
v_cvt_pk_bf16_f32 v201, v202, v203
v_add_f32 v252, v252, v216
v_add_f32 v252, v252, v217
v_cvt_pk_bf16_f32 v202, v216, v217
v_add_f32 v252, v252, v218
v_add_f32 v252, v252, v219
v_cvt_pk_bf16_f32 v203, v218, v219
v_mfma_f32_16x16x32_bf16 v[216:219], a[224:227], a[64:67], 0
ds_read_b64_tr_b16 a[206:207], v241 offset:560
ds_read_b64_tr_b16 a[208:209], v241 offset:64
v_mfma_f32_16x16x32_bf16 v[216:219], a[228:231], a[68:71], v[216:219]
s_add_u32 m0, s26, 16992
ds_read_b64_tr_b16 a[210:211], v241 offset:576
ds_read_b64_tr_b16 a[212:213], v241 offset:80
v_mfma_f32_16x16x32_bf16 v[216:219], a[232:235], a[72:75], v[216:219]
buffer_load_dwordx4 v242, s[12:15], s29 offen offset:3072 lds
v_mfma_f32_16x16x32_bf16 v[216:219], a[236:239], a[76:79], v[216:219]
s_add_u32 s29, s29, 16384
ds_read_b64_tr_b16 a[214:215], v241 offset:592
v_mfma_f32_16x16x32_bf16 v[216:219], a[240:243], a[80:83], v[216:219]
v_mfma_f32_16x16x32_bf16 v[216:219], a[244:247], a[84:87], v[216:219]
ds_read_b64_tr_b16 a[216:217], v241 offset:96
v_mfma_f32_16x16x32_bf16 v[216:219], a[248:251], a[88:91], v[216:219]
v_mfma_f32_16x16x32_bf16 v[216:219], a[252:255], a[92:95], v[216:219]
s_waitcnt lgkmcnt(11)
ds_read_b64_tr_b16 a[218:219], v241 offset:608
v_mfma_f32_16x16x32_bf16 v[0:3], v[192:195], a[192:195], 0
v_mfma_f32_16x16x32_bf16 v[64:67], v[196:199], a[192:195], 0
ds_read_b64_tr_b16 a[220:221], v241 offset:112
v_mfma_f32_16x16x32_bf16 v[128:131], v[200:203], a[192:195], 0
v_mfma_f32_16x16x32_bf16 a[128:131], v[204:207], a[192:195], 0
s_waitcnt lgkmcnt(11)
ds_read_b64_tr_b16 a[222:223], v241 offset:624
v_mfma_f32_16x16x32_bf16 a[132:135], v[204:207], a[196:199], 0
ds_read_b64_tr_b16 a[224:225], v241 offset:256
v_mfma_f32_16x16x32_bf16 v[132:135], v[200:203], a[196:199], 0
v_mfma_f32_16x16x32_bf16 v[68:71], v[196:199], a[196:199], 0
ds_read_b64_tr_b16 a[226:227], v241 offset:768
v_mfma_f32_16x16x32_bf16 v[4:7], v[192:195], a[196:199], 0
s_waitcnt lgkmcnt(12)
v_mfma_f32_16x16x32_bf16 v[8:11], v[192:195], a[200:203], 0
ds_read_b64_tr_b16 a[228:229], v241 offset:272
v_mfma_f32_16x16x32_bf16 v[72:75], v[196:199], a[200:203], 0
v_fma_f32 v224, v224, s27, -v246
v_mfma_f32_16x16x32_bf16 v[136:139], v[200:203], a[200:203], 0
ds_read_b64_tr_b16 a[230:231], v241 offset:784
v_fma_f32 v225, v225, s27, -v246
v_mfma_f32_16x16x32_bf16 a[136:139], v[204:207], a[200:203], 0
s_waitcnt lgkmcnt(12)
v_exp_f32 v224, v224
v_mfma_f32_16x16x32_bf16 a[140:143], v[204:207], a[204:207], 0
ds_read_b64_tr_b16 a[232:233], v241 offset:288
v_fma_f32 v226, v226, s27, -v246
v_mfma_f32_16x16x32_bf16 v[140:143], v[200:203], a[204:207], 0
v_fma_f32 v227, v227, s27, -v246
v_mfma_f32_16x16x32_bf16 v[76:79], v[196:199], a[204:207], 0
v_exp_f32 v225, v225
v_mfma_f32_16x16x32_bf16 v[12:15], v[192:195], a[204:207], 0
s_waitcnt lgkmcnt(11)
ds_read_b64_tr_b16 a[234:235], v241 offset:800
v_add_f32 v250, v250, v224
v_mfma_f32_16x16x32_bf16 v[16:19], v[192:195], a[208:211], 0
v_exp_f32 v226, v226
v_mfma_f32_16x16x32_bf16 v[80:83], v[196:199], a[208:211], 0
ds_read_b64_tr_b16 a[236:237], v241 offset:304
v_add_f32 v250, v250, v225
v_mfma_f32_16x16x32_bf16 v[144:147], v[200:203], a[208:211], 0
ds_read_b64_tr_b16 a[238:239], v241 offset:816
v_cvt_pk_bf16_f32 v224, v224, v225
v_mfma_f32_16x16x32_bf16 a[144:147], v[204:207], a[208:211], 0
s_waitcnt lgkmcnt(12)
v_exp_f32 v227, v227
v_mfma_f32_16x16x32_bf16 a[148:151], v[204:207], a[212:215], 0
ds_read_b64_tr_b16 a[240:241], v241 offset:320
v_add_f32 v250, v250, v226
v_mfma_f32_16x16x32_bf16 v[148:151], v[200:203], a[212:215], 0
v_add_f32 v250, v250, v227
v_cvt_pk_bf16_f32 v225, v226, v227
v_mfma_f32_16x16x32_bf16 v[84:87], v[196:199], a[212:215], 0
ds_read_b64_tr_b16 a[242:243], v241 offset:832
v_fma_f32 v228, v228, s27, -v247
v_mfma_f32_16x16x32_bf16 v[20:23], v[192:195], a[212:215], 0
s_waitcnt lgkmcnt(12)
ds_read_b64_tr_b16 a[244:245], v241 offset:336
v_fma_f32 v229, v229, s27, -v247
v_mfma_f32_16x16x32_bf16 v[24:27], v[192:195], a[216:219], 0
v_exp_f32 v228, v228
v_mfma_f32_16x16x32_bf16 v[88:91], v[196:199], a[216:219], 0
ds_read_b64_tr_b16 a[246:247], v241 offset:848
v_fma_f32 v230, v230, s27, -v247
v_mfma_f32_16x16x32_bf16 v[152:155], v[200:203], a[216:219], 0
v_fma_f32 v231, v231, s27, -v247
v_mfma_f32_16x16x32_bf16 a[152:155], v[204:207], a[216:219], 0
s_waitcnt lgkmcnt(12)
v_exp_f32 v229, v229
v_mfma_f32_16x16x32_bf16 a[156:159], v[204:207], a[220:223], 0
ds_read_b64_tr_b16 a[248:249], v241 offset:352
v_add_f32 v251, v251, v228
v_mfma_f32_16x16x32_bf16 v[156:159], v[200:203], a[220:223], 0
v_exp_f32 v230, v230
v_mfma_f32_16x16x32_bf16 v[92:95], v[196:199], a[220:223], 0
ds_read_b64_tr_b16 a[250:251], v241 offset:864
v_add_f32 v251, v251, v229
v_mfma_f32_16x16x32_bf16 v[28:31], v[192:195], a[220:223], 0
s_waitcnt lgkmcnt(12)
ds_read_b64_tr_b16 a[252:253], v241 offset:368
v_cvt_pk_bf16_f32 v228, v228, v229
v_mfma_f32_16x16x32_bf16 v[32:35], v[192:195], a[224:227], 0
v_exp_f32 v231, v231
v_mfma_f32_16x16x32_bf16 v[96:99], v[196:199], a[224:227], 0
ds_read_b64_tr_b16 a[254:255], v241 offset:880
v_add_f32 v251, v251, v230
v_mfma_f32_16x16x32_bf16 v[160:163], v[200:203], a[224:227], 0
v_add_f32 v251, v251, v231
v_cvt_pk_bf16_f32 v229, v230, v231
v_mfma_f32_16x16x32_bf16 a[160:163], v[204:207], a[224:227], 0
s_waitcnt lgkmcnt(12)
v_fma_f32 v232, v232, s27, -v248
v_fma_f32 v233, v233, s27, -v248
v_mfma_f32_16x16x32_bf16 a[164:167], v[204:207], a[228:231], 0
v_exp_f32 v232, v232
v_mfma_f32_16x16x32_bf16 v[164:167], v[200:203], a[228:231], 0
v_fma_f32 v234, v234, s27, -v248
v_fma_f32 v235, v235, s27, -v248
v_mfma_f32_16x16x32_bf16 v[100:103], v[196:199], a[228:231], 0
v_exp_f32 v233, v233
v_mfma_f32_16x16x32_bf16 v[36:39], v[192:195], a[228:231], 0
s_waitcnt lgkmcnt(10)
v_add_f32 v252, v252, v232
v_mfma_f32_16x16x32_bf16 v[40:43], v[192:195], a[232:235], 0
v_exp_f32 v234, v234
v_mfma_f32_16x16x32_bf16 v[104:107], v[196:199], a[232:235], 0
s_waitcnt vmcnt(10) lgkmcnt(0)
v_add_f32 v252, v252, v233
v_cvt_pk_bf16_f32 v232, v232, v233
v_mfma_f32_16x16x32_bf16 v[168:171], v[200:203], a[232:235], 0
s_barrier
v_mfma_f32_16x16x32_bf16 a[168:171], v[204:207], a[232:235], 0
s_add_u32 m0, s3, 36864
ds_read_b128 v[236:239], v242 offset:30720
ds_read_b128 a[192:195], v240 offset:0
v_mfma_f32_16x16x32_bf16 a[172:175], v[204:207], a[236:239], 0
buffer_load_dwordx4 v242, s[16:19], s30 offen offset:0 lds
v_mfma_f32_16x16x32_bf16 v[172:175], v[200:203], a[236:239], 0
v_exp_f32 v235, v235
v_mfma_f32_16x16x32_bf16 v[108:111], v[196:199], a[236:239], 0
ds_read_b128 a[196:199], v240 offset:64
ds_read_b128 a[200:203], v240 offset:128
v_mfma_f32_16x16x32_bf16 v[44:47], v[192:195], a[236:239], 0
s_add_u32 m0, s3, 36880
v_add_f32 v252, v252, v234
v_add_f32 v252, v252, v235
v_mfma_f32_16x16x32_bf16 v[48:51], v[192:195], a[240:243], 0
buffer_load_dwordx4 v242, s[16:19], s30 offen offset:1024 lds
v_mfma_f32_16x16x32_bf16 v[112:115], v[196:199], a[240:243], 0
ds_read_b128 a[204:207], v240 offset:192
v_cvt_pk_bf16_f32 v233, v234, v235
v_mfma_f32_16x16x32_bf16 v[176:179], v[200:203], a[240:243], 0
ds_read_b128 a[208:211], v240 offset:256
v_fma_f32 v208, v208, s27, -v246
v_mfma_f32_16x16x32_bf16 a[176:179], v[204:207], a[240:243], 0
ds_read_b128 a[212:215], v240 offset:320
v_fma_f32 v209, v209, s27, -v246
v_mfma_f32_16x16x32_bf16 a[180:183], v[204:207], a[244:247], 0
s_add_u32 m0, s3, 36896
v_exp_f32 v208, v208
v_mfma_f32_16x16x32_bf16 v[180:183], v[200:203], a[244:247], 0
buffer_load_dwordx4 v242, s[16:19], s30 offen offset:2048 lds
v_mfma_f32_16x16x32_bf16 v[116:119], v[196:199], a[244:247], 0
ds_read_b128 a[216:219], v240 offset:384
v_fma_f32 v210, v210, s27, -v246
v_mfma_f32_16x16x32_bf16 v[52:55], v[192:195], a[244:247], 0
ds_read_b128 a[220:223], v240 offset:448
v_fma_f32 v211, v211, s27, -v246
v_mfma_f32_16x16x32_bf16 v[56:59], v[192:195], a[248:251], 0
v_exp_f32 v209, v209
v_mfma_f32_16x16x32_bf16 v[120:123], v[196:199], a[248:251], 0
s_add_u32 m0, s3, 36912
v_add_f32 v250, v250, v208
v_mfma_f32_16x16x32_bf16 v[184:187], v[200:203], a[248:251], 0
buffer_load_dwordx4 v242, s[16:19], s30 offen offset:3072 lds
v_mfma_f32_16x16x32_bf16 a[184:187], v[204:207], a[248:251], 0
s_add_u32 s30, s30, 16384
v_exp_f32 v210, v210
v_mfma_f32_16x16x32_bf16 a[188:191], v[204:207], a[252:255], 0
v_add_f32 v250, v250, v209
v_cvt_pk_bf16_f32 v226, v208, v209
v_mfma_f32_16x16x32_bf16 v[188:191], v[200:203], a[252:255], 0
v_exp_f32 v211, v211
v_mfma_f32_16x16x32_bf16 v[124:127], v[196:199], a[252:255], 0
v_add_f32 v250, v250, v210
v_add_f32 v250, v250, v211
v_mfma_f32_16x16x32_bf16 v[60:63], v[192:195], a[252:255], 0
v_cvt_pk_bf16_f32 v227, v210, v211
.p2align 6
L_loopp:
s_waitcnt lgkmcnt(7)
v_mfma_f32_16x16x32_bf16 v[192:195], a[192:195], a[0:3], 0
s_waitcnt lgkmcnt(6)
ds_read_b128 a[224:227], v240 offset:512
v_fma_f32 v212, v212, s27, -v247
v_mfma_f32_16x16x32_bf16 v[192:195], a[196:199], a[4:7], v[192:195]
s_waitcnt lgkmcnt(6)
ds_read_b128 a[228:231], v240 offset:576
v_fma_f32 v213, v213, s27, -v247
v_mfma_f32_16x16x32_bf16 v[192:195], a[200:203], a[8:11], v[192:195]
s_waitcnt lgkmcnt(6)
v_exp_f32 v212, v212
v_mfma_f32_16x16x32_bf16 v[192:195], a[204:207], a[12:15], v[192:195]
s_waitcnt lgkmcnt(5)
ds_read_b128 a[232:235], v240 offset:640
v_fma_f32 v214, v214, s27, -v247
v_mfma_f32_16x16x32_bf16 v[192:195], a[208:211], a[16:19], v[192:195]
s_waitcnt lgkmcnt(5)
ds_read_b128 a[236:239], v240 offset:704
v_fma_f32 v215, v215, s27, -v247
v_mfma_f32_16x16x32_bf16 v[192:195], a[212:215], a[20:23], v[192:195]
s_waitcnt lgkmcnt(5)
v_exp_f32 v213, v213
v_mfma_f32_16x16x32_bf16 v[192:195], a[216:219], a[24:27], v[192:195]
s_waitcnt lgkmcnt(4)
ds_read_b128 a[240:243], v240 offset:768
v_mfma_f32_16x16x32_bf16 v[192:195], a[220:223], a[28:31], v[192:195]
v_add_f32 v251, v251, v212
v_mfma_f32_16x16x32_bf16 v[196:199], a[220:223], a[60:63], 0
s_add_u32 m0, s5, 0
ds_read_b128 a[244:247], v240 offset:832
v_mfma_f32_16x16x32_bf16 v[196:199], a[216:219], a[56:59], v[196:199]
buffer_load_dwordx4 v243, s[8:11], s38 offen nt lds
v_mfma_f32_16x16x32_bf16 v[196:199], a[212:215], a[52:55], v[196:199]
s_add_u32 s38, s38, 512
v_exp_f32 v214, v214
v_mfma_f32_16x16x32_bf16 v[196:199], a[208:211], a[48:51], v[196:199]
ds_read_b128 a[248:251], v240 offset:896
v_add_f32 v251, v251, v213
v_mfma_f32_16x16x32_bf16 v[196:199], a[204:207], a[44:47], v[196:199]
ds_read_b128 a[252:255], v240 offset:960
v_cvt_pk_bf16_f32 v230, v212, v213
v_mfma_f32_16x16x32_bf16 v[196:199], a[200:203], a[40:43], v[196:199]
v_exp_f32 v215, v215
v_mfma_f32_16x16x32_bf16 v[196:199], a[196:199], a[36:39], v[196:199]
v_add_f32 v251, v251, v214
v_mfma_f32_16x16x32_bf16 v[196:199], a[192:195], a[32:35], v[196:199]
v_add_f32 v251, v251, v215
v_mfma_f32_16x16x32_bf16 v[200:203], a[192:195], a[64:67], 0
v_cvt_pk_bf16_f32 v231, v214, v215
v_fma_f32 v216, v216, s27, -v248
v_mfma_f32_16x16x32_bf16 v[200:203], a[196:199], a[68:71], v[200:203]
v_fma_f32 v217, v217, s27, -v248
v_mfma_f32_16x16x32_bf16 v[200:203], a[200:203], a[72:75], v[200:203]
v_exp_f32 v216, v216
v_mfma_f32_16x16x32_bf16 v[200:203], a[204:207], a[76:79], v[200:203]
v_fma_f32 v218, v218, s27, -v248
v_mfma_f32_16x16x32_bf16 v[200:203], a[208:211], a[80:83], v[200:203]
v_fma_f32 v219, v219, s27, -v248
v_mfma_f32_16x16x32_bf16 v[200:203], a[212:215], a[84:87], v[200:203]
v_exp_f32 v217, v217
v_mfma_f32_16x16x32_bf16 v[200:203], a[216:219], a[88:91], v[200:203]
s_waitcnt vmcnt(10) lgkmcnt(0)
v_add_f32 v252, v252, v216
v_mfma_f32_16x16x32_bf16 v[200:203], a[220:223], a[92:95], v[200:203]
s_barrier
v_mfma_f32_16x16x32_bf16 v[208:211], a[224:227], a[0:3], 0
s_add_u32 m0, s26, 0
ds_read_b64_tr_b16 a[192:193], v241 offset:16640
v_mfma_f32_16x16x32_bf16 v[208:211], a[228:231], a[4:7], v[208:211]
buffer_load_dwordx4 v242, s[12:15], s29 offen offset:0 lds
v_mfma_f32_16x16x32_bf16 v[208:211], a[232:235], a[8:11], v[208:211]
v_exp_f32 v218, v218
v_mfma_f32_16x16x32_bf16 v[208:211], a[236:239], a[12:15], v[208:211]
ds_read_b64_tr_b16 a[194:195], v241 offset:17152
ds_read_b64_tr_b16 a[196:197], v241 offset:16656
v_mfma_f32_16x16x32_bf16 v[208:211], a[240:243], a[16:19], v[208:211]
v_add_f32 v252, v252, v217
v_cvt_pk_bf16_f32 v234, v216, v217
v_mfma_f32_16x16x32_bf16 v[208:211], a[244:247], a[20:23], v[208:211]
s_add_u32 m0, s26, 32
ds_read_b64_tr_b16 a[198:199], v241 offset:17168
v_mfma_f32_16x16x32_bf16 v[208:211], a[248:251], a[24:27], v[208:211]
buffer_load_dwordx4 v242, s[12:15], s29 offen offset:1024 lds
v_mfma_f32_16x16x32_bf16 v[208:211], a[252:255], a[28:31], v[208:211]
v_exp_f32 v219, v219
v_mfma_f32_16x16x32_bf16 v[212:215], a[252:255], a[60:63], 0
ds_read_b64_tr_b16 a[200:201], v241 offset:16672
v_add_f32 v252, v252, v218
v_mfma_f32_16x16x32_bf16 v[212:215], a[248:251], a[56:59], v[212:215]
ds_read_b64_tr_b16 a[202:203], v241 offset:17184
v_add_f32 v252, v252, v219
v_mfma_f32_16x16x32_bf16 v[212:215], a[244:247], a[52:55], v[212:215]
ds_read_b64_tr_b16 a[204:205], v241 offset:16688
v_cvt_pk_bf16_f32 v235, v218, v219
v_mfma_f32_16x16x32_bf16 v[212:215], a[240:243], a[48:51], v[212:215]
s_add_u32 m0, s26, 64
v_mfma_f32_16x16x32_bf16 v[212:215], a[236:239], a[44:47], v[212:215]
buffer_load_dwordx4 v242, s[12:15], s29 offen offset:2048 lds
v_mfma_f32_16x16x32_bf16 v[212:215], a[232:235], a[40:43], v[212:215]
ds_read_b64_tr_b16 a[206:207], v241 offset:17200
v_fma_f32 v192, v192, s27, -v246
v_mfma_f32_16x16x32_bf16 v[212:215], a[228:231], a[36:39], v[212:215]
ds_read_b64_tr_b16 a[208:209], v241 offset:16704
v_fma_f32 v193, v193, s27, -v246
v_mfma_f32_16x16x32_bf16 v[212:215], a[224:227], a[32:35], v[212:215]
v_exp_f32 v192, v192
v_mfma_f32_16x16x32_bf16 v[216:219], a[224:227], a[64:67], 0
ds_read_b64_tr_b16 a[210:211], v241 offset:17216
v_mfma_f32_16x16x32_bf16 v[216:219], a[228:231], a[68:71], v[216:219]
s_add_u32 m0, s26, 96
ds_read_b64_tr_b16 a[212:213], v241 offset:16720
v_mfma_f32_16x16x32_bf16 v[216:219], a[232:235], a[72:75], v[216:219]
buffer_load_dwordx4 v242, s[12:15], s29 offen offset:3072 lds
v_mfma_f32_16x16x32_bf16 v[216:219], a[236:239], a[76:79], v[216:219]
s_add_u32 s29, s29, 16384
v_fma_f32 v194, v194, s27, -v246
v_fma_f32 v195, v195, s27, -v246
v_mfma_f32_16x16x32_bf16 v[216:219], a[240:243], a[80:83], v[216:219]
ds_read_b64_tr_b16 a[214:215], v241 offset:17232
v_mfma_f32_16x16x32_bf16 v[216:219], a[244:247], a[84:87], v[216:219]
v_exp_f32 v193, v193
v_mfma_f32_16x16x32_bf16 v[216:219], a[248:251], a[88:91], v[216:219]
ds_read_b64_tr_b16 a[216:217], v241 offset:16736
v_add_f32 v250, v250, v192
v_mfma_f32_16x16x32_bf16 v[216:219], a[252:255], a[92:95], v[216:219]
s_waitcnt lgkmcnt(11)
ds_read_b64_tr_b16 a[218:219], v241 offset:17248
v_mfma_f32_16x16x32_bf16 v[0:3], v[224:227], a[192:195], v[0:3]
v_exp_f32 v194, v194
v_mfma_f32_16x16x32_bf16 v[64:67], v[228:231], a[192:195], v[64:67]
ds_read_b64_tr_b16 a[220:221], v241 offset:16752
v_add_f32 v250, v250, v193
v_mfma_f32_16x16x32_bf16 v[128:131], v[232:235], a[192:195], v[128:131]
v_cvt_pk_bf16_f32 v192, v192, v193
v_mfma_f32_16x16x32_bf16 a[128:131], v[236:239], a[192:195], a[128:131]
s_waitcnt lgkmcnt(11)
ds_read_b64_tr_b16 a[222:223], v241 offset:17264
v_mfma_f32_16x16x32_bf16 a[132:135], v[236:239], a[196:199], a[132:135]
v_exp_f32 v195, v195
v_mfma_f32_16x16x32_bf16 v[132:135], v[232:235], a[196:199], v[132:135]
ds_read_b64_tr_b16 a[224:225], v241 offset:16896
v_add_f32 v250, v250, v194
v_mfma_f32_16x16x32_bf16 v[68:71], v[228:231], a[196:199], v[68:71]
ds_read_b64_tr_b16 a[226:227], v241 offset:17408
v_add_f32 v250, v250, v195
v_mfma_f32_16x16x32_bf16 v[4:7], v[224:227], a[196:199], v[4:7]
s_waitcnt lgkmcnt(12)
v_cvt_pk_bf16_f32 v193, v194, v195
v_mfma_f32_16x16x32_bf16 v[8:11], v[224:227], a[200:203], v[8:11]
v_fma_f32 v196, v196, s27, -v247
v_fma_f32 v197, v197, s27, -v247
v_mfma_f32_16x16x32_bf16 v[72:75], v[228:231], a[200:203], v[72:75]
ds_read_b64_tr_b16 a[228:229], v241 offset:16912
v_mfma_f32_16x16x32_bf16 v[136:139], v[232:235], a[200:203], v[136:139]
v_exp_f32 v196, v196
v_mfma_f32_16x16x32_bf16 a[136:139], v[236:239], a[200:203], a[136:139]
s_waitcnt lgkmcnt(11)
ds_read_b64_tr_b16 a[230:231], v241 offset:17424
v_mfma_f32_16x16x32_bf16 a[140:143], v[236:239], a[204:207], a[140:143]
ds_read_b64_tr_b16 a[232:233], v241 offset:16928
v_fma_f32 v198, v198, s27, -v247
v_mfma_f32_16x16x32_bf16 v[140:143], v[232:235], a[204:207], v[140:143]
v_fma_f32 v199, v199, s27, -v247
v_mfma_f32_16x16x32_bf16 v[76:79], v[228:231], a[204:207], v[76:79]
ds_read_b64_tr_b16 a[234:235], v241 offset:17440
v_mfma_f32_16x16x32_bf16 v[12:15], v[224:227], a[204:207], v[12:15]
s_waitcnt lgkmcnt(12)
v_exp_f32 v197, v197
v_mfma_f32_16x16x32_bf16 v[16:19], v[224:227], a[208:211], v[16:19]
ds_read_b64_tr_b16 a[236:237], v241 offset:16944
v_add_f32 v251, v251, v196
v_mfma_f32_16x16x32_bf16 v[80:83], v[228:231], a[208:211], v[80:83]
v_exp_f32 v198, v198
v_mfma_f32_16x16x32_bf16 v[144:147], v[232:235], a[208:211], v[144:147]
ds_read_b64_tr_b16 a[238:239], v241 offset:17456
v_mfma_f32_16x16x32_bf16 a[144:147], v[236:239], a[208:211], a[144:147]
s_waitcnt lgkmcnt(12)
v_add_f32 v251, v251, v197
v_cvt_pk_bf16_f32 v196, v196, v197
v_mfma_f32_16x16x32_bf16 a[148:151], v[236:239], a[212:215], a[148:151]
ds_read_b64_tr_b16 a[240:241], v241 offset:16960
v_mfma_f32_16x16x32_bf16 v[148:151], v[232:235], a[212:215], v[148:151]
v_exp_f32 v199, v199
v_mfma_f32_16x16x32_bf16 v[84:87], v[228:231], a[212:215], v[84:87]
ds_read_b64_tr_b16 a[242:243], v241 offset:17472
v_mfma_f32_16x16x32_bf16 v[20:23], v[224:227], a[212:215], v[20:23]
s_waitcnt lgkmcnt(12)
ds_read_b64_tr_b16 a[244:245], v241 offset:16976
v_add_f32 v251, v251, v198
v_mfma_f32_16x16x32_bf16 v[24:27], v[224:227], a[216:219], v[24:27]
v_add_f32 v251, v251, v199
v_cvt_pk_bf16_f32 v197, v198, v199
v_mfma_f32_16x16x32_bf16 v[88:91], v[228:231], a[216:219], v[88:91]
ds_read_b64_tr_b16 a[246:247], v241 offset:17488
v_fma_f32 v200, v200, s27, -v248
v_mfma_f32_16x16x32_bf16 v[152:155], v[232:235], a[216:219], v[152:155]
v_fma_f32 v201, v201, s27, -v248
v_mfma_f32_16x16x32_bf16 a[152:155], v[236:239], a[216:219], a[152:155]
s_waitcnt lgkmcnt(12)
ds_read_b64_tr_b16 a[248:249], v241 offset:16992
v_mfma_f32_16x16x32_bf16 a[156:159], v[236:239], a[220:223], a[156:159]
v_exp_f32 v200, v200
v_mfma_f32_16x16x32_bf16 v[156:159], v[232:235], a[220:223], v[156:159]
ds_read_b64_tr_b16 a[250:251], v241 offset:17504
v_mfma_f32_16x16x32_bf16 v[92:95], v[228:231], a[220:223], v[92:95]
v_fma_f32 v202, v202, s27, -v248
v_fma_f32 v203, v203, s27, -v248
v_mfma_f32_16x16x32_bf16 v[28:31], v[224:227], a[220:223], v[28:31]
s_waitcnt lgkmcnt(12)
ds_read_b64_tr_b16 a[252:253], v241 offset:17008
v_mfma_f32_16x16x32_bf16 v[32:35], v[224:227], a[224:227], v[32:35]
v_exp_f32 v201, v201
v_mfma_f32_16x16x32_bf16 v[96:99], v[228:231], a[224:227], v[96:99]
ds_read_b64_tr_b16 a[254:255], v241 offset:17520
v_add_f32 v252, v252, v200
v_mfma_f32_16x16x32_bf16 v[160:163], v[232:235], a[224:227], v[160:163]
v_exp_f32 v202, v202
v_mfma_f32_16x16x32_bf16 a[160:163], v[236:239], a[224:227], a[160:163]
s_waitcnt lgkmcnt(12)
v_add_f32 v252, v252, v201
v_mfma_f32_16x16x32_bf16 a[164:167], v[236:239], a[228:231], a[164:167]
v_cvt_pk_bf16_f32 v200, v200, v201
v_mfma_f32_16x16x32_bf16 v[164:167], v[232:235], a[228:231], v[164:167]
v_exp_f32 v203, v203
v_mfma_f32_16x16x32_bf16 v[100:103], v[228:231], a[228:231], v[100:103]
v_add_f32 v252, v252, v202
v_mfma_f32_16x16x32_bf16 v[36:39], v[224:227], a[228:231], v[36:39]
s_waitcnt lgkmcnt(10)
v_add_f32 v252, v252, v203
v_cvt_pk_bf16_f32 v201, v202, v203
v_mfma_f32_16x16x32_bf16 v[40:43], v[224:227], a[232:235], v[40:43]
v_fma_f32 v208, v208, s27, -v246
v_mfma_f32_16x16x32_bf16 v[104:107], v[228:231], a[232:235], v[104:107]
s_waitcnt vmcnt(9) lgkmcnt(0)
v_fma_f32 v209, v209, s27, -v246
v_mfma_f32_16x16x32_bf16 v[168:171], v[232:235], a[232:235], v[168:171]
s_barrier
v_mfma_f32_16x16x32_bf16 a[168:171], v[236:239], a[232:235], a[168:171]
s_add_u32 m0, s3, 53504
ds_read_b128 v[204:207], v242 offset:29696
ds_read_b128 a[192:195], v240 offset:16896
v_mfma_f32_16x16x32_bf16 a[172:175], v[236:239], a[236:239], a[172:175]
buffer_load_dwordx4 v242, s[16:19], s30 offen offset:0 lds
v_mfma_f32_16x16x32_bf16 v[172:175], v[232:235], a[236:239], v[172:175]
ds_read_b128 a[196:199], v240 offset:16960
ds_read_b128 a[200:203], v240 offset:17024
v_mfma_f32_16x16x32_bf16 v[108:111], v[228:231], a[236:239], v[108:111]
v_exp_f32 v208, v208
v_mfma_f32_16x16x32_bf16 v[44:47], v[224:227], a[236:239], v[44:47]
s_add_u32 m0, s3, 53520
ds_read_b128 a[204:207], v240 offset:17088
v_fma_f32 v210, v210, s27, -v246
v_mfma_f32_16x16x32_bf16 v[48:51], v[224:227], a[240:243], v[48:51]
buffer_load_dwordx4 v242, s[16:19], s30 offen offset:1024 lds
v_mfma_f32_16x16x32_bf16 v[112:115], v[228:231], a[240:243], v[112:115]
ds_read_b128 a[208:211], v240 offset:17152
v_fma_f32 v211, v211, s27, -v246
v_mfma_f32_16x16x32_bf16 v[176:179], v[232:235], a[240:243], v[176:179]
v_exp_f32 v209, v209
v_mfma_f32_16x16x32_bf16 a[176:179], v[236:239], a[240:243], a[176:179]
ds_read_b128 a[212:215], v240 offset:17216
v_add_f32 v250, v250, v208
v_mfma_f32_16x16x32_bf16 a[180:183], v[236:239], a[244:247], a[180:183]
s_add_u32 m0, s3, 53536
v_mfma_f32_16x16x32_bf16 v[180:183], v[232:235], a[244:247], v[180:183]
buffer_load_dwordx4 v242, s[16:19], s30 offen offset:2048 lds
v_mfma_f32_16x16x32_bf16 v[116:119], v[228:231], a[244:247], v[116:119]
ds_read_b128 a[216:219], v240 offset:17280
v_mfma_f32_16x16x32_bf16 v[52:55], v[224:227], a[244:247], v[52:55]
v_exp_f32 v210, v210
v_mfma_f32_16x16x32_bf16 v[56:59], v[224:227], a[248:251], v[56:59]
ds_read_b128 a[220:223], v240 offset:17344
v_add_f32 v250, v250, v209
v_mfma_f32_16x16x32_bf16 v[120:123], v[228:231], a[248:251], v[120:123]
s_add_u32 m0, s3, 53552
v_cvt_pk_bf16_f32 v194, v208, v209
v_mfma_f32_16x16x32_bf16 v[184:187], v[232:235], a[248:251], v[184:187]
buffer_load_dwordx4 v242, s[16:19], s30 offen offset:3072 lds
v_mfma_f32_16x16x32_bf16 a[184:187], v[236:239], a[248:251], a[184:187]
s_add_u32 s30, s30, 16384
v_exp_f32 v211, v211
v_mfma_f32_16x16x32_bf16 a[188:191], v[236:239], a[252:255], a[188:191]
v_add_f32 v250, v250, v210
v_add_f32 v250, v250, v211
v_mfma_f32_16x16x32_bf16 v[188:191], v[232:235], a[252:255], v[188:191]
v_cvt_pk_bf16_f32 v195, v210, v211
v_mfma_f32_16x16x32_bf16 v[124:127], v[228:231], a[252:255], v[124:127]
v_mfma_f32_16x16x32_bf16 v[60:63], v[224:227], a[252:255], v[60:63]
s_waitcnt lgkmcnt(7)
v_mfma_f32_16x16x32_bf16 v[224:227], a[192:195], a[0:3], 0
s_waitcnt lgkmcnt(6)
ds_read_b128 a[224:227], v240 offset:17408
v_fma_f32 v212, v212, s27, -v247
v_mfma_f32_16x16x32_bf16 v[224:227], a[196:199], a[4:7], v[224:227]
s_waitcnt lgkmcnt(6)
ds_read_b128 a[228:231], v240 offset:17472
v_fma_f32 v213, v213, s27, -v247
v_mfma_f32_16x16x32_bf16 v[224:227], a[200:203], a[8:11], v[224:227]
s_waitcnt lgkmcnt(6)
v_exp_f32 v212, v212
v_mfma_f32_16x16x32_bf16 v[224:227], a[204:207], a[12:15], v[224:227]
s_waitcnt lgkmcnt(5)
ds_read_b128 a[232:235], v240 offset:17536
v_fma_f32 v214, v214, s27, -v247
v_mfma_f32_16x16x32_bf16 v[224:227], a[208:211], a[16:19], v[224:227]
s_waitcnt lgkmcnt(5)
ds_read_b128 a[236:239], v240 offset:17600
v_fma_f32 v215, v215, s27, -v247
v_mfma_f32_16x16x32_bf16 v[224:227], a[212:215], a[20:23], v[224:227]
s_waitcnt lgkmcnt(5)
v_exp_f32 v213, v213
v_mfma_f32_16x16x32_bf16 v[224:227], a[216:219], a[24:27], v[224:227]
s_waitcnt lgkmcnt(4)
ds_read_b128 a[240:243], v240 offset:17664
v_mfma_f32_16x16x32_bf16 v[224:227], a[220:223], a[28:31], v[224:227]
v_add_f32 v251, v251, v212
v_mfma_f32_16x16x32_bf16 v[228:231], a[220:223], a[60:63], 0
s_add_u32 m0, s5, 8448
ds_read_b128 a[244:247], v240 offset:17728
v_mfma_f32_16x16x32_bf16 v[228:231], a[216:219], a[56:59], v[228:231]
s_add_u32 s5, s5, 1056
buffer_load_dwordx4 v243, s[8:11], s33 offen nt lds
v_mfma_f32_16x16x32_bf16 v[228:231], a[212:215], a[52:55], v[228:231]
s_add_u32 s33, s33, 512
v_exp_f32 v214, v214
v_mfma_f32_16x16x32_bf16 v[228:231], a[208:211], a[48:51], v[228:231]
ds_read_b128 a[248:251], v240 offset:17792
v_add_f32 v251, v251, v213
v_mfma_f32_16x16x32_bf16 v[228:231], a[204:207], a[44:47], v[228:231]
ds_read_b128 a[252:255], v240 offset:17856
v_cvt_pk_bf16_f32 v198, v212, v213
v_mfma_f32_16x16x32_bf16 v[228:231], a[200:203], a[40:43], v[228:231]
v_exp_f32 v215, v215
v_mfma_f32_16x16x32_bf16 v[228:231], a[196:199], a[36:39], v[228:231]
v_add_f32 v251, v251, v214
v_mfma_f32_16x16x32_bf16 v[228:231], a[192:195], a[32:35], v[228:231]
v_add_f32 v251, v251, v215
v_mfma_f32_16x16x32_bf16 v[232:235], a[192:195], a[64:67], 0
v_cvt_pk_bf16_f32 v199, v214, v215
v_fma_f32 v216, v216, s27, -v248
v_mfma_f32_16x16x32_bf16 v[232:235], a[196:199], a[68:71], v[232:235]
v_fma_f32 v217, v217, s27, -v248
v_mfma_f32_16x16x32_bf16 v[232:235], a[200:203], a[72:75], v[232:235]
v_exp_f32 v216, v216
v_mfma_f32_16x16x32_bf16 v[232:235], a[204:207], a[76:79], v[232:235]
v_fma_f32 v218, v218, s27, -v248
v_mfma_f32_16x16x32_bf16 v[232:235], a[208:211], a[80:83], v[232:235]
v_fma_f32 v219, v219, s27, -v248
v_mfma_f32_16x16x32_bf16 v[232:235], a[212:215], a[84:87], v[232:235]
v_exp_f32 v217, v217
v_mfma_f32_16x16x32_bf16 v[232:235], a[216:219], a[88:91], v[232:235]
s_waitcnt vmcnt(10) lgkmcnt(0)
v_add_f32 v252, v252, v216
v_mfma_f32_16x16x32_bf16 v[232:235], a[220:223], a[92:95], v[232:235]
s_barrier
v_mfma_f32_16x16x32_bf16 v[208:211], a[224:227], a[0:3], 0
s_add_u32 m0, s26, 16896
ds_read_b64_tr_b16 a[192:193], v241 offset:0
v_mfma_f32_16x16x32_bf16 v[208:211], a[228:231], a[4:7], v[208:211]
buffer_load_dwordx4 v242, s[12:15], s29 offen offset:0 lds
v_mfma_f32_16x16x32_bf16 v[208:211], a[232:235], a[8:11], v[208:211]
v_exp_f32 v218, v218
v_mfma_f32_16x16x32_bf16 v[208:211], a[236:239], a[12:15], v[208:211]
ds_read_b64_tr_b16 a[194:195], v241 offset:512
ds_read_b64_tr_b16 a[196:197], v241 offset:16
v_mfma_f32_16x16x32_bf16 v[208:211], a[240:243], a[16:19], v[208:211]
v_add_f32 v252, v252, v217
v_cvt_pk_bf16_f32 v202, v216, v217
v_mfma_f32_16x16x32_bf16 v[208:211], a[244:247], a[20:23], v[208:211]
s_add_u32 m0, s26, 16928
ds_read_b64_tr_b16 a[198:199], v241 offset:528
v_mfma_f32_16x16x32_bf16 v[208:211], a[248:251], a[24:27], v[208:211]
buffer_load_dwordx4 v242, s[12:15], s29 offen offset:1024 lds
v_mfma_f32_16x16x32_bf16 v[208:211], a[252:255], a[28:31], v[208:211]
v_exp_f32 v219, v219
v_mfma_f32_16x16x32_bf16 v[212:215], a[252:255], a[60:63], 0
ds_read_b64_tr_b16 a[200:201], v241 offset:32
v_add_f32 v252, v252, v218
v_mfma_f32_16x16x32_bf16 v[212:215], a[248:251], a[56:59], v[212:215]
ds_read_b64_tr_b16 a[202:203], v241 offset:544
v_add_f32 v252, v252, v219
v_mfma_f32_16x16x32_bf16 v[212:215], a[244:247], a[52:55], v[212:215]
ds_read_b64_tr_b16 a[204:205], v241 offset:48
v_cvt_pk_bf16_f32 v203, v218, v219
v_mfma_f32_16x16x32_bf16 v[212:215], a[240:243], a[48:51], v[212:215]
s_add_u32 m0, s26, 16960
v_mfma_f32_16x16x32_bf16 v[212:215], a[236:239], a[44:47], v[212:215]
buffer_load_dwordx4 v242, s[12:15], s29 offen offset:2048 lds
v_mfma_f32_16x16x32_bf16 v[212:215], a[232:235], a[40:43], v[212:215]
ds_read_b64_tr_b16 a[206:207], v241 offset:560
v_fma_f32 v224, v224, s27, -v246
v_mfma_f32_16x16x32_bf16 v[212:215], a[228:231], a[36:39], v[212:215]
ds_read_b64_tr_b16 a[208:209], v241 offset:64
v_fma_f32 v225, v225, s27, -v246
v_mfma_f32_16x16x32_bf16 v[212:215], a[224:227], a[32:35], v[212:215]
v_exp_f32 v224, v224
v_mfma_f32_16x16x32_bf16 v[216:219], a[224:227], a[64:67], 0
ds_read_b64_tr_b16 a[210:211], v241 offset:576
v_mfma_f32_16x16x32_bf16 v[216:219], a[228:231], a[68:71], v[216:219]
s_add_u32 m0, s26, 16992
ds_read_b64_tr_b16 a[212:213], v241 offset:80
v_mfma_f32_16x16x32_bf16 v[216:219], a[232:235], a[72:75], v[216:219]
buffer_load_dwordx4 v242, s[12:15], s29 offen offset:3072 lds
v_mfma_f32_16x16x32_bf16 v[216:219], a[236:239], a[76:79], v[216:219]
s_add_u32 s29, s29, 16384
v_fma_f32 v226, v226, s27, -v246
v_fma_f32 v227, v227, s27, -v246
v_mfma_f32_16x16x32_bf16 v[216:219], a[240:243], a[80:83], v[216:219]
ds_read_b64_tr_b16 a[214:215], v241 offset:592
v_mfma_f32_16x16x32_bf16 v[216:219], a[244:247], a[84:87], v[216:219]
v_exp_f32 v225, v225
v_mfma_f32_16x16x32_bf16 v[216:219], a[248:251], a[88:91], v[216:219]
ds_read_b64_tr_b16 a[216:217], v241 offset:96
v_add_f32 v250, v250, v224
v_mfma_f32_16x16x32_bf16 v[216:219], a[252:255], a[92:95], v[216:219]
s_waitcnt lgkmcnt(11)
ds_read_b64_tr_b16 a[218:219], v241 offset:608
v_mfma_f32_16x16x32_bf16 v[0:3], v[192:195], a[192:195], v[0:3]
v_exp_f32 v226, v226
v_mfma_f32_16x16x32_bf16 v[64:67], v[196:199], a[192:195], v[64:67]
ds_read_b64_tr_b16 a[220:221], v241 offset:112
v_add_f32 v250, v250, v225
v_mfma_f32_16x16x32_bf16 v[128:131], v[200:203], a[192:195], v[128:131]
v_cvt_pk_bf16_f32 v224, v224, v225
v_mfma_f32_16x16x32_bf16 a[128:131], v[204:207], a[192:195], a[128:131]
s_waitcnt lgkmcnt(11)
ds_read_b64_tr_b16 a[222:223], v241 offset:624
v_mfma_f32_16x16x32_bf16 a[132:135], v[204:207], a[196:199], a[132:135]
v_exp_f32 v227, v227
v_mfma_f32_16x16x32_bf16 v[132:135], v[200:203], a[196:199], v[132:135]
ds_read_b64_tr_b16 a[224:225], v241 offset:256
v_add_f32 v250, v250, v226
v_mfma_f32_16x16x32_bf16 v[68:71], v[196:199], a[196:199], v[68:71]
ds_read_b64_tr_b16 a[226:227], v241 offset:768
v_add_f32 v250, v250, v227
v_mfma_f32_16x16x32_bf16 v[4:7], v[192:195], a[196:199], v[4:7]
s_waitcnt lgkmcnt(12)
v_cvt_pk_bf16_f32 v225, v226, v227
v_mfma_f32_16x16x32_bf16 v[8:11], v[192:195], a[200:203], v[8:11]
v_fma_f32 v228, v228, s27, -v247
v_fma_f32 v229, v229, s27, -v247
v_mfma_f32_16x16x32_bf16 v[72:75], v[196:199], a[200:203], v[72:75]
ds_read_b64_tr_b16 a[228:229], v241 offset:272
v_mfma_f32_16x16x32_bf16 v[136:139], v[200:203], a[200:203], v[136:139]
v_exp_f32 v228, v228
v_mfma_f32_16x16x32_bf16 a[136:139], v[204:207], a[200:203], a[136:139]
s_waitcnt lgkmcnt(11)
ds_read_b64_tr_b16 a[230:231], v241 offset:784
v_mfma_f32_16x16x32_bf16 a[140:143], v[204:207], a[204:207], a[140:143]
ds_read_b64_tr_b16 a[232:233], v241 offset:288
v_fma_f32 v230, v230, s27, -v247
v_mfma_f32_16x16x32_bf16 v[140:143], v[200:203], a[204:207], v[140:143]
v_fma_f32 v231, v231, s27, -v247
v_mfma_f32_16x16x32_bf16 v[76:79], v[196:199], a[204:207], v[76:79]
ds_read_b64_tr_b16 a[234:235], v241 offset:800
v_mfma_f32_16x16x32_bf16 v[12:15], v[192:195], a[204:207], v[12:15]
s_waitcnt lgkmcnt(12)
v_exp_f32 v229, v229
v_mfma_f32_16x16x32_bf16 v[16:19], v[192:195], a[208:211], v[16:19]
ds_read_b64_tr_b16 a[236:237], v241 offset:304
v_add_f32 v251, v251, v228
v_mfma_f32_16x16x32_bf16 v[80:83], v[196:199], a[208:211], v[80:83]
v_exp_f32 v230, v230
v_mfma_f32_16x16x32_bf16 v[144:147], v[200:203], a[208:211], v[144:147]
ds_read_b64_tr_b16 a[238:239], v241 offset:816
v_mfma_f32_16x16x32_bf16 a[144:147], v[204:207], a[208:211], a[144:147]
s_waitcnt lgkmcnt(12)
v_add_f32 v251, v251, v229
v_cvt_pk_bf16_f32 v228, v228, v229
v_mfma_f32_16x16x32_bf16 a[148:151], v[204:207], a[212:215], a[148:151]
ds_read_b64_tr_b16 a[240:241], v241 offset:320
v_mfma_f32_16x16x32_bf16 v[148:151], v[200:203], a[212:215], v[148:151]
v_exp_f32 v231, v231
v_mfma_f32_16x16x32_bf16 v[84:87], v[196:199], a[212:215], v[84:87]
ds_read_b64_tr_b16 a[242:243], v241 offset:832
v_mfma_f32_16x16x32_bf16 v[20:23], v[192:195], a[212:215], v[20:23]
s_waitcnt lgkmcnt(12)
ds_read_b64_tr_b16 a[244:245], v241 offset:336
v_add_f32 v251, v251, v230
v_mfma_f32_16x16x32_bf16 v[24:27], v[192:195], a[216:219], v[24:27]
v_add_f32 v251, v251, v231
v_cvt_pk_bf16_f32 v229, v230, v231
v_mfma_f32_16x16x32_bf16 v[88:91], v[196:199], a[216:219], v[88:91]
ds_read_b64_tr_b16 a[246:247], v241 offset:848
v_fma_f32 v232, v232, s27, -v248
v_mfma_f32_16x16x32_bf16 v[152:155], v[200:203], a[216:219], v[152:155]
v_fma_f32 v233, v233, s27, -v248
v_mfma_f32_16x16x32_bf16 a[152:155], v[204:207], a[216:219], a[152:155]
s_waitcnt lgkmcnt(12)
ds_read_b64_tr_b16 a[248:249], v241 offset:352
v_mfma_f32_16x16x32_bf16 a[156:159], v[204:207], a[220:223], a[156:159]
v_exp_f32 v232, v232
v_mfma_f32_16x16x32_bf16 v[156:159], v[200:203], a[220:223], v[156:159]
ds_read_b64_tr_b16 a[250:251], v241 offset:864
v_mfma_f32_16x16x32_bf16 v[92:95], v[196:199], a[220:223], v[92:95]
v_fma_f32 v234, v234, s27, -v248
v_fma_f32 v235, v235, s27, -v248
v_mfma_f32_16x16x32_bf16 v[28:31], v[192:195], a[220:223], v[28:31]
s_waitcnt lgkmcnt(12)
ds_read_b64_tr_b16 a[252:253], v241 offset:368
v_mfma_f32_16x16x32_bf16 v[32:35], v[192:195], a[224:227], v[32:35]
v_exp_f32 v233, v233
v_mfma_f32_16x16x32_bf16 v[96:99], v[196:199], a[224:227], v[96:99]
ds_read_b64_tr_b16 a[254:255], v241 offset:880
v_add_f32 v252, v252, v232
v_mfma_f32_16x16x32_bf16 v[160:163], v[200:203], a[224:227], v[160:163]
v_exp_f32 v234, v234
v_mfma_f32_16x16x32_bf16 a[160:163], v[204:207], a[224:227], a[160:163]
s_waitcnt lgkmcnt(12)
v_add_f32 v252, v252, v233
v_mfma_f32_16x16x32_bf16 a[164:167], v[204:207], a[228:231], a[164:167]
v_cvt_pk_bf16_f32 v232, v232, v233
v_mfma_f32_16x16x32_bf16 v[164:167], v[200:203], a[228:231], v[164:167]
v_exp_f32 v235, v235
v_mfma_f32_16x16x32_bf16 v[100:103], v[196:199], a[228:231], v[100:103]
v_add_f32 v252, v252, v234
v_mfma_f32_16x16x32_bf16 v[36:39], v[192:195], a[228:231], v[36:39]
s_waitcnt lgkmcnt(10)
v_add_f32 v252, v252, v235
v_cvt_pk_bf16_f32 v233, v234, v235
v_mfma_f32_16x16x32_bf16 v[40:43], v[192:195], a[232:235], v[40:43]
v_fma_f32 v208, v208, s27, -v246
v_mfma_f32_16x16x32_bf16 v[104:107], v[196:199], a[232:235], v[104:107]
s_waitcnt vmcnt(9) lgkmcnt(0)
v_fma_f32 v209, v209, s27, -v246
v_mfma_f32_16x16x32_bf16 v[168:171], v[200:203], a[232:235], v[168:171]
s_barrier
v_mfma_f32_16x16x32_bf16 a[168:171], v[204:207], a[232:235], a[168:171]
s_add_u32 m0, s3, 36864
ds_read_b128 v[236:239], v242 offset:30720
ds_read_b128 a[192:195], v240 offset:0
v_mfma_f32_16x16x32_bf16 a[172:175], v[204:207], a[236:239], a[172:175]
buffer_load_dwordx4 v242, s[16:19], s30 offen offset:0 lds
v_mfma_f32_16x16x32_bf16 v[172:175], v[200:203], a[236:239], v[172:175]
ds_read_b128 a[196:199], v240 offset:64
ds_read_b128 a[200:203], v240 offset:128
v_mfma_f32_16x16x32_bf16 v[108:111], v[196:199], a[236:239], v[108:111]
v_exp_f32 v208, v208
v_mfma_f32_16x16x32_bf16 v[44:47], v[192:195], a[236:239], v[44:47]
s_add_u32 m0, s3, 36880
ds_read_b128 a[204:207], v240 offset:192
v_fma_f32 v210, v210, s27, -v246
v_mfma_f32_16x16x32_bf16 v[48:51], v[192:195], a[240:243], v[48:51]
buffer_load_dwordx4 v242, s[16:19], s30 offen offset:1024 lds
v_mfma_f32_16x16x32_bf16 v[112:115], v[196:199], a[240:243], v[112:115]
ds_read_b128 a[208:211], v240 offset:256
v_fma_f32 v211, v211, s27, -v246
v_mfma_f32_16x16x32_bf16 v[176:179], v[200:203], a[240:243], v[176:179]
v_exp_f32 v209, v209
v_mfma_f32_16x16x32_bf16 a[176:179], v[204:207], a[240:243], a[176:179]
ds_read_b128 a[212:215], v240 offset:320
v_add_f32 v250, v250, v208
v_mfma_f32_16x16x32_bf16 a[180:183], v[204:207], a[244:247], a[180:183]
s_add_u32 m0, s3, 36896
v_mfma_f32_16x16x32_bf16 v[180:183], v[200:203], a[244:247], v[180:183]
buffer_load_dwordx4 v242, s[16:19], s30 offen offset:2048 lds
v_mfma_f32_16x16x32_bf16 v[116:119], v[196:199], a[244:247], v[116:119]
ds_read_b128 a[216:219], v240 offset:384
v_mfma_f32_16x16x32_bf16 v[52:55], v[192:195], a[244:247], v[52:55]
v_exp_f32 v210, v210
v_mfma_f32_16x16x32_bf16 v[56:59], v[192:195], a[248:251], v[56:59]
ds_read_b128 a[220:223], v240 offset:448
v_add_f32 v250, v250, v209
v_mfma_f32_16x16x32_bf16 v[120:123], v[196:199], a[248:251], v[120:123]
s_add_u32 m0, s3, 36912
v_cvt_pk_bf16_f32 v226, v208, v209
v_mfma_f32_16x16x32_bf16 v[184:187], v[200:203], a[248:251], v[184:187]
buffer_load_dwordx4 v242, s[16:19], s30 offen offset:3072 lds
v_mfma_f32_16x16x32_bf16 a[184:187], v[204:207], a[248:251], a[184:187]
s_add_u32 s30, s30, 16384
v_exp_f32 v211, v211
v_mfma_f32_16x16x32_bf16 a[188:191], v[204:207], a[252:255], a[188:191]
v_add_f32 v250, v250, v210
v_add_f32 v250, v250, v211
v_mfma_f32_16x16x32_bf16 v[188:191], v[200:203], a[252:255], v[188:191]
v_cvt_pk_bf16_f32 v227, v210, v211
v_mfma_f32_16x16x32_bf16 v[124:127], v[196:199], a[252:255], v[124:127]
v_mfma_f32_16x16x32_bf16 v[60:63], v[192:195], a[252:255], v[60:63]
s_sub_u32 s39, s39, 1
s_cbranch_scc0 L_loopp
s_waitcnt lgkmcnt(7)
v_mfma_f32_16x16x32_bf16 v[192:195], a[192:195], a[0:3], 0
s_waitcnt lgkmcnt(6)
ds_read_b128 a[224:227], v240 offset:512
v_fma_f32 v212, v212, s27, -v247
v_mfma_f32_16x16x32_bf16 v[192:195], a[196:199], a[4:7], v[192:195]
s_waitcnt lgkmcnt(6)
ds_read_b128 a[228:231], v240 offset:576
v_fma_f32 v213, v213, s27, -v247
v_mfma_f32_16x16x32_bf16 v[192:195], a[200:203], a[8:11], v[192:195]
s_waitcnt lgkmcnt(6)
v_exp_f32 v212, v212
v_mfma_f32_16x16x32_bf16 v[192:195], a[204:207], a[12:15], v[192:195]
s_waitcnt lgkmcnt(5)
ds_read_b128 a[232:235], v240 offset:640
v_fma_f32 v214, v214, s27, -v247
v_mfma_f32_16x16x32_bf16 v[192:195], a[208:211], a[16:19], v[192:195]
s_waitcnt lgkmcnt(5)
ds_read_b128 a[236:239], v240 offset:704
v_fma_f32 v215, v215, s27, -v247
v_mfma_f32_16x16x32_bf16 v[192:195], a[212:215], a[20:23], v[192:195]
s_waitcnt lgkmcnt(5)
v_exp_f32 v213, v213
v_mfma_f32_16x16x32_bf16 v[192:195], a[216:219], a[24:27], v[192:195]
s_waitcnt lgkmcnt(4)
ds_read_b128 a[240:243], v240 offset:768
v_add_f32 v251, v251, v212
v_mfma_f32_16x16x32_bf16 v[192:195], a[220:223], a[28:31], v[192:195]
v_exp_f32 v214, v214
v_mfma_f32_16x16x32_bf16 v[196:199], a[220:223], a[60:63], 0
s_add_u32 m0, s5, 0
ds_read_b128 a[244:247], v240 offset:832
v_mfma_f32_16x16x32_bf16 v[196:199], a[216:219], a[56:59], v[196:199]
buffer_load_dwordx4 v243, s[8:11], s38 offen nt lds
v_mfma_f32_16x16x32_bf16 v[196:199], a[212:215], a[52:55], v[196:199]
s_add_u32 s38, s38, 512
ds_read_b128 a[248:251], v240 offset:896
v_add_f32 v251, v251, v213
v_mfma_f32_16x16x32_bf16 v[196:199], a[208:211], a[48:51], v[196:199]
ds_read_b128 a[252:255], v240 offset:960
v_cvt_pk_bf16_f32 v230, v212, v213
v_mfma_f32_16x16x32_bf16 v[196:199], a[204:207], a[44:47], v[196:199]
v_exp_f32 v215, v215
v_mfma_f32_16x16x32_bf16 v[196:199], a[200:203], a[40:43], v[196:199]
v_add_f32 v251, v251, v214
v_add_f32 v251, v251, v215
v_mfma_f32_16x16x32_bf16 v[196:199], a[196:199], a[36:39], v[196:199]
s_add_u32 m0, s5, 8448
v_mfma_f32_16x16x32_bf16 v[196:199], a[192:195], a[32:35], v[196:199]
s_add_u32 s5, s5, 1056
buffer_load_dwordx4 v243, s[8:11], s33 offen nt lds
v_mfma_f32_16x16x32_bf16 v[200:203], a[192:195], a[64:67], 0
s_add_u32 s33, s33, 512
v_cvt_pk_bf16_f32 v231, v214, v215
v_fma_f32 v216, v216, s27, -v248
v_mfma_f32_16x16x32_bf16 v[200:203], a[196:199], a[68:71], v[200:203]
v_fma_f32 v217, v217, s27, -v248
v_mfma_f32_16x16x32_bf16 v[200:203], a[200:203], a[72:75], v[200:203]
v_exp_f32 v216, v216
v_mfma_f32_16x16x32_bf16 v[200:203], a[204:207], a[76:79], v[200:203]
v_fma_f32 v218, v218, s27, -v248
v_fma_f32 v219, v219, s27, -v248
v_mfma_f32_16x16x32_bf16 v[200:203], a[208:211], a[80:83], v[200:203]
v_exp_f32 v217, v217
v_mfma_f32_16x16x32_bf16 v[200:203], a[212:215], a[84:87], v[200:203]
v_add_f32 v252, v252, v216
v_mfma_f32_16x16x32_bf16 v[200:203], a[216:219], a[88:91], v[200:203]
s_waitcnt vmcnt(11) lgkmcnt(0)
v_exp_f32 v218, v218
v_mfma_f32_16x16x32_bf16 v[200:203], a[220:223], a[92:95], v[200:203]
s_barrier
v_mfma_f32_16x16x32_bf16 v[208:211], a[224:227], a[0:3], 0
s_mov_b32 s29, s32
s_add_u32 m0, s26, 0
v_add_f32 v252, v252, v217
v_mfma_f32_16x16x32_bf16 v[208:211], a[228:231], a[4:7], v[208:211]
buffer_load_dwordx4 v242, s[12:15], s29 offen offset:0 lds
v_mfma_f32_16x16x32_bf16 v[208:211], a[232:235], a[8:11], v[208:211]
ds_read_b64_tr_b16 a[192:193], v241 offset:16640
ds_read_b64_tr_b16 a[194:195], v241 offset:17152
v_mfma_f32_16x16x32_bf16 v[208:211], a[236:239], a[12:15], v[208:211]
ds_read_b64_tr_b16 a[196:197], v241 offset:16656
v_cvt_pk_bf16_f32 v234, v216, v217
v_mfma_f32_16x16x32_bf16 v[208:211], a[240:243], a[16:19], v[208:211]
v_exp_f32 v219, v219
v_mfma_f32_16x16x32_bf16 v[208:211], a[244:247], a[20:23], v[208:211]
s_add_u32 m0, s26, 32
ds_read_b64_tr_b16 a[198:199], v241 offset:17168
v_add_f32 v252, v252, v218
v_mfma_f32_16x16x32_bf16 v[208:211], a[248:251], a[24:27], v[208:211]
buffer_load_dwordx4 v242, s[12:15], s29 offen offset:1024 lds
v_mfma_f32_16x16x32_bf16 v[208:211], a[252:255], a[28:31], v[208:211]
ds_read_b64_tr_b16 a[200:201], v241 offset:16672
v_add_f32 v252, v252, v219
v_mfma_f32_16x16x32_bf16 v[212:215], a[252:255], a[60:63], 0
v_cvt_pk_bf16_f32 v235, v218, v219
v_fma_f32 v192, v192, s27, -v246
v_mfma_f32_16x16x32_bf16 v[212:215], a[248:251], a[56:59], v[212:215]
ds_read_b64_tr_b16 a[202:203], v241 offset:17184
v_fma_f32 v193, v193, s27, -v246
v_mfma_f32_16x16x32_bf16 v[212:215], a[244:247], a[52:55], v[212:215]
v_exp_f32 v192, v192
v_mfma_f32_16x16x32_bf16 v[212:215], a[240:243], a[48:51], v[212:215]
s_add_u32 m0, s26, 64
ds_read_b64_tr_b16 a[204:205], v241 offset:16688
v_mfma_f32_16x16x32_bf16 v[212:215], a[236:239], a[44:47], v[212:215]
buffer_load_dwordx4 v242, s[12:15], s29 offen offset:2048 lds
v_mfma_f32_16x16x32_bf16 v[212:215], a[232:235], a[40:43], v[212:215]
ds_read_b64_tr_b16 a[206:207], v241 offset:17200
v_fma_f32 v194, v194, s27, -v246
v_mfma_f32_16x16x32_bf16 v[212:215], a[228:231], a[36:39], v[212:215]
ds_read_b64_tr_b16 a[208:209], v241 offset:16704
v_fma_f32 v195, v195, s27, -v246
v_mfma_f32_16x16x32_bf16 v[212:215], a[224:227], a[32:35], v[212:215]
v_exp_f32 v193, v193
v_mfma_f32_16x16x32_bf16 v[216:219], a[224:227], a[64:67], 0
ds_read_b64_tr_b16 a[210:211], v241 offset:17216
v_add_f32 v250, v250, v192
v_mfma_f32_16x16x32_bf16 v[216:219], a[228:231], a[68:71], v[216:219]
s_add_u32 m0, s26, 96
ds_read_b64_tr_b16 a[212:213], v241 offset:16720
v_mfma_f32_16x16x32_bf16 v[216:219], a[232:235], a[72:75], v[216:219]
buffer_load_dwordx4 v242, s[12:15], s29 offen offset:3072 lds
v_mfma_f32_16x16x32_bf16 v[216:219], a[236:239], a[76:79], v[216:219]
s_add_u32 s29, s29, 16384
v_exp_f32 v194, v194
v_mfma_f32_16x16x32_bf16 v[216:219], a[240:243], a[80:83], v[216:219]
ds_read_b64_tr_b16 a[214:215], v241 offset:17232
v_add_f32 v250, v250, v193
v_mfma_f32_16x16x32_bf16 v[216:219], a[244:247], a[84:87], v[216:219]
ds_read_b64_tr_b16 a[216:217], v241 offset:16736
v_cvt_pk_bf16_f32 v192, v192, v193
v_mfma_f32_16x16x32_bf16 v[216:219], a[248:251], a[88:91], v[216:219]
v_exp_f32 v195, v195
v_mfma_f32_16x16x32_bf16 v[216:219], a[252:255], a[92:95], v[216:219]
s_waitcnt lgkmcnt(11)
ds_read_b64_tr_b16 a[218:219], v241 offset:17248
v_add_f32 v250, v250, v194
v_mfma_f32_16x16x32_bf16 v[0:3], v[224:227], a[192:195], v[0:3]
v_add_f32 v250, v250, v195
v_cvt_pk_bf16_f32 v193, v194, v195
v_mfma_f32_16x16x32_bf16 v[64:67], v[228:231], a[192:195], v[64:67]
ds_read_b64_tr_b16 a[220:221], v241 offset:16752
v_fma_f32 v196, v196, s27, -v247
v_mfma_f32_16x16x32_bf16 v[128:131], v[232:235], a[192:195], v[128:131]
v_fma_f32 v197, v197, s27, -v247
v_mfma_f32_16x16x32_bf16 a[128:131], v[236:239], a[192:195], a[128:131]
s_waitcnt lgkmcnt(11)
ds_read_b64_tr_b16 a[222:223], v241 offset:17264
v_mfma_f32_16x16x32_bf16 a[132:135], v[236:239], a[196:199], a[132:135]
v_exp_f32 v196, v196
v_mfma_f32_16x16x32_bf16 v[132:135], v[232:235], a[196:199], v[132:135]
ds_read_b64_tr_b16 a[224:225], v241 offset:16896
v_fma_f32 v198, v198, s27, -v247
v_mfma_f32_16x16x32_bf16 v[68:71], v[228:231], a[196:199], v[68:71]
ds_read_b64_tr_b16 a[226:227], v241 offset:17408
v_fma_f32 v199, v199, s27, -v247
v_mfma_f32_16x16x32_bf16 v[4:7], v[224:227], a[196:199], v[4:7]
s_waitcnt lgkmcnt(12)
v_exp_f32 v197, v197
v_mfma_f32_16x16x32_bf16 v[8:11], v[224:227], a[200:203], v[8:11]
ds_read_b64_tr_b16 a[228:229], v241 offset:16912
v_add_f32 v251, v251, v196
v_mfma_f32_16x16x32_bf16 v[72:75], v[228:231], a[200:203], v[72:75]
v_exp_f32 v198, v198
v_mfma_f32_16x16x32_bf16 v[136:139], v[232:235], a[200:203], v[136:139]
ds_read_b64_tr_b16 a[230:231], v241 offset:17424
v_add_f32 v251, v251, v197
v_mfma_f32_16x16x32_bf16 a[136:139], v[236:239], a[200:203], a[136:139]
s_waitcnt lgkmcnt(12)
v_cvt_pk_bf16_f32 v196, v196, v197
v_mfma_f32_16x16x32_bf16 a[140:143], v[236:239], a[204:207], a[140:143]
ds_read_b64_tr_b16 a[232:233], v241 offset:16928
v_mfma_f32_16x16x32_bf16 v[140:143], v[232:235], a[204:207], v[140:143]
v_exp_f32 v199, v199
v_mfma_f32_16x16x32_bf16 v[76:79], v[228:231], a[204:207], v[76:79]
ds_read_b64_tr_b16 a[234:235], v241 offset:17440
v_add_f32 v251, v251, v198
v_mfma_f32_16x16x32_bf16 v[12:15], v[224:227], a[204:207], v[12:15]
s_waitcnt lgkmcnt(12)
v_add_f32 v251, v251, v199
v_cvt_pk_bf16_f32 v197, v198, v199
v_mfma_f32_16x16x32_bf16 v[16:19], v[224:227], a[208:211], v[16:19]
ds_read_b64_tr_b16 a[236:237], v241 offset:16944
v_fma_f32 v200, v200, s27, -v248
v_mfma_f32_16x16x32_bf16 v[80:83], v[228:231], a[208:211], v[80:83]
ds_read_b64_tr_b16 a[238:239], v241 offset:17456
v_fma_f32 v201, v201, s27, -v248
v_mfma_f32_16x16x32_bf16 v[144:147], v[232:235], a[208:211], v[144:147]
v_exp_f32 v200, v200
v_mfma_f32_16x16x32_bf16 a[144:147], v[236:239], a[208:211], a[144:147]
s_waitcnt lgkmcnt(12)
ds_read_b64_tr_b16 a[240:241], v241 offset:16960
v_fma_f32 v202, v202, s27, -v248
v_mfma_f32_16x16x32_bf16 a[148:151], v[236:239], a[212:215], a[148:151]
v_fma_f32 v203, v203, s27, -v248
v_mfma_f32_16x16x32_bf16 v[148:151], v[232:235], a[212:215], v[148:151]
v_exp_f32 v201, v201
v_mfma_f32_16x16x32_bf16 v[84:87], v[228:231], a[212:215], v[84:87]
ds_read_b64_tr_b16 a[242:243], v241 offset:17472
v_mfma_f32_16x16x32_bf16 v[20:23], v[224:227], a[212:215], v[20:23]
s_waitcnt lgkmcnt(12)
ds_read_b64_tr_b16 a[244:245], v241 offset:16976
v_add_f32 v252, v252, v200
v_mfma_f32_16x16x32_bf16 v[24:27], v[224:227], a[216:219], v[24:27]
v_exp_f32 v202, v202
v_mfma_f32_16x16x32_bf16 v[88:91], v[228:231], a[216:219], v[88:91]
ds_read_b64_tr_b16 a[246:247], v241 offset:17488
v_add_f32 v252, v252, v201
v_mfma_f32_16x16x32_bf16 v[152:155], v[232:235], a[216:219], v[152:155]
v_cvt_pk_bf16_f32 v200, v200, v201
v_mfma_f32_16x16x32_bf16 a[152:155], v[236:239], a[216:219], a[152:155]
s_waitcnt lgkmcnt(12)
ds_read_b64_tr_b16 a[248:249], v241 offset:16992
v_mfma_f32_16x16x32_bf16 a[156:159], v[236:239], a[220:223], a[156:159]
v_exp_f32 v203, v203
v_mfma_f32_16x16x32_bf16 v[156:159], v[232:235], a[220:223], v[156:159]
ds_read_b64_tr_b16 a[250:251], v241 offset:17504
v_add_f32 v252, v252, v202
v_mfma_f32_16x16x32_bf16 v[92:95], v[228:231], a[220:223], v[92:95]
v_add_f32 v252, v252, v203
v_cvt_pk_bf16_f32 v201, v202, v203
v_mfma_f32_16x16x32_bf16 v[28:31], v[224:227], a[220:223], v[28:31]
s_waitcnt lgkmcnt(12)
ds_read_b64_tr_b16 a[252:253], v241 offset:17008
v_fma_f32 v208, v208, s27, -v246
v_mfma_f32_16x16x32_bf16 v[32:35], v[224:227], a[224:227], v[32:35]
ds_read_b64_tr_b16 a[254:255], v241 offset:17520
v_fma_f32 v209, v209, s27, -v246
v_mfma_f32_16x16x32_bf16 v[96:99], v[228:231], a[224:227], v[96:99]
v_exp_f32 v208, v208
v_mfma_f32_16x16x32_bf16 v[160:163], v[232:235], a[224:227], v[160:163]
v_fma_f32 v210, v210, s27, -v246
v_fma_f32 v211, v211, s27, -v246
v_mfma_f32_16x16x32_bf16 a[160:163], v[236:239], a[224:227], a[160:163]
s_waitcnt lgkmcnt(12)
v_exp_f32 v209, v209
v_mfma_f32_16x16x32_bf16 a[164:167], v[236:239], a[228:231], a[164:167]
v_add_f32 v250, v250, v208
v_mfma_f32_16x16x32_bf16 v[164:167], v[232:235], a[228:231], v[164:167]
v_exp_f32 v210, v210
v_mfma_f32_16x16x32_bf16 v[100:103], v[228:231], a[228:231], v[100:103]
v_add_f32 v250, v250, v209
v_mfma_f32_16x16x32_bf16 v[36:39], v[224:227], a[228:231], v[36:39]
s_waitcnt lgkmcnt(10)
v_cvt_pk_bf16_f32 v194, v208, v209
v_mfma_f32_16x16x32_bf16 v[40:43], v[224:227], a[232:235], v[40:43]
v_exp_f32 v211, v211
v_mfma_f32_16x16x32_bf16 v[104:107], v[228:231], a[232:235], v[104:107]
s_waitcnt vmcnt(10) lgkmcnt(0)
v_add_f32 v250, v250, v210
v_add_f32 v250, v250, v211
v_mfma_f32_16x16x32_bf16 v[168:171], v[232:235], a[232:235], v[168:171]
s_barrier
v_mfma_f32_16x16x32_bf16 a[168:171], v[236:239], a[232:235], a[168:171]
s_add_u32 m0, s3, 53504
ds_read_b128 v[204:207], v242 offset:29696
ds_read_b128 a[192:195], v240 offset:16896
v_mfma_f32_16x16x32_bf16 a[172:175], v[236:239], a[236:239], a[172:175]
buffer_load_dwordx4 v242, s[16:19], s30 offen offset:0 lds
v_mfma_f32_16x16x32_bf16 v[172:175], v[232:235], a[236:239], v[172:175]
ds_read_b128 a[196:199], v240 offset:16960
ds_read_b128 a[200:203], v240 offset:17024
v_mfma_f32_16x16x32_bf16 v[108:111], v[228:231], a[236:239], v[108:111]
v_cvt_pk_bf16_f32 v195, v210, v211
v_fma_f32 v212, v212, s27, -v247
v_mfma_f32_16x16x32_bf16 v[44:47], v[224:227], a[236:239], v[44:47]
s_add_u32 m0, s3, 53520
ds_read_b128 a[204:207], v240 offset:17088
v_fma_f32 v213, v213, s27, -v247
v_mfma_f32_16x16x32_bf16 v[48:51], v[224:227], a[240:243], v[48:51]
buffer_load_dwordx4 v242, s[16:19], s30 offen offset:1024 lds
v_mfma_f32_16x16x32_bf16 v[112:115], v[228:231], a[240:243], v[112:115]
v_exp_f32 v212, v212
v_mfma_f32_16x16x32_bf16 v[176:179], v[232:235], a[240:243], v[176:179]
ds_read_b128 a[208:211], v240 offset:17152
v_fma_f32 v214, v214, s27, -v247
v_mfma_f32_16x16x32_bf16 a[176:179], v[236:239], a[240:243], a[176:179]
ds_read_b128 a[212:215], v240 offset:17216
v_fma_f32 v215, v215, s27, -v247
v_mfma_f32_16x16x32_bf16 a[180:183], v[236:239], a[244:247], a[180:183]
s_add_u32 m0, s3, 53536
v_exp_f32 v213, v213
v_mfma_f32_16x16x32_bf16 v[180:183], v[232:235], a[244:247], v[180:183]
buffer_load_dwordx4 v242, s[16:19], s30 offen offset:2048 lds
v_mfma_f32_16x16x32_bf16 v[116:119], v[228:231], a[244:247], v[116:119]
ds_read_b128 a[216:219], v240 offset:17280
v_add_f32 v251, v251, v212
v_mfma_f32_16x16x32_bf16 v[52:55], v[224:227], a[244:247], v[52:55]
ds_read_b128 a[220:223], v240 offset:17344
v_mfma_f32_16x16x32_bf16 v[56:59], v[224:227], a[248:251], v[56:59]
v_exp_f32 v214, v214
v_mfma_f32_16x16x32_bf16 v[120:123], v[228:231], a[248:251], v[120:123]
s_add_u32 m0, s3, 53552
v_add_f32 v251, v251, v213
v_mfma_f32_16x16x32_bf16 v[184:187], v[232:235], a[248:251], v[184:187]
buffer_load_dwordx4 v242, s[16:19], s30 offen offset:3072 lds
v_mfma_f32_16x16x32_bf16 a[184:187], v[236:239], a[248:251], a[184:187]
s_add_u32 s30, s30, 16384
v_cvt_pk_bf16_f32 v198, v212, v213
v_mfma_f32_16x16x32_bf16 a[188:191], v[236:239], a[252:255], a[188:191]
v_exp_f32 v215, v215
v_mfma_f32_16x16x32_bf16 v[188:191], v[232:235], a[252:255], v[188:191]
v_add_f32 v251, v251, v214
v_add_f32 v251, v251, v215
v_mfma_f32_16x16x32_bf16 v[124:127], v[228:231], a[252:255], v[124:127]
v_cvt_pk_bf16_f32 v199, v214, v215
v_mfma_f32_16x16x32_bf16 v[60:63], v[224:227], a[252:255], v[60:63]
s_waitcnt lgkmcnt(7)
v_mfma_f32_16x16x32_bf16 v[224:227], a[192:195], a[0:3], 0
s_waitcnt lgkmcnt(6)
ds_read_b128 a[224:227], v240 offset:17408
v_fma_f32 v216, v216, s27, -v248
v_mfma_f32_16x16x32_bf16 v[224:227], a[196:199], a[4:7], v[224:227]
s_waitcnt lgkmcnt(6)
ds_read_b128 a[228:231], v240 offset:17472
v_fma_f32 v217, v217, s27, -v248
v_mfma_f32_16x16x32_bf16 v[224:227], a[200:203], a[8:11], v[224:227]
s_waitcnt lgkmcnt(6)
v_exp_f32 v216, v216
v_mfma_f32_16x16x32_bf16 v[224:227], a[204:207], a[12:15], v[224:227]
s_waitcnt lgkmcnt(5)
ds_read_b128 a[232:235], v240 offset:17536
v_fma_f32 v218, v218, s27, -v248
v_mfma_f32_16x16x32_bf16 v[224:227], a[208:211], a[16:19], v[224:227]
s_waitcnt lgkmcnt(5)
ds_read_b128 a[236:239], v240 offset:17600
v_fma_f32 v219, v219, s27, -v248
v_mfma_f32_16x16x32_bf16 v[224:227], a[212:215], a[20:23], v[224:227]
s_waitcnt lgkmcnt(5)
v_exp_f32 v217, v217
v_mfma_f32_16x16x32_bf16 v[224:227], a[216:219], a[24:27], v[224:227]
s_waitcnt lgkmcnt(4)
ds_read_b128 a[240:243], v240 offset:17664
v_add_f32 v252, v252, v216
v_mfma_f32_16x16x32_bf16 v[224:227], a[220:223], a[28:31], v[224:227]
v_exp_f32 v218, v218
v_mfma_f32_16x16x32_bf16 v[228:231], a[220:223], a[60:63], 0
ds_read_b128 a[244:247], v240 offset:17728
v_add_f32 v252, v252, v217
v_mfma_f32_16x16x32_bf16 v[228:231], a[216:219], a[56:59], v[228:231]
ds_read_b128 a[248:251], v240 offset:17792
v_cvt_pk_bf16_f32 v202, v216, v217
v_mfma_f32_16x16x32_bf16 v[228:231], a[212:215], a[52:55], v[228:231]
v_exp_f32 v219, v219
v_mfma_f32_16x16x32_bf16 v[228:231], a[208:211], a[48:51], v[228:231]
v_add_f32 v252, v252, v218
v_add_f32 v252, v252, v219
v_mfma_f32_16x16x32_bf16 v[228:231], a[204:207], a[44:47], v[228:231]
ds_read_b128 a[252:255], v240 offset:17856
v_cvt_pk_bf16_f32 v203, v218, v219
v_mfma_f32_16x16x32_bf16 v[228:231], a[200:203], a[40:43], v[228:231]
v_fma_f32 v224, v224, s27, -v246
v_fma_f32 v225, v225, s27, -v246
v_mfma_f32_16x16x32_bf16 v[228:231], a[196:199], a[36:39], v[228:231]
v_exp_f32 v224, v224
v_mfma_f32_16x16x32_bf16 v[228:231], a[192:195], a[32:35], v[228:231]
v_fma_f32 v226, v226, s27, -v246
v_fma_f32 v227, v227, s27, -v246
v_mfma_f32_16x16x32_bf16 v[232:235], a[192:195], a[64:67], 0
v_exp_f32 v225, v225
v_mfma_f32_16x16x32_bf16 v[232:235], a[196:199], a[68:71], v[232:235]
v_add_f32 v250, v250, v224
v_mfma_f32_16x16x32_bf16 v[232:235], a[200:203], a[72:75], v[232:235]
v_exp_f32 v226, v226
v_mfma_f32_16x16x32_bf16 v[232:235], a[204:207], a[76:79], v[232:235]
v_add_f32 v250, v250, v225
v_cvt_pk_bf16_f32 v224, v224, v225
v_mfma_f32_16x16x32_bf16 v[232:235], a[208:211], a[80:83], v[232:235]
v_exp_f32 v227, v227
v_mfma_f32_16x16x32_bf16 v[232:235], a[212:215], a[84:87], v[232:235]
v_add_f32 v250, v250, v226
v_add_f32 v250, v250, v227
v_mfma_f32_16x16x32_bf16 v[232:235], a[216:219], a[88:91], v[232:235]
s_waitcnt vmcnt(10) lgkmcnt(0)
v_cvt_pk_bf16_f32 v225, v226, v227
v_fma_f32 v228, v228, s27, -v247
v_mfma_f32_16x16x32_bf16 v[232:235], a[220:223], a[92:95], v[232:235]
s_barrier
v_mfma_f32_16x16x32_bf16 v[208:211], a[224:227], a[0:3], 0
s_add_u32 m0, s26, 16896
ds_read_b64_tr_b16 a[192:193], v241 offset:0
v_fma_f32 v229, v229, s27, -v247
v_mfma_f32_16x16x32_bf16 v[208:211], a[228:231], a[4:7], v[208:211]
buffer_load_dwordx4 v242, s[12:15], s29 offen offset:0 lds
v_mfma_f32_16x16x32_bf16 v[208:211], a[232:235], a[8:11], v[208:211]
v_exp_f32 v228, v228
v_mfma_f32_16x16x32_bf16 v[208:211], a[236:239], a[12:15], v[208:211]
ds_read_b64_tr_b16 a[194:195], v241 offset:512
v_fma_f32 v230, v230, s27, -v247
v_mfma_f32_16x16x32_bf16 v[208:211], a[240:243], a[16:19], v[208:211]
s_add_u32 m0, s26, 16928
ds_read_b64_tr_b16 a[196:197], v241 offset:16
v_mfma_f32_16x16x32_bf16 v[208:211], a[244:247], a[20:23], v[208:211]
buffer_load_dwordx4 v242, s[12:15], s29 offen offset:1024 lds
v_mfma_f32_16x16x32_bf16 v[208:211], a[248:251], a[24:27], v[208:211]
ds_read_b64_tr_b16 a[198:199], v241 offset:528
v_fma_f32 v231, v231, s27, -v247
v_mfma_f32_16x16x32_bf16 v[208:211], a[252:255], a[28:31], v[208:211]
v_exp_f32 v229, v229
v_mfma_f32_16x16x32_bf16 v[212:215], a[252:255], a[60:63], 0
s_waitcnt vmcnt(10)
s_add_u32 m0, s26, 16960
ds_read_b128 a[0:3], v255 offset:0
v_mfma_f32_16x16x32_bf16 v[212:215], a[248:251], a[56:59], v[212:215]
buffer_load_dwordx4 v242, s[12:15], s29 offen offset:2048 lds
v_mfma_f32_16x16x32_bf16 v[212:215], a[244:247], a[52:55], v[212:215]
ds_read_b128 a[4:7], v255 offset:64
ds_read_b64_tr_b16 a[200:201], v241 offset:32
v_mfma_f32_16x16x32_bf16 v[212:215], a[240:243], a[48:51], v[212:215]
ds_read_b128 a[8:11], v255 offset:128
ds_read_b64_tr_b16 a[202:203], v241 offset:544
v_mfma_f32_16x16x32_bf16 v[212:215], a[236:239], a[44:47], v[212:215]
s_add_u32 m0, s26, 16992
ds_read_b128 a[12:15], v255 offset:192
ds_read_b128 a[16:19], v255 offset:256
v_mfma_f32_16x16x32_bf16 v[212:215], a[232:235], a[40:43], v[212:215]
buffer_load_dwordx4 v242, s[12:15], s29 offen offset:3072 lds
v_mfma_f32_16x16x32_bf16 v[212:215], a[228:231], a[36:39], v[212:215]
s_add_u32 s29, s29, 16384
ds_read_b128 a[20:23], v255 offset:320
ds_read_b64_tr_b16 a[204:205], v241 offset:48
v_mfma_f32_16x16x32_bf16 v[212:215], a[224:227], a[32:35], v[212:215]
ds_read_b128 a[24:27], v255 offset:384
ds_read_b64_tr_b16 a[206:207], v241 offset:560
v_mfma_f32_16x16x32_bf16 v[216:219], a[224:227], a[64:67], 0
ds_read_b128 a[28:31], v255 offset:448
ds_read_b64_tr_b16 a[208:209], v241 offset:64
v_mfma_f32_16x16x32_bf16 v[216:219], a[228:231], a[68:71], v[216:219]
ds_read_b64_tr_b16 a[210:211], v241 offset:576
v_add_f32 v251, v251, v228
v_mfma_f32_16x16x32_bf16 v[216:219], a[232:235], a[72:75], v[216:219]
v_exp_f32 v230, v230
v_mfma_f32_16x16x32_bf16 v[216:219], a[236:239], a[76:79], v[216:219]
v_add_f32 v251, v251, v229
v_cvt_pk_bf16_f32 v228, v228, v229
v_mfma_f32_16x16x32_bf16 v[216:219], a[240:243], a[80:83], v[216:219]
ds_read_b64_tr_b16 a[212:213], v241 offset:80
v_mfma_f32_16x16x32_bf16 v[216:219], a[244:247], a[84:87], v[216:219]
v_exp_f32 v231, v231
v_mfma_f32_16x16x32_bf16 v[216:219], a[248:251], a[88:91], v[216:219]
ds_read_b64_tr_b16 a[214:215], v241 offset:592
v_add_f32 v251, v251, v230
v_mfma_f32_16x16x32_bf16 v[216:219], a[252:255], a[92:95], v[216:219]
s_waitcnt lgkmcnt(15)
v_add_f32 v251, v251, v231
v_cvt_pk_bf16_f32 v229, v230, v231
v_mfma_f32_16x16x32_bf16 v[0:3], v[192:195], a[192:195], v[0:3]
ds_read_b64_tr_b16 a[216:217], v241 offset:96
v_fma_f32 v232, v232, s27, -v248
v_mfma_f32_16x16x32_bf16 v[64:67], v[196:199], a[192:195], v[64:67]
ds_read_b64_tr_b16 a[218:219], v241 offset:608
v_fma_f32 v233, v233, s27, -v248
v_mfma_f32_16x16x32_bf16 v[128:131], v[200:203], a[192:195], v[128:131]
v_exp_f32 v232, v232
v_mfma_f32_16x16x32_bf16 a[128:131], v[204:207], a[192:195], a[128:131]
s_waitcnt lgkmcnt(15)
v_fma_f32 v234, v234, s27, -v248
v_fma_f32 v235, v235, s27, -v248
v_mfma_f32_16x16x32_bf16 a[132:135], v[204:207], a[196:199], a[132:135]
s_add_u32 s38, s36, 16384
ds_read_b64_tr_b16 a[220:221], v241 offset:112
v_mfma_f32_16x16x32_bf16 v[132:135], v[200:203], a[196:199], v[132:135]
s_add_u32 m0, s4, 0
v_exp_f32 v233, v233
v_mfma_f32_16x16x32_bf16 v[68:71], v[196:199], a[196:199], v[68:71]
s_waitcnt lgkmcnt(7)
buffer_load_dwordx4 v243, s[8:11], s38 offen offset:0 nt lds
v_mfma_f32_16x16x32_bf16 v[4:7], v[192:195], a[196:199], v[4:7]
ds_read_b64_tr_b16 a[222:223], v241 offset:624
v_add_f32 v252, v252, v232
v_mfma_f32_16x16x32_bf16 v[8:11], v[192:195], a[200:203], v[8:11]
v_exp_f32 v234, v234
v_mfma_f32_16x16x32_bf16 v[72:75], v[196:199], a[200:203], v[72:75]
s_add_u32 m0, s4, 544
ds_read_b64_tr_b16 a[224:225], v241 offset:256
v_add_f32 v252, v252, v233
v_mfma_f32_16x16x32_bf16 v[136:139], v[200:203], a[200:203], v[136:139]
buffer_load_dwordx4 v243, s[8:11], s38 offen offset:512 nt lds
v_mfma_f32_16x16x32_bf16 a[136:139], v[204:207], a[200:203], a[136:139]
ds_read_b64_tr_b16 a[226:227], v241 offset:768
v_cvt_pk_bf16_f32 v232, v232, v233
v_mfma_f32_16x16x32_bf16 a[140:143], v[204:207], a[204:207], a[140:143]
v_exp_f32 v235, v235
v_mfma_f32_16x16x32_bf16 v[140:143], v[200:203], a[204:207], v[140:143]
ds_read_b64_tr_b16 a[228:229], v241 offset:272
v_add_f32 v252, v252, v234
v_mfma_f32_16x16x32_bf16 v[76:79], v[196:199], a[204:207], v[76:79]
s_add_u32 m0, s4, 1088
ds_read_b64_tr_b16 a[230:231], v241 offset:784
v_mfma_f32_16x16x32_bf16 v[12:15], v[192:195], a[204:207], v[12:15]
s_waitcnt lgkmcnt(10)
buffer_load_dwordx4 v243, s[8:11], s38 offen offset:1024 nt lds
v_mfma_f32_16x16x32_bf16 v[16:19], v[192:195], a[208:211], v[16:19]
ds_read_b64_tr_b16 a[232:233], v241 offset:288
v_add_f32 v252, v252, v235
v_mfma_f32_16x16x32_bf16 v[80:83], v[196:199], a[208:211], v[80:83]
v_cvt_pk_bf16_f32 v233, v234, v235
v_fma_f32 v208, v208, s27, -v246
v_mfma_f32_16x16x32_bf16 v[144:147], v[200:203], a[208:211], v[144:147]
ds_read_b64_tr_b16 a[234:235], v241 offset:800
v_fma_f32 v209, v209, s27, -v246
v_mfma_f32_16x16x32_bf16 a[144:147], v[204:207], a[208:211], a[144:147]
s_waitcnt lgkmcnt(10)
v_exp_f32 v208, v208
v_mfma_f32_16x16x32_bf16 a[148:151], v[204:207], a[212:215], a[148:151]
s_add_u32 m0, s4, 1632
ds_read_b64_tr_b16 a[236:237], v241 offset:304
v_fma_f32 v210, v210, s27, -v246
v_mfma_f32_16x16x32_bf16 v[148:151], v[200:203], a[212:215], v[148:151]
buffer_load_dwordx4 v243, s[8:11], s38 offen offset:1536 nt lds
v_mfma_f32_16x16x32_bf16 v[84:87], v[196:199], a[212:215], v[84:87]
ds_read_b64_tr_b16 a[238:239], v241 offset:816
v_fma_f32 v211, v211, s27, -v246
v_mfma_f32_16x16x32_bf16 v[20:23], v[192:195], a[212:215], v[20:23]
s_waitcnt lgkmcnt(10)
v_exp_f32 v209, v209
v_mfma_f32_16x16x32_bf16 v[24:27], v[192:195], a[216:219], v[24:27]
ds_read_b64_tr_b16 a[240:241], v241 offset:320
v_add_f32 v250, v250, v208
v_mfma_f32_16x16x32_bf16 v[88:91], v[196:199], a[216:219], v[88:91]
s_add_u32 m0, s4, 2176
v_exp_f32 v210, v210
v_mfma_f32_16x16x32_bf16 v[152:155], v[200:203], a[216:219], v[152:155]
buffer_load_dwordx4 v243, s[8:11], s38 offen offset:2048 nt lds
v_mfma_f32_16x16x32_bf16 a[152:155], v[204:207], a[216:219], a[152:155]
s_waitcnt lgkmcnt(9)
ds_read_b64_tr_b16 a[242:243], v241 offset:832
v_add_f32 v250, v250, v209
v_mfma_f32_16x16x32_bf16 a[156:159], v[204:207], a[220:223], a[156:159]
ds_read_b64_tr_b16 a[244:245], v241 offset:336
v_cvt_pk_bf16_f32 v226, v208, v209
v_mfma_f32_16x16x32_bf16 v[156:159], v[200:203], a[220:223], v[156:159]
s_add_u32 m0, s4, 2720
v_exp_f32 v211, v211
v_mfma_f32_16x16x32_bf16 v[92:95], v[196:199], a[220:223], v[92:95]
buffer_load_dwordx4 v243, s[8:11], s38 offen offset:2560 nt lds
v_mfma_f32_16x16x32_bf16 v[28:31], v[192:195], a[220:223], v[28:31]
s_waitcnt lgkmcnt(9)
ds_read_b64_tr_b16 a[246:247], v241 offset:848
v_add_f32 v250, v250, v210
v_mfma_f32_16x16x32_bf16 v[32:35], v[192:195], a[224:227], v[32:35]
ds_read_b64_tr_b16 a[248:249], v241 offset:352
v_add_f32 v250, v250, v211
v_mfma_f32_16x16x32_bf16 v[96:99], v[196:199], a[224:227], v[96:99]
v_cvt_pk_bf16_f32 v227, v210, v211
v_mfma_f32_16x16x32_bf16 v[160:163], v[200:203], a[224:227], v[160:163]
s_add_u32 m0, s4, 3264
ds_read_b64_tr_b16 a[250:251], v241 offset:864
v_mfma_f32_16x16x32_bf16 a[160:163], v[204:207], a[224:227], a[160:163]
s_waitcnt lgkmcnt(10)
buffer_load_dwordx4 v243, s[8:11], s38 offen offset:3072 nt lds
v_mfma_f32_16x16x32_bf16 a[164:167], v[204:207], a[228:231], a[164:167]
ds_read_b64_tr_b16 a[252:253], v241 offset:368
v_fma_f32 v212, v212, s27, -v247
v_mfma_f32_16x16x32_bf16 v[164:167], v[200:203], a[228:231], v[164:167]
v_fma_f32 v213, v213, s27, -v247
v_mfma_f32_16x16x32_bf16 v[100:103], v[196:199], a[228:231], v[100:103]
v_exp_f32 v212, v212
v_mfma_f32_16x16x32_bf16 v[36:39], v[192:195], a[228:231], v[36:39]
s_waitcnt lgkmcnt(9)
ds_read_b64_tr_b16 a[254:255], v241 offset:880
v_fma_f32 v214, v214, s27, -v247
v_mfma_f32_16x16x32_bf16 v[40:43], v[192:195], a[232:235], v[40:43]
s_add_u32 m0, s4, 3808
v_fma_f32 v215, v215, s27, -v247
v_mfma_f32_16x16x32_bf16 v[104:107], v[196:199], a[232:235], v[104:107]
buffer_load_dwordx4 v243, s[8:11], s38 offen offset:3584 nt lds
v_mfma_f32_16x16x32_bf16 v[168:171], v[200:203], a[232:235], v[168:171]
v_exp_f32 v213, v213
v_mfma_f32_16x16x32_bf16 a[168:171], v[204:207], a[232:235], a[168:171]
s_waitcnt lgkmcnt(8)
v_add_f32 v251, v251, v212
v_add_f32 v251, v251, v213
v_mfma_f32_16x16x32_bf16 a[172:175], v[204:207], a[236:239], a[172:175]
v_exp_f32 v214, v214
v_mfma_f32_16x16x32_bf16 v[172:175], v[200:203], a[236:239], v[172:175]
v_cvt_pk_bf16_f32 v230, v212, v213
v_add_f32 v251, v251, v214
v_mfma_f32_16x16x32_bf16 v[108:111], v[196:199], a[236:239], v[108:111]
v_exp_f32 v215, v215
v_mfma_f32_16x16x32_bf16 v[44:47], v[192:195], a[236:239], v[44:47]
s_waitcnt vmcnt(12) lgkmcnt(0)
v_add_f32 v251, v251, v215
v_cvt_pk_bf16_f32 v231, v214, v215
v_mfma_f32_16x16x32_bf16 v[48:51], v[192:195], a[240:243], v[48:51]
s_barrier
v_mfma_f32_16x16x32_bf16 v[112:115], v[196:199], a[240:243], v[112:115]
ds_read_b128 v[236:239], v242 offset:30720
ds_read_b32 v253, v242 offset:31744
v_mfma_f32_16x16x32_bf16 v[176:179], v[200:203], a[240:243], v[176:179]
ds_read_b64_tr_b16 a[192:193], v241 offset:16640
ds_read_b64_tr_b16 a[194:195], v241 offset:17152
v_mfma_f32_16x16x32_bf16 a[176:179], v[204:207], a[240:243], a[176:179]
v_fma_f32 v216, v216, s27, -v248
v_fma_f32 v217, v217, s27, -v248
v_mfma_f32_16x16x32_bf16 a[180:183], v[204:207], a[244:247], a[180:183]
ds_read_b64_tr_b16 a[196:197], v241 offset:16656
ds_read_b64_tr_b16 a[198:199], v241 offset:17168
v_mfma_f32_16x16x32_bf16 v[180:183], v[200:203], a[244:247], v[180:183]
ds_read_b64_tr_b16 a[200:201], v241 offset:16672
ds_read_b64_tr_b16 a[202:203], v241 offset:17184
v_mfma_f32_16x16x32_bf16 v[116:119], v[196:199], a[244:247], v[116:119]
ds_read_b64_tr_b16 a[204:205], v241 offset:16688
ds_read_b64_tr_b16 a[206:207], v241 offset:17200
v_mfma_f32_16x16x32_bf16 v[52:55], v[192:195], a[244:247], v[52:55]
v_exp_f32 v216, v216
v_mfma_f32_16x16x32_bf16 v[56:59], v[192:195], a[248:251], v[56:59]
v_fma_f32 v218, v218, s27, -v248
v_fma_f32 v219, v219, s27, -v248
v_mfma_f32_16x16x32_bf16 v[120:123], v[196:199], a[248:251], v[120:123]
v_exp_f32 v217, v217
v_mfma_f32_16x16x32_bf16 v[184:187], v[200:203], a[248:251], v[184:187]
v_add_f32 v252, v252, v216
v_add_f32 v252, v252, v217
v_mfma_f32_16x16x32_bf16 a[184:187], v[204:207], a[248:251], a[184:187]
v_exp_f32 v218, v218
v_mfma_f32_16x16x32_bf16 a[188:191], v[204:207], a[252:255], a[188:191]
v_cvt_pk_bf16_f32 v234, v216, v217
v_add_f32 v252, v252, v218
v_mfma_f32_16x16x32_bf16 v[188:191], v[200:203], a[252:255], v[188:191]
v_exp_f32 v219, v219
v_mfma_f32_16x16x32_bf16 v[124:127], v[196:199], a[252:255], v[124:127]
v_add_f32 v252, v252, v219
v_cvt_pk_bf16_f32 v235, v218, v219
v_mfma_f32_16x16x32_bf16 v[60:63], v[192:195], a[252:255], v[60:63]
s_branch L_last4
L_fin4:
s_waitcnt lgkmcnt(0)
s_nop 6
ds_write_b64 v245, v[0:1] offset:0
ds_write_b64 v245, v[2:3] offset:288
v_pk_mul_f32 v[16:17], v[16:17], v[208:209]
v_pk_mul_f32 v[18:19], v[18:19], v[210:211]
v_pk_mul_f32 v[20:21], v[20:21], v[208:209]
v_pk_mul_f32 v[22:23], v[22:23], v[210:211]
ds_write_b64 v245, v[4:5] offset:576
v_pk_mul_f32 v[24:25], v[24:25], v[208:209]
v_pk_mul_f32 v[26:27], v[26:27], v[210:211]
v_pk_mul_f32 v[28:29], v[28:29], v[208:209]
v_pk_mul_f32 v[30:31], v[30:31], v[210:211]
ds_write_b64 v245, v[6:7] offset:864
v_cvt_pk_bf16_f32 v16, v16, v20
v_cvt_pk_bf16_f32 v20, v18, v22
v_cvt_pk_bf16_f32 v18, v17, v21
v_cvt_pk_bf16_f32 v22, v19, v23
v_cvt_pk_bf16_f32 v17, v24, v28
v_cvt_pk_bf16_f32 v19, v25, v29
v_cvt_pk_bf16_f32 v21, v26, v30
v_cvt_pk_bf16_f32 v23, v27, v31
ds_write_b64 v245, v[16:17] offset:128
v_pk_mul_f32 v[64:65], v[64:65], v[212:213]
v_pk_mul_f32 v[66:67], v[66:67], v[214:215]
ds_write_b64 v245, v[18:19] offset:416
v_pk_mul_f32 v[68:69], v[68:69], v[212:213]
v_pk_mul_f32 v[70:71], v[70:71], v[214:215]
v_pk_mul_f32 v[72:73], v[72:73], v[212:213]
v_pk_mul_f32 v[74:75], v[74:75], v[214:215]
v_pk_mul_f32 v[76:77], v[76:77], v[212:213]
ds_write_b64 v245, v[20:21] offset:704
v_pk_mul_f32 v[78:79], v[78:79], v[214:215]
v_cvt_pk_bf16_f32 v64, v64, v68
v_cvt_pk_bf16_f32 v68, v66, v70
v_cvt_pk_bf16_f32 v66, v65, v69
ds_write_b64 v245, v[22:23] offset:992
v_cvt_pk_bf16_f32 v70, v67, v71
v_cvt_pk_bf16_f32 v65, v72, v76
v_cvt_pk_bf16_f32 v67, v73, v77
v_cvt_pk_bf16_f32 v69, v74, v78
v_cvt_pk_bf16_f32 v71, v75, v79
ds_read_b64_tr_b16 v[0:1], v254 offset:0
ds_read_b64_tr_b16 v[2:3], v254 offset:32
ds_read_b64_tr_b16 v[4:5], v254 offset:1152
v_pk_mul_f32 v[80:81], v[80:81], v[212:213]
ds_read_b64_tr_b16 v[6:7], v254 offset:1184
ds_read_b64_tr_b16 v[8:9], v254 offset:2304
ds_read_b64_tr_b16 v[10:11], v254 offset:2336
v_pk_mul_f32 v[82:83], v[82:83], v[214:215]
ds_read_b64_tr_b16 v[12:13], v254 offset:3456
ds_read_b64_tr_b16 v[14:15], v254 offset:3488
ds_write_b64 v245, v[64:65] offset:0
v_pk_mul_f32 v[84:85], v[84:85], v[212:213]
v_pk_mul_f32 v[86:87], v[86:87], v[214:215]
v_pk_mul_f32 v[88:89], v[88:89], v[212:213]
v_pk_mul_f32 v[90:91], v[90:91], v[214:215]
v_pk_mul_f32 v[92:93], v[92:93], v[212:213]
v_pk_mul_f32 v[94:95], v[94:95], v[214:215]
ds_write_b64 v245, v[66:67] offset:288
s_waitcnt lgkmcnt(8)
buffer_store_dwordx4 v[0:3], v244, s[20:23], s92 offen offset:0 nt
v_cvt_pk_bf16_f32 v80, v80, v84
v_cvt_pk_bf16_f32 v84, v82, v86
ds_write_b64 v245, v[68:69] offset:576
v_cvt_pk_bf16_f32 v82, v81, v85
v_cvt_pk_bf16_f32 v86, v83, v87
v_cvt_pk_bf16_f32 v81, v88, v92
s_waitcnt lgkmcnt(7)
buffer_store_dwordx4 v[4:7], v244, s[20:23], s92 offen offset:2048 nt
ds_write_b64 v245, v[70:71] offset:864
v_cvt_pk_bf16_f32 v83, v89, v93
v_cvt_pk_bf16_f32 v85, v90, v94
v_cvt_pk_bf16_f32 v87, v91, v95
v_pk_mul_f32 v[128:129], v[128:129], v[216:217]
ds_write_b64 v245, v[80:81] offset:128
s_waitcnt lgkmcnt(7)
buffer_store_dwordx4 v[8:11], v244, s[20:23], s93 offen offset:0 nt
v_pk_mul_f32 v[130:131], v[130:131], v[218:219]
v_pk_mul_f32 v[132:133], v[132:133], v[216:217]
v_pk_mul_f32 v[134:135], v[134:135], v[218:219]
ds_write_b64 v245, v[82:83] offset:416
v_pk_mul_f32 v[136:137], v[136:137], v[216:217]
v_pk_mul_f32 v[138:139], v[138:139], v[218:219]
v_pk_mul_f32 v[140:141], v[140:141], v[216:217]
v_pk_mul_f32 v[142:143], v[142:143], v[218:219]
s_waitcnt lgkmcnt(6)
buffer_store_dwordx4 v[12:15], v244, s[20:23], s93 offen offset:2048 nt
ds_write_b64 v245, v[84:85] offset:704
v_cvt_pk_bf16_f32 v128, v128, v132
v_cvt_pk_bf16_f32 v132, v130, v134
v_cvt_pk_bf16_f32 v130, v129, v133
ds_write_b64 v245, v[86:87] offset:992
v_cvt_pk_bf16_f32 v134, v131, v135
v_cvt_pk_bf16_f32 v129, v136, v140
v_cvt_pk_bf16_f32 v131, v137, v141
v_cvt_pk_bf16_f32 v133, v138, v142
v_cvt_pk_bf16_f32 v135, v139, v143
ds_read_b64_tr_b16 v[64:65], v254 offset:0
ds_read_b64_tr_b16 v[66:67], v254 offset:32
ds_read_b64_tr_b16 v[68:69], v254 offset:1152
v_pk_mul_f32 v[144:145], v[144:145], v[216:217]
ds_read_b64_tr_b16 v[70:71], v254 offset:1184
ds_read_b64_tr_b16 v[72:73], v254 offset:2304
ds_read_b64_tr_b16 v[74:75], v254 offset:2336
ds_read_b64_tr_b16 v[76:77], v254 offset:3456
v_pk_mul_f32 v[146:147], v[146:147], v[218:219]
ds_read_b64_tr_b16 v[78:79], v254 offset:3488
ds_write_b64 v245, v[128:129] offset:0
v_pk_mul_f32 v[148:149], v[148:149], v[216:217]
v_pk_mul_f32 v[150:151], v[150:151], v[218:219]
v_pk_mul_f32 v[152:153], v[152:153], v[216:217]
v_pk_mul_f32 v[154:155], v[154:155], v[218:219]
v_pk_mul_f32 v[156:157], v[156:157], v[216:217]
ds_write_b64 v245, v[130:131] offset:288
s_waitcnt lgkmcnt(8)
buffer_store_dwordx4 v[64:67], v244, s[20:23], s94 offen offset:0 nt
v_pk_mul_f32 v[158:159], v[158:159], v[218:219]
v_cvt_pk_bf16_f32 v144, v144, v148
v_cvt_pk_bf16_f32 v148, v146, v150
ds_write_b64 v245, v[132:133] offset:576
v_cvt_pk_bf16_f32 v146, v145, v149
v_cvt_pk_bf16_f32 v150, v147, v151
s_waitcnt lgkmcnt(7)
buffer_store_dwordx4 v[68:71], v244, s[20:23], s94 offen offset:2048 nt
ds_write_b64 v245, v[134:135] offset:864
v_cvt_pk_bf16_f32 v145, v152, v156
v_cvt_pk_bf16_f32 v147, v153, v157
v_cvt_pk_bf16_f32 v149, v154, v158
v_cvt_pk_bf16_f32 v151, v155, v159
v_accvgpr_read_b32 v192, a128
ds_write_b64 v245, v[144:145] offset:128
s_waitcnt lgkmcnt(7)
buffer_store_dwordx4 v[72:75], v244, s[20:23], s95 offen offset:0 nt
v_accvgpr_read_b32 v193, a129
v_accvgpr_read_b32 v194, a130
v_accvgpr_read_b32 v195, a131
ds_write_b64 v245, v[146:147] offset:416
v_accvgpr_read_b32 v196, a132
v_accvgpr_read_b32 v197, a133
v_accvgpr_read_b32 v198, a134
s_waitcnt lgkmcnt(6)
buffer_store_dwordx4 v[76:79], v244, s[20:23], s95 offen offset:2048 nt
ds_write_b64 v245, v[148:149] offset:704
v_accvgpr_read_b32 v199, a135
v_accvgpr_read_b32 v200, a136
v_accvgpr_read_b32 v201, a137
v_accvgpr_read_b32 v202, a138
ds_write_b64 v245, v[150:151] offset:992
v_accvgpr_read_b32 v203, a139
v_accvgpr_read_b32 v204, a140
v_accvgpr_read_b32 v205, a141
v_accvgpr_read_b32 v206, a142
v_accvgpr_read_b32 v207, a143
ds_read_b64_tr_b16 v[128:129], v254 offset:0
ds_read_b64_tr_b16 v[130:131], v254 offset:32
ds_read_b64_tr_b16 v[132:133], v254 offset:1152
ds_read_b64_tr_b16 v[134:135], v254 offset:1184
v_pk_mul_f32 v[192:193], v[192:193], v[220:221]
ds_read_b64_tr_b16 v[136:137], v254 offset:2304
ds_read_b64_tr_b16 v[138:139], v254 offset:2336
ds_read_b64_tr_b16 v[140:141], v254 offset:3456
v_pk_mul_f32 v[194:195], v[194:195], v[222:223]
ds_read_b64_tr_b16 v[142:143], v254 offset:3488
v_pk_mul_f32 v[196:197], v[196:197], v[220:221]
v_pk_mul_f32 v[198:199], v[198:199], v[222:223]
v_pk_mul_f32 v[200:201], v[200:201], v[220:221]
v_pk_mul_f32 v[202:203], v[202:203], v[222:223]
v_pk_mul_f32 v[204:205], v[204:205], v[220:221]
v_pk_mul_f32 v[206:207], v[206:207], v[222:223]
v_cvt_pk_bf16_f32 v192, v192, v196
v_cvt_pk_bf16_f32 v196, v194, v198
v_cvt_pk_bf16_f32 v194, v193, v197
v_cvt_pk_bf16_f32 v198, v195, v199
s_waitcnt lgkmcnt(6)
buffer_store_dwordx4 v[128:131], v244, s[20:23], s96 offen offset:0 nt
v_cvt_pk_bf16_f32 v193, v200, v204
v_cvt_pk_bf16_f32 v195, v201, v205
v_cvt_pk_bf16_f32 v197, v202, v206
v_cvt_pk_bf16_f32 v199, v203, v207
ds_write_b64 v245, v[192:193] offset:0
ds_write_b64 v245, v[194:195] offset:288
s_waitcnt lgkmcnt(6)
buffer_store_dwordx4 v[132:135], v244, s[20:23], s96 offen offset:2048 nt
ds_write_b64 v245, v[196:197] offset:576
v_accvgpr_read_b32 v224, a144
v_accvgpr_read_b32 v225, a145
v_accvgpr_read_b32 v226, a146
v_accvgpr_read_b32 v227, a147
v_accvgpr_read_b32 v228, a148
v_accvgpr_read_b32 v229, a149
ds_write_b64 v245, v[198:199] offset:864
s_waitcnt lgkmcnt(6)
buffer_store_dwordx4 v[136:139], v244, s[20:23], s97 offen offset:0 nt
v_accvgpr_read_b32 v230, a150
v_accvgpr_read_b32 v231, a151
v_accvgpr_read_b32 v232, a152
v_accvgpr_read_b32 v233, a153
v_accvgpr_read_b32 v234, a154
v_accvgpr_read_b32 v235, a155
v_accvgpr_read_b32 v236, a156
v_accvgpr_read_b32 v237, a157
v_accvgpr_read_b32 v238, a158
s_waitcnt lgkmcnt(4)
buffer_store_dwordx4 v[140:143], v244, s[20:23], s97 offen offset:2048 nt
v_accvgpr_read_b32 v239, a159
v_pk_mul_f32 v[224:225], v[224:225], v[220:221]
v_pk_mul_f32 v[226:227], v[226:227], v[222:223]
v_pk_mul_f32 v[228:229], v[228:229], v[220:221]
v_pk_mul_f32 v[230:231], v[230:231], v[222:223]
v_pk_mul_f32 v[232:233], v[232:233], v[220:221]
v_pk_mul_f32 v[234:235], v[234:235], v[222:223]
v_pk_mul_f32 v[236:237], v[236:237], v[220:221]
v_pk_mul_f32 v[238:239], v[238:239], v[222:223]
v_cvt_pk_bf16_f32 v224, v224, v228
v_cvt_pk_bf16_f32 v228, v226, v230
v_cvt_pk_bf16_f32 v226, v225, v229
v_cvt_pk_bf16_f32 v230, v227, v231
v_cvt_pk_bf16_f32 v225, v232, v236
v_cvt_pk_bf16_f32 v227, v233, v237
v_cvt_pk_bf16_f32 v229, v234, v238
v_cvt_pk_bf16_f32 v231, v235, v239
ds_write_b64 v245, v[224:225] offset:128
ds_write_b64 v245, v[226:227] offset:416
v_pk_mul_f32 v[32:33], v[32:33], v[208:209]
v_pk_mul_f32 v[34:35], v[34:35], v[210:211]
ds_write_b64 v245, v[228:229] offset:704
v_pk_mul_f32 v[36:37], v[36:37], v[208:209]
v_pk_mul_f32 v[38:39], v[38:39], v[210:211]
v_pk_mul_f32 v[40:41], v[40:41], v[208:209]
v_pk_mul_f32 v[42:43], v[42:43], v[210:211]
v_pk_mul_f32 v[44:45], v[44:45], v[208:209]
ds_write_b64 v245, v[230:231] offset:992
v_pk_mul_f32 v[46:47], v[46:47], v[210:211]
v_cvt_pk_bf16_f32 v32, v32, v36
v_cvt_pk_bf16_f32 v36, v34, v38
v_cvt_pk_bf16_f32 v34, v33, v37
v_cvt_pk_bf16_f32 v38, v35, v39
ds_read_b64_tr_b16 a[128:129], v254 offset:0
ds_read_b64_tr_b16 a[130:131], v254 offset:32
ds_read_b64_tr_b16 a[132:133], v254 offset:1152
ds_read_b64_tr_b16 a[134:135], v254 offset:1184
v_cvt_pk_bf16_f32 v33, v40, v44
ds_read_b64_tr_b16 a[136:137], v254 offset:2304
ds_read_b64_tr_b16 a[138:139], v254 offset:2336
ds_read_b64_tr_b16 a[140:141], v254 offset:3456
v_cvt_pk_bf16_f32 v35, v41, v45
ds_read_b64_tr_b16 a[142:143], v254 offset:3488
ds_write_b64 v245, v[32:33] offset:0
v_cvt_pk_bf16_f32 v37, v42, v46
v_cvt_pk_bf16_f32 v39, v43, v47
v_pk_mul_f32 v[48:49], v[48:49], v[208:209]
v_pk_mul_f32 v[50:51], v[50:51], v[210:211]
v_pk_mul_f32 v[52:53], v[52:53], v[208:209]
ds_write_b64 v245, v[34:35] offset:288
s_waitcnt lgkmcnt(8)
buffer_store_dwordx4 a[128:131], v244, s[20:23], s98 offen offset:0 nt
v_pk_mul_f32 v[54:55], v[54:55], v[210:211]
v_pk_mul_f32 v[56:57], v[56:57], v[208:209]
v_pk_mul_f32 v[58:59], v[58:59], v[210:211]
ds_write_b64 v245, v[36:37] offset:576
v_pk_mul_f32 v[60:61], v[60:61], v[208:209]
v_pk_mul_f32 v[62:63], v[62:63], v[210:211]
s_waitcnt lgkmcnt(7)
buffer_store_dwordx4 a[132:135], v244, s[20:23], s98 offen offset:2048 nt
ds_write_b64 v245, v[38:39] offset:864
v_cvt_pk_bf16_f32 v48, v48, v52
v_cvt_pk_bf16_f32 v52, v50, v54
v_cvt_pk_bf16_f32 v50, v49, v53
v_cvt_pk_bf16_f32 v54, v51, v55
v_cvt_pk_bf16_f32 v49, v56, v60
v_cvt_pk_bf16_f32 v51, v57, v61
v_cvt_pk_bf16_f32 v53, v58, v62
v_cvt_pk_bf16_f32 v55, v59, v63
ds_write_b64 v245, v[48:49] offset:128
s_waitcnt lgkmcnt(7)
buffer_store_dwordx4 a[136:139], v244, s[20:23], s99 offen offset:0 nt
ds_write_b64 v245, v[50:51] offset:416
v_pk_mul_f32 v[96:97], v[96:97], v[212:213]
v_pk_mul_f32 v[98:99], v[98:99], v[214:215]
v_pk_mul_f32 v[100:101], v[100:101], v[212:213]
v_pk_mul_f32 v[102:103], v[102:103], v[214:215]
v_pk_mul_f32 v[104:105], v[104:105], v[212:213]
v_pk_mul_f32 v[106:107], v[106:107], v[214:215]
ds_write_b64 v245, v[52:53] offset:704
s_waitcnt lgkmcnt(7)
buffer_store_dwordx4 a[140:143], v244, s[20:23], s99 offen offset:2048 nt
v_pk_mul_f32 v[108:109], v[108:109], v[212:213]
v_pk_mul_f32 v[110:111], v[110:111], v[214:215]
ds_write_b64 v245, v[54:55] offset:992
v_cvt_pk_bf16_f32 v96, v96, v100
v_cvt_pk_bf16_f32 v100, v98, v102
v_cvt_pk_bf16_f32 v98, v97, v101
v_cvt_pk_bf16_f32 v102, v99, v103
v_cvt_pk_bf16_f32 v97, v104, v108
ds_read_b64_tr_b16 v[32:33], v254 offset:0
ds_read_b64_tr_b16 v[34:35], v254 offset:32
ds_read_b64_tr_b16 v[36:37], v254 offset:1152
v_cvt_pk_bf16_f32 v99, v105, v109
ds_read_b64_tr_b16 v[38:39], v254 offset:1184
ds_read_b64_tr_b16 v[40:41], v254 offset:2304
ds_read_b64_tr_b16 v[42:43], v254 offset:2336
ds_read_b64_tr_b16 v[44:45], v254 offset:3456
v_cvt_pk_bf16_f32 v101, v106, v110
ds_read_b64_tr_b16 v[46:47], v254 offset:3488
ds_write_b64 v245, v[96:97] offset:0
v_cvt_pk_bf16_f32 v103, v107, v111
v_pk_mul_f32 v[112:113], v[112:113], v[212:213]
v_pk_mul_f32 v[114:115], v[114:115], v[214:215]
v_pk_mul_f32 v[116:117], v[116:117], v[212:213]
v_pk_mul_f32 v[118:119], v[118:119], v[214:215]
ds_write_b64 v245, v[98:99] offset:288
s_waitcnt lgkmcnt(8)
buffer_store_dwordx4 v[32:35], v244, s[20:23], s92 offen offset:256 nt
v_pk_mul_f32 v[120:121], v[120:121], v[212:213]
v_pk_mul_f32 v[122:123], v[122:123], v[214:215]
v_pk_mul_f32 v[124:125], v[124:125], v[212:213]
ds_write_b64 v245, v[100:101] offset:576
v_pk_mul_f32 v[126:127], v[126:127], v[214:215]
v_cvt_pk_bf16_f32 v112, v112, v116
s_waitcnt lgkmcnt(7)
buffer_store_dwordx4 v[36:39], v244, s[20:23], s92 offen offset:2304 nt
ds_write_b64 v245, v[102:103] offset:864
v_cvt_pk_bf16_f32 v116, v114, v118
v_cvt_pk_bf16_f32 v114, v113, v117
v_cvt_pk_bf16_f32 v118, v115, v119
v_cvt_pk_bf16_f32 v113, v120, v124
v_cvt_pk_bf16_f32 v115, v121, v125
v_cvt_pk_bf16_f32 v117, v122, v126
v_cvt_pk_bf16_f32 v119, v123, v127
ds_write_b64 v245, v[112:113] offset:128
s_waitcnt lgkmcnt(7)
buffer_store_dwordx4 v[40:43], v244, s[20:23], s93 offen offset:256 nt
v_pk_mul_f32 v[160:161], v[160:161], v[216:217]
ds_write_b64 v245, v[114:115] offset:416
v_pk_mul_f32 v[162:163], v[162:163], v[218:219]
v_pk_mul_f32 v[164:165], v[164:165], v[216:217]
v_pk_mul_f32 v[166:167], v[166:167], v[218:219]
v_pk_mul_f32 v[168:169], v[168:169], v[216:217]
ds_write_b64 v245, v[116:117] offset:704
s_waitcnt lgkmcnt(7)
buffer_store_dwordx4 v[44:47], v244, s[20:23], s93 offen offset:2304 nt
v_pk_mul_f32 v[170:171], v[170:171], v[218:219]
v_pk_mul_f32 v[172:173], v[172:173], v[216:217]
v_pk_mul_f32 v[174:175], v[174:175], v[218:219]
ds_write_b64 v245, v[118:119] offset:992
v_cvt_pk_bf16_f32 v160, v160, v164
v_cvt_pk_bf16_f32 v164, v162, v166
v_cvt_pk_bf16_f32 v162, v161, v165
v_cvt_pk_bf16_f32 v166, v163, v167
v_cvt_pk_bf16_f32 v161, v168, v172
ds_read_b64_tr_b16 v[96:97], v254 offset:0
ds_read_b64_tr_b16 v[98:99], v254 offset:32
ds_read_b64_tr_b16 v[100:101], v254 offset:1152
ds_read_b64_tr_b16 v[102:103], v254 offset:1184
v_cvt_pk_bf16_f32 v163, v169, v173
ds_read_b64_tr_b16 v[104:105], v254 offset:2304
ds_read_b64_tr_b16 v[106:107], v254 offset:2336
ds_read_b64_tr_b16 v[108:109], v254 offset:3456
v_cvt_pk_bf16_f32 v165, v170, v174
ds_read_b64_tr_b16 v[110:111], v254 offset:3488
ds_write_b64 v245, v[160:161] offset:0
v_cvt_pk_bf16_f32 v167, v171, v175
v_pk_mul_f32 v[176:177], v[176:177], v[216:217]
v_pk_mul_f32 v[178:179], v[178:179], v[218:219]
v_pk_mul_f32 v[180:181], v[180:181], v[216:217]
v_pk_mul_f32 v[182:183], v[182:183], v[218:219]
ds_write_b64 v245, v[162:163] offset:288
s_waitcnt lgkmcnt(8)
buffer_store_dwordx4 v[96:99], v244, s[20:23], s94 offen offset:256 nt
v_pk_mul_f32 v[184:185], v[184:185], v[216:217]
v_pk_mul_f32 v[186:187], v[186:187], v[218:219]
v_pk_mul_f32 v[188:189], v[188:189], v[216:217]
ds_write_b64 v245, v[164:165] offset:576
v_pk_mul_f32 v[190:191], v[190:191], v[218:219]
v_cvt_pk_bf16_f32 v176, v176, v180
s_waitcnt lgkmcnt(7)
buffer_store_dwordx4 v[100:103], v244, s[20:23], s94 offen offset:2304 nt
ds_write_b64 v245, v[166:167] offset:864
v_cvt_pk_bf16_f32 v180, v178, v182
v_cvt_pk_bf16_f32 v178, v177, v181
v_cvt_pk_bf16_f32 v182, v179, v183
v_cvt_pk_bf16_f32 v177, v184, v188
v_cvt_pk_bf16_f32 v179, v185, v189
v_cvt_pk_bf16_f32 v181, v186, v190
v_cvt_pk_bf16_f32 v183, v187, v191
ds_write_b64 v245, v[176:177] offset:128
s_waitcnt lgkmcnt(7)
buffer_store_dwordx4 v[104:107], v244, s[20:23], s95 offen offset:256 nt
ds_write_b64 v245, v[178:179] offset:416
v_accvgpr_read_b32 v192, a160
v_accvgpr_read_b32 v193, a161
v_accvgpr_read_b32 v194, a162
v_accvgpr_read_b32 v195, a163
v_accvgpr_read_b32 v196, a164
v_accvgpr_read_b32 v197, a165
s_waitcnt lgkmcnt(6)
buffer_store_dwordx4 v[108:111], v244, s[20:23], s95 offen offset:2304 nt
ds_write_b64 v245, v[180:181] offset:704
v_accvgpr_read_b32 v198, a166
v_accvgpr_read_b32 v199, a167
v_accvgpr_read_b32 v200, a168
ds_write_b64 v245, v[182:183] offset:992
v_accvgpr_read_b32 v201, a169
v_accvgpr_read_b32 v202, a170
v_accvgpr_read_b32 v203, a171
v_accvgpr_read_b32 v204, a172
v_accvgpr_read_b32 v205, a173
ds_read_b64_tr_b16 v[160:161], v254 offset:0
ds_read_b64_tr_b16 v[162:163], v254 offset:32
ds_read_b64_tr_b16 v[164:165], v254 offset:1152
ds_read_b64_tr_b16 v[166:167], v254 offset:1184
v_accvgpr_read_b32 v206, a174
ds_read_b64_tr_b16 v[168:169], v254 offset:2304
ds_read_b64_tr_b16 v[170:171], v254 offset:2336
ds_read_b64_tr_b16 v[172:173], v254 offset:3456
v_accvgpr_read_b32 v207, a175
ds_read_b64_tr_b16 v[174:175], v254 offset:3488
v_pk_mul_f32 v[192:193], v[192:193], v[220:221]
v_pk_mul_f32 v[194:195], v[194:195], v[222:223]
v_pk_mul_f32 v[196:197], v[196:197], v[220:221]
v_pk_mul_f32 v[198:199], v[198:199], v[222:223]
v_pk_mul_f32 v[200:201], v[200:201], v[220:221]
v_pk_mul_f32 v[202:203], v[202:203], v[222:223]
v_pk_mul_f32 v[204:205], v[204:205], v[220:221]
v_pk_mul_f32 v[206:207], v[206:207], v[222:223]
v_cvt_pk_bf16_f32 v192, v192, v196
v_cvt_pk_bf16_f32 v196, v194, v198
s_waitcnt lgkmcnt(6)
buffer_store_dwordx4 v[160:163], v244, s[20:23], s96 offen offset:256 nt
v_cvt_pk_bf16_f32 v194, v193, v197
v_cvt_pk_bf16_f32 v198, v195, v199
v_cvt_pk_bf16_f32 v193, v200, v204
v_cvt_pk_bf16_f32 v195, v201, v205
v_cvt_pk_bf16_f32 v197, v202, v206
v_cvt_pk_bf16_f32 v199, v203, v207
ds_write_b64 v245, v[192:193] offset:0
ds_write_b64 v245, v[194:195] offset:288
s_waitcnt lgkmcnt(6)
buffer_store_dwordx4 v[164:167], v244, s[20:23], s96 offen offset:2304 nt
ds_write_b64 v245, v[196:197] offset:576
v_accvgpr_read_b32 v224, a176
v_accvgpr_read_b32 v225, a177
v_accvgpr_read_b32 v226, a178
v_accvgpr_read_b32 v227, a179
v_accvgpr_read_b32 v228, a180
v_accvgpr_read_b32 v229, a181
ds_write_b64 v245, v[198:199] offset:864
s_waitcnt lgkmcnt(6)
buffer_store_dwordx4 v[168:171], v244, s[20:23], s97 offen offset:256 nt
v_accvgpr_read_b32 v230, a182
v_accvgpr_read_b32 v231, a183
v_accvgpr_read_b32 v232, a184
v_accvgpr_read_b32 v233, a185
v_accvgpr_read_b32 v234, a186
v_accvgpr_read_b32 v235, a187
v_accvgpr_read_b32 v236, a188
v_accvgpr_read_b32 v237, a189
v_accvgpr_read_b32 v238, a190
s_waitcnt lgkmcnt(4)
buffer_store_dwordx4 v[172:175], v244, s[20:23], s97 offen offset:2304 nt
v_accvgpr_read_b32 v239, a191
v_pk_mul_f32 v[224:225], v[224:225], v[220:221]
v_pk_mul_f32 v[226:227], v[226:227], v[222:223]
v_pk_mul_f32 v[228:229], v[228:229], v[220:221]
v_pk_mul_f32 v[230:231], v[230:231], v[222:223]
v_pk_mul_f32 v[232:233], v[232:233], v[220:221]
v_pk_mul_f32 v[234:235], v[234:235], v[222:223]
v_pk_mul_f32 v[236:237], v[236:237], v[220:221]
v_pk_mul_f32 v[238:239], v[238:239], v[222:223]
v_cvt_pk_bf16_f32 v224, v224, v228
v_cvt_pk_bf16_f32 v228, v226, v230
v_cvt_pk_bf16_f32 v226, v225, v229
v_cvt_pk_bf16_f32 v230, v227, v231
v_cvt_pk_bf16_f32 v225, v232, v236
v_cvt_pk_bf16_f32 v227, v233, v237
v_cvt_pk_bf16_f32 v229, v234, v238
v_cvt_pk_bf16_f32 v231, v235, v239
ds_write_b64 v245, v[224:225] offset:128
ds_write_b64 v245, v[226:227] offset:416
ds_write_b64 v245, v[228:229] offset:704
ds_write_b64 v245, v[230:231] offset:992
ds_read_b64_tr_b16 a[160:161], v254 offset:0
ds_read_b64_tr_b16 a[162:163], v254 offset:32
ds_read_b64_tr_b16 a[164:165], v254 offset:1152
ds_read_b64_tr_b16 a[166:167], v254 offset:1184
ds_read_b64_tr_b16 a[168:169], v254 offset:2304
ds_read_b64_tr_b16 a[170:171], v254 offset:2336
ds_read_b64_tr_b16 a[172:173], v254 offset:3456
ds_read_b64_tr_b16 a[174:175], v254 offset:3488
s_waitcnt lgkmcnt(6)
buffer_store_dwordx4 a[160:163], v244, s[20:23], s98 offen offset:256 nt
s_waitcnt lgkmcnt(4)
buffer_store_dwordx4 a[164:167], v244, s[20:23], s98 offen offset:2304 nt
s_waitcnt lgkmcnt(2)
buffer_store_dwordx4 a[168:171], v244, s[20:23], s99 offen offset:256 nt
s_waitcnt lgkmcnt(0)
buffer_store_dwordx4 a[172:175], v244, s[20:23], s99 offen offset:2304 nt
s_cmp_lg_u64 s[42:43], 0
s_cbranch_scc1 L_slow
s_endpgm
L_fin3:
s_waitcnt lgkmcnt(0)
s_nop 6
v_pk_mul_f32 v[0:1], v[0:1], v[208:209]
v_pk_mul_f32 v[2:3], v[2:3], v[210:211]
v_pk_mul_f32 v[4:5], v[4:5], v[208:209]
v_pk_mul_f32 v[6:7], v[6:7], v[210:211]
v_pk_mul_f32 v[8:9], v[8:9], v[208:209]
v_pk_mul_f32 v[10:11], v[10:11], v[210:211]
v_pk_mul_f32 v[12:13], v[12:13], v[208:209]
v_pk_mul_f32 v[14:15], v[14:15], v[210:211]
v_cvt_pk_bf16_f32 v0, v0, v4
v_cvt_pk_bf16_f32 v4, v2, v6
v_cvt_pk_bf16_f32 v2, v1, v5
v_cvt_pk_bf16_f32 v6, v3, v7
v_cvt_pk_bf16_f32 v1, v8, v12
v_cvt_pk_bf16_f32 v3, v9, v13
v_cvt_pk_bf16_f32 v5, v10, v14
v_cvt_pk_bf16_f32 v7, v11, v15
ds_write_b64 v245, v[0:1] offset:0
ds_write_b64 v245, v[2:3] offset:288
v_pk_mul_f32 v[16:17], v[16:17], v[208:209]
v_pk_mul_f32 v[18:19], v[18:19], v[210:211]
ds_write_b64 v245, v[4:5] offset:576
v_pk_mul_f32 v[20:21], v[20:21], v[208:209]
v_pk_mul_f32 v[22:23], v[22:23], v[210:211]
v_pk_mul_f32 v[24:25], v[24:25], v[208:209]
v_pk_mul_f32 v[26:27], v[26:27], v[210:211]
v_pk_mul_f32 v[28:29], v[28:29], v[208:209]
ds_write_b64 v245, v[6:7] offset:864
v_pk_mul_f32 v[30:31], v[30:31], v[210:211]
v_cvt_pk_bf16_f32 v16, v16, v20
v_cvt_pk_bf16_f32 v20, v18, v22
v_cvt_pk_bf16_f32 v18, v17, v21
v_cvt_pk_bf16_f32 v22, v19, v23
v_cvt_pk_bf16_f32 v17, v24, v28
v_cvt_pk_bf16_f32 v19, v25, v29
v_cvt_pk_bf16_f32 v21, v26, v30
v_cvt_pk_bf16_f32 v23, v27, v31
ds_write_b64 v245, v[16:17] offset:128
v_pk_mul_f32 v[64:65], v[64:65], v[212:213]
ds_write_b64 v245, v[18:19] offset:416
v_pk_mul_f32 v[66:67], v[66:67], v[214:215]
v_pk_mul_f32 v[68:69], v[68:69], v[212:213]
v_pk_mul_f32 v[70:71], v[70:71], v[214:215]
v_pk_mul_f32 v[72:73], v[72:73], v[212:213]
ds_write_b64 v245, v[20:21] offset:704
v_pk_mul_f32 v[74:75], v[74:75], v[214:215]
v_pk_mul_f32 v[76:77], v[76:77], v[212:213]
v_pk_mul_f32 v[78:79], v[78:79], v[214:215]
v_cvt_pk_bf16_f32 v64, v64, v68
v_cvt_pk_bf16_f32 v68, v66, v70
ds_write_b64 v245, v[22:23] offset:992
v_cvt_pk_bf16_f32 v66, v65, v69
v_cvt_pk_bf16_f32 v70, v67, v71
v_cvt_pk_bf16_f32 v65, v72, v76
v_cvt_pk_bf16_f32 v67, v73, v77
v_cvt_pk_bf16_f32 v69, v74, v78
ds_read_b64_tr_b16 v[0:1], v254 offset:0
ds_read_b64_tr_b16 v[2:3], v254 offset:32
ds_read_b64_tr_b16 v[4:5], v254 offset:1152
v_cvt_pk_bf16_f32 v71, v75, v79
ds_read_b64_tr_b16 v[6:7], v254 offset:1184
ds_read_b64_tr_b16 v[8:9], v254 offset:2304
ds_read_b64_tr_b16 v[10:11], v254 offset:2336
ds_read_b64_tr_b16 v[12:13], v254 offset:3456
v_pk_mul_f32 v[80:81], v[80:81], v[212:213]
ds_read_b64_tr_b16 v[14:15], v254 offset:3488
ds_write_b64 v245, v[64:65] offset:0
v_pk_mul_f32 v[82:83], v[82:83], v[214:215]
v_pk_mul_f32 v[84:85], v[84:85], v[212:213]
v_pk_mul_f32 v[86:87], v[86:87], v[214:215]
v_pk_mul_f32 v[88:89], v[88:89], v[212:213]
v_pk_mul_f32 v[90:91], v[90:91], v[214:215]
ds_write_b64 v245, v[66:67] offset:288
s_waitcnt lgkmcnt(8)
buffer_store_dwordx4 v[0:3], v244, s[20:23], s92 offen offset:0 nt
v_pk_mul_f32 v[92:93], v[92:93], v[212:213]
v_pk_mul_f32 v[94:95], v[94:95], v[214:215]
v_cvt_pk_bf16_f32 v80, v80, v84
ds_write_b64 v245, v[68:69] offset:576
v_cvt_pk_bf16_f32 v84, v82, v86
v_cvt_pk_bf16_f32 v82, v81, v85
s_waitcnt lgkmcnt(7)
buffer_store_dwordx4 v[4:7], v244, s[20:23], s92 offen offset:2048 nt
ds_write_b64 v245, v[70:71] offset:864
v_cvt_pk_bf16_f32 v86, v83, v87
v_cvt_pk_bf16_f32 v81, v88, v92
v_cvt_pk_bf16_f32 v83, v89, v93
v_cvt_pk_bf16_f32 v85, v90, v94
v_cvt_pk_bf16_f32 v87, v91, v95
ds_write_b64 v245, v[80:81] offset:128
s_waitcnt lgkmcnt(7)
buffer_store_dwordx4 v[8:11], v244, s[20:23], s93 offen offset:0 nt
v_pk_mul_f32 v[128:129], v[128:129], v[216:217]
v_pk_mul_f32 v[130:131], v[130:131], v[218:219]
v_pk_mul_f32 v[132:133], v[132:133], v[216:217]
ds_write_b64 v245, v[82:83] offset:416
v_pk_mul_f32 v[134:135], v[134:135], v[218:219]
v_pk_mul_f32 v[136:137], v[136:137], v[216:217]
v_pk_mul_f32 v[138:139], v[138:139], v[218:219]
s_waitcnt lgkmcnt(6)
buffer_store_dwordx4 v[12:15], v244, s[20:23], s93 offen offset:2048 nt
ds_write_b64 v245, v[84:85] offset:704
v_pk_mul_f32 v[140:141], v[140:141], v[216:217]
v_pk_mul_f32 v[142:143], v[142:143], v[218:219]
v_cvt_pk_bf16_f32 v128, v128, v132
v_cvt_pk_bf16_f32 v132, v130, v134
ds_write_b64 v245, v[86:87] offset:992
v_cvt_pk_bf16_f32 v130, v129, v133
v_cvt_pk_bf16_f32 v134, v131, v135
v_cvt_pk_bf16_f32 v129, v136, v140
v_cvt_pk_bf16_f32 v131, v137, v141
v_cvt_pk_bf16_f32 v133, v138, v142
ds_read_b64_tr_b16 v[64:65], v254 offset:0
ds_read_b64_tr_b16 v[66:67], v254 offset:32
ds_read_b64_tr_b16 v[68:69], v254 offset:1152
ds_read_b64_tr_b16 v[70:71], v254 offset:1184
v_cvt_pk_bf16_f32 v135, v139, v143
ds_read_b64_tr_b16 v[72:73], v254 offset:2304
ds_read_b64_tr_b16 v[74:75], v254 offset:2336
ds_read_b64_tr_b16 v[76:77], v254 offset:3456
v_pk_mul_f32 v[144:145], v[144:145], v[216:217]
ds_read_b64_tr_b16 v[78:79], v254 offset:3488
ds_write_b64 v245, v[128:129] offset:0
v_pk_mul_f32 v[146:147], v[146:147], v[218:219]
v_pk_mul_f32 v[148:149], v[148:149], v[216:217]
v_pk_mul_f32 v[150:151], v[150:151], v[218:219]
v_pk_mul_f32 v[152:153], v[152:153], v[216:217]
v_pk_mul_f32 v[154:155], v[154:155], v[218:219]
ds_write_b64 v245, v[130:131] offset:288
s_waitcnt lgkmcnt(8)
buffer_store_dwordx4 v[64:67], v244, s[20:23], s94 offen offset:0 nt
v_pk_mul_f32 v[156:157], v[156:157], v[216:217]
v_pk_mul_f32 v[158:159], v[158:159], v[218:219]
v_cvt_pk_bf16_f32 v144, v144, v148
ds_write_b64 v245, v[132:133] offset:576
v_cvt_pk_bf16_f32 v148, v146, v150
v_cvt_pk_bf16_f32 v146, v145, v149
s_waitcnt lgkmcnt(7)
buffer_store_dwordx4 v[68:71], v244, s[20:23], s94 offen offset:2048 nt
ds_write_b64 v245, v[134:135] offset:864
v_cvt_pk_bf16_f32 v150, v147, v151
v_cvt_pk_bf16_f32 v145, v152, v156
v_cvt_pk_bf16_f32 v147, v153, v157
v_cvt_pk_bf16_f32 v149, v154, v158
v_cvt_pk_bf16_f32 v151, v155, v159
ds_write_b64 v245, v[144:145] offset:128
s_waitcnt lgkmcnt(7)
buffer_store_dwordx4 v[72:75], v244, s[20:23], s95 offen offset:0 nt
v_pk_mul_f32 v[32:33], v[32:33], v[208:209]
v_pk_mul_f32 v[34:35], v[34:35], v[210:211]
ds_write_b64 v245, v[146:147] offset:416
v_pk_mul_f32 v[36:37], v[36:37], v[208:209]
v_pk_mul_f32 v[38:39], v[38:39], v[210:211]
v_pk_mul_f32 v[40:41], v[40:41], v[208:209]
v_pk_mul_f32 v[42:43], v[42:43], v[210:211]
s_waitcnt lgkmcnt(6)
buffer_store_dwordx4 v[76:79], v244, s[20:23], s95 offen offset:2048 nt
ds_write_b64 v245, v[148:149] offset:704
v_pk_mul_f32 v[44:45], v[44:45], v[208:209]
v_pk_mul_f32 v[46:47], v[46:47], v[210:211]
v_cvt_pk_bf16_f32 v32, v32, v36
v_cvt_pk_bf16_f32 v36, v34, v38
ds_write_b64 v245, v[150:151] offset:992
v_cvt_pk_bf16_f32 v34, v33, v37
v_cvt_pk_bf16_f32 v38, v35, v39
v_cvt_pk_bf16_f32 v33, v40, v44
v_cvt_pk_bf16_f32 v35, v41, v45
ds_read_b64_tr_b16 v[128:129], v254 offset:0
ds_read_b64_tr_b16 v[130:131], v254 offset:32
ds_read_b64_tr_b16 v[132:133], v254 offset:1152
v_cvt_pk_bf16_f32 v37, v42, v46
ds_read_b64_tr_b16 v[134:135], v254 offset:1184
ds_read_b64_tr_b16 v[136:137], v254 offset:2304
ds_read_b64_tr_b16 v[138:139], v254 offset:2336
v_cvt_pk_bf16_f32 v39, v43, v47
ds_read_b64_tr_b16 v[140:141], v254 offset:3456
ds_read_b64_tr_b16 v[142:143], v254 offset:3488
ds_write_b64 v245, v[32:33] offset:0
v_pk_mul_f32 v[48:49], v[48:49], v[208:209]
v_pk_mul_f32 v[50:51], v[50:51], v[210:211]
v_pk_mul_f32 v[52:53], v[52:53], v[208:209]
v_pk_mul_f32 v[54:55], v[54:55], v[210:211]
v_pk_mul_f32 v[56:57], v[56:57], v[208:209]
v_pk_mul_f32 v[58:59], v[58:59], v[210:211]
ds_write_b64 v245, v[34:35] offset:288
s_waitcnt lgkmcnt(8)
buffer_store_dwordx4 v[128:131], v244, s[20:23], s96 offen offset:0 nt
v_pk_mul_f32 v[60:61], v[60:61], v[208:209]
v_pk_mul_f32 v[62:63], v[62:63], v[210:211]
ds_write_b64 v245, v[36:37] offset:576
v_cvt_pk_bf16_f32 v48, v48, v52
v_cvt_pk_bf16_f32 v52, v50, v54
v_cvt_pk_bf16_f32 v50, v49, v53
s_waitcnt lgkmcnt(7)
buffer_store_dwordx4 v[132:135], v244, s[20:23], s96 offen offset:2048 nt
ds_write_b64 v245, v[38:39] offset:864
v_cvt_pk_bf16_f32 v54, v51, v55
v_cvt_pk_bf16_f32 v49, v56, v60
v_cvt_pk_bf16_f32 v51, v57, v61
v_cvt_pk_bf16_f32 v53, v58, v62
v_cvt_pk_bf16_f32 v55, v59, v63
ds_write_b64 v245, v[48:49] offset:128
s_waitcnt lgkmcnt(7)
buffer_store_dwordx4 v[136:139], v244, s[20:23], s97 offen offset:0 nt
v_pk_mul_f32 v[96:97], v[96:97], v[212:213]
v_pk_mul_f32 v[98:99], v[98:99], v[214:215]
ds_write_b64 v245, v[50:51] offset:416
v_pk_mul_f32 v[100:101], v[100:101], v[212:213]
v_pk_mul_f32 v[102:103], v[102:103], v[214:215]
v_pk_mul_f32 v[104:105], v[104:105], v[212:213]
v_pk_mul_f32 v[106:107], v[106:107], v[214:215]
s_waitcnt lgkmcnt(6)
buffer_store_dwordx4 v[140:143], v244, s[20:23], s97 offen offset:2048 nt
ds_write_b64 v245, v[52:53] offset:704
v_pk_mul_f32 v[108:109], v[108:109], v[212:213]
v_pk_mul_f32 v[110:111], v[110:111], v[214:215]
v_cvt_pk_bf16_f32 v96, v96, v100
ds_write_b64 v245, v[54:55] offset:992
v_cvt_pk_bf16_f32 v100, v98, v102
v_cvt_pk_bf16_f32 v98, v97, v101
v_cvt_pk_bf16_f32 v102, v99, v103
v_cvt_pk_bf16_f32 v97, v104, v108
v_cvt_pk_bf16_f32 v99, v105, v109
ds_read_b64_tr_b16 v[32:33], v254 offset:0
ds_read_b64_tr_b16 v[34:35], v254 offset:32
ds_read_b64_tr_b16 v[36:37], v254 offset:1152
v_cvt_pk_bf16_f32 v101, v106, v110
ds_read_b64_tr_b16 v[38:39], v254 offset:1184
ds_read_b64_tr_b16 v[40:41], v254 offset:2304
ds_read_b64_tr_b16 v[42:43], v254 offset:2336
v_cvt_pk_bf16_f32 v103, v107, v111
ds_read_b64_tr_b16 v[44:45], v254 offset:3456
ds_read_b64_tr_b16 v[46:47], v254 offset:3488
ds_write_b64 v245, v[96:97] offset:0
v_pk_mul_f32 v[112:113], v[112:113], v[212:213]
v_pk_mul_f32 v[114:115], v[114:115], v[214:215]
v_pk_mul_f32 v[116:117], v[116:117], v[212:213]
v_pk_mul_f32 v[118:119], v[118:119], v[214:215]
v_pk_mul_f32 v[120:121], v[120:121], v[212:213]
v_pk_mul_f32 v[122:123], v[122:123], v[214:215]
ds_write_b64 v245, v[98:99] offset:288
s_waitcnt lgkmcnt(8)
buffer_store_dwordx4 v[32:35], v244, s[20:23], s92 offen offset:256 nt
v_pk_mul_f32 v[124:125], v[124:125], v[212:213]
v_pk_mul_f32 v[126:127], v[126:127], v[214:215]
ds_write_b64 v245, v[100:101] offset:576
v_cvt_pk_bf16_f32 v112, v112, v116
v_cvt_pk_bf16_f32 v116, v114, v118
v_cvt_pk_bf16_f32 v114, v113, v117
s_waitcnt lgkmcnt(7)
buffer_store_dwordx4 v[36:39], v244, s[20:23], s92 offen offset:2304 nt
ds_write_b64 v245, v[102:103] offset:864
v_cvt_pk_bf16_f32 v118, v115, v119
v_cvt_pk_bf16_f32 v113, v120, v124
v_cvt_pk_bf16_f32 v115, v121, v125
v_cvt_pk_bf16_f32 v117, v122, v126
v_cvt_pk_bf16_f32 v119, v123, v127
ds_write_b64 v245, v[112:113] offset:128
s_waitcnt lgkmcnt(7)
buffer_store_dwordx4 v[40:43], v244, s[20:23], s93 offen offset:256 nt
v_pk_mul_f32 v[160:161], v[160:161], v[216:217]
v_pk_mul_f32 v[162:163], v[162:163], v[218:219]
ds_write_b64 v245, v[114:115] offset:416
v_pk_mul_f32 v[164:165], v[164:165], v[216:217]
v_pk_mul_f32 v[166:167], v[166:167], v[218:219]
v_pk_mul_f32 v[168:169], v[168:169], v[216:217]
v_pk_mul_f32 v[170:171], v[170:171], v[218:219]
s_waitcnt lgkmcnt(6)
buffer_store_dwordx4 v[44:47], v244, s[20:23], s93 offen offset:2304 nt
ds_write_b64 v245, v[116:117] offset:704
v_pk_mul_f32 v[172:173], v[172:173], v[216:217]
v_pk_mul_f32 v[174:175], v[174:175], v[218:219]
v_cvt_pk_bf16_f32 v160, v160, v164
ds_write_b64 v245, v[118:119] offset:992
v_cvt_pk_bf16_f32 v164, v162, v166
v_cvt_pk_bf16_f32 v162, v161, v165
v_cvt_pk_bf16_f32 v166, v163, v167
v_cvt_pk_bf16_f32 v161, v168, v172
v_cvt_pk_bf16_f32 v163, v169, v173
ds_read_b64_tr_b16 v[96:97], v254 offset:0
ds_read_b64_tr_b16 v[98:99], v254 offset:32
ds_read_b64_tr_b16 v[100:101], v254 offset:1152
v_cvt_pk_bf16_f32 v165, v170, v174
ds_read_b64_tr_b16 v[102:103], v254 offset:1184
ds_read_b64_tr_b16 v[104:105], v254 offset:2304
ds_read_b64_tr_b16 v[106:107], v254 offset:2336
ds_read_b64_tr_b16 v[108:109], v254 offset:3456
v_cvt_pk_bf16_f32 v167, v171, v175
ds_read_b64_tr_b16 v[110:111], v254 offset:3488
ds_write_b64 v245, v[160:161] offset:0
v_pk_mul_f32 v[176:177], v[176:177], v[216:217]
v_pk_mul_f32 v[178:179], v[178:179], v[218:219]
v_pk_mul_f32 v[180:181], v[180:181], v[216:217]
v_pk_mul_f32 v[182:183], v[182:183], v[218:219]
v_pk_mul_f32 v[184:185], v[184:185], v[216:217]
ds_write_b64 v245, v[162:163] offset:288
s_waitcnt lgkmcnt(8)
buffer_store_dwordx4 v[96:99], v244, s[20:23], s94 offen offset:256 nt
v_pk_mul_f32 v[186:187], v[186:187], v[218:219]
v_pk_mul_f32 v[188:189], v[188:189], v[216:217]
v_pk_mul_f32 v[190:191], v[190:191], v[218:219]
ds_write_b64 v245, v[164:165] offset:576
v_cvt_pk_bf16_f32 v176, v176, v180
v_cvt_pk_bf16_f32 v180, v178, v182
s_waitcnt lgkmcnt(7)
buffer_store_dwordx4 v[100:103], v244, s[20:23], s94 offen offset:2304 nt
ds_write_b64 v245, v[166:167] offset:864
v_cvt_pk_bf16_f32 v178, v177, v181
v_cvt_pk_bf16_f32 v182, v179, v183
v_cvt_pk_bf16_f32 v177, v184, v188
v_cvt_pk_bf16_f32 v179, v185, v189
v_cvt_pk_bf16_f32 v181, v186, v190
v_cvt_pk_bf16_f32 v183, v187, v191
ds_write_b64 v245, v[176:177] offset:128
s_waitcnt lgkmcnt(7)
buffer_store_dwordx4 v[104:107], v244, s[20:23], s95 offen offset:256 nt
ds_write_b64 v245, v[178:179] offset:416
s_waitcnt lgkmcnt(6)
buffer_store_dwordx4 v[108:111], v244, s[20:23], s95 offen offset:2304 nt
ds_write_b64 v245, v[180:181] offset:704
ds_write_b64 v245, v[182:183] offset:992
ds_read_b64_tr_b16 v[160:161], v254 offset:0
ds_read_b64_tr_b16 v[162:163], v254 offset:32
ds_read_b64_tr_b16 v[164:165], v254 offset:1152
ds_read_b64_tr_b16 v[166:167], v254 offset:1184
ds_read_b64_tr_b16 v[168:169], v254 offset:2304
ds_read_b64_tr_b16 v[170:171], v254 offset:2336
ds_read_b64_tr_b16 v[172:173], v254 offset:3456
ds_read_b64_tr_b16 v[174:175], v254 offset:3488
s_waitcnt lgkmcnt(6)
buffer_store_dwordx4 v[160:163], v244, s[20:23], s96 offen offset:256 nt
s_waitcnt lgkmcnt(4)
buffer_store_dwordx4 v[164:167], v244, s[20:23], s96 offen offset:2304 nt
s_waitcnt lgkmcnt(2)
buffer_store_dwordx4 v[168:171], v244, s[20:23], s97 offen offset:256 nt
s_waitcnt lgkmcnt(0)
buffer_store_dwordx4 v[172:175], v244, s[20:23], s97 offen offset:2304 nt
s_cmp_lg_u64 s[42:43], 0
s_cbranch_scc1 L_slow
s_endpgm
L_codeend2:
L_slow:
s_waitcnt vmcnt(0) lgkmcnt(0)
v_mbcnt_lo_u32_b32 v178, -1, 0
v_mbcnt_hi_u32_b32 v178, -1, v178
v_lshrrev_b32 v180, 4, v178
v_and_b32 v178, 15, v178
v_lshlrev_b32 v181, 9, v178
v_lshl_add_u32 v179, v180, 4, v181
v_lshl_add_u32 v181, v180, 3, v181
v_lshlrev_b32 v180, 11, v180
v_lshl_add_u32 v180, v178, 1, v180
s_mov_b32 s46, 0
s_mov_b32 s47, s34
L_slow_tile:
buffer_load_dwordx4 v[0:3], v179, s[8:11], s47 offen offset:0
buffer_load_dwordx4 v[4:7], v179, s[8:11], s47 offen offset:64
buffer_load_dwordx4 v[8:11], v179, s[8:11], s47 offen offset:128
buffer_load_dwordx4 v[12:15], v179, s[8:11], s47 offen offset:192
buffer_load_dwordx4 v[16:19], v179, s[8:11], s47 offen offset:256
buffer_load_dwordx4 v[20:23], v179, s[8:11], s47 offen offset:320
buffer_load_dwordx4 v[24:27], v179, s[8:11], s47 offen offset:384
buffer_load_dwordx4 v[28:31], v179, s[8:11], s47 offen offset:448
v_mov_b32 v176, 0xff800000
s_mov_b32 s48, s31
s_mov_b32 s49, 32
L_slow_max:
buffer_load_dwordx4 v[32:35], v179, s[12:15], s48 offen offset:0
buffer_load_dwordx4 v[36:39], v179, s[12:15], s48 offen offset:64
buffer_load_dwordx4 v[40:43], v179, s[12:15], s48 offen offset:128
buffer_load_dwordx4 v[44:47], v179, s[12:15], s48 offen offset:192
buffer_load_dwordx4 v[48:51], v179, s[12:15], s48 offen offset:256
buffer_load_dwordx4 v[52:55], v179, s[12:15], s48 offen offset:320
buffer_load_dwordx4 v[56:59], v179, s[12:15], s48 offen offset:384
buffer_load_dwordx4 v[60:63], v179, s[12:15], s48 offen offset:448
s_waitcnt vmcnt(0)
v_mfma_f32_16x16x32_bf16 v[160:163], v[32:35], v[0:3], 0
v_mfma_f32_16x16x32_bf16 v[160:163], v[36:39], v[4:7], v[160:163]
v_mfma_f32_16x16x32_bf16 v[160:163], v[40:43], v[8:11], v[160:163]
v_mfma_f32_16x16x32_bf16 v[160:163], v[44:47], v[12:15], v[160:163]
v_mfma_f32_16x16x32_bf16 v[160:163], v[48:51], v[16:19], v[160:163]
v_mfma_f32_16x16x32_bf16 v[160:163], v[52:55], v[20:23], v[160:163]
v_mfma_f32_16x16x32_bf16 v[160:163], v[56:59], v[24:27], v[160:163]
v_mfma_f32_16x16x32_bf16 v[160:163], v[60:63], v[28:31], v[160:163]
s_nop 7
s_nop 1
s_add_u32 s48, s48, 8192
v_max3_f32 v176, v176, v160, v161
v_max3_f32 v176, v176, v162, v163
s_sub_u32 s49, s49, 1
s_cmp_lg_u32 s49, 0
s_cbranch_scc1 L_slow_max
s_nop 1
v_mov_b32 v178, v176
s_nop 1
v_permlane32_swap_b32 v176, v178
s_nop 1
v_max_f32 v176, v176, v178
s_nop 1
v_mov_b32 v178, v176
s_nop 1
v_permlane16_swap_b32 v176, v178
s_nop 1
v_max_f32 v176, v176, v178
v_mul_f32 v176, s27, v176
v_mov_b32 v177, 0
v_mov_b32 v96, 0
v_mov_b32 v97, 0
v_mov_b32 v98, 0
v_mov_b32 v99, 0
v_mov_b32 v100, 0
v_mov_b32 v101, 0
v_mov_b32 v102, 0
v_mov_b32 v103, 0
v_mov_b32 v104, 0
v_mov_b32 v105, 0
v_mov_b32 v106, 0
v_mov_b32 v107, 0
v_mov_b32 v108, 0
v_mov_b32 v109, 0
v_mov_b32 v110, 0
v_mov_b32 v111, 0
v_mov_b32 v112, 0
v_mov_b32 v113, 0
v_mov_b32 v114, 0
v_mov_b32 v115, 0
v_mov_b32 v116, 0
v_mov_b32 v117, 0
v_mov_b32 v118, 0
v_mov_b32 v119, 0
v_mov_b32 v120, 0
v_mov_b32 v121, 0
v_mov_b32 v122, 0
v_mov_b32 v123, 0
v_mov_b32 v124, 0
v_mov_b32 v125, 0
v_mov_b32 v126, 0
v_mov_b32 v127, 0
v_mov_b32 v128, 0
v_mov_b32 v129, 0
v_mov_b32 v130, 0
v_mov_b32 v131, 0
v_mov_b32 v132, 0
v_mov_b32 v133, 0
v_mov_b32 v134, 0
v_mov_b32 v135, 0
v_mov_b32 v136, 0
v_mov_b32 v137, 0
v_mov_b32 v138, 0
v_mov_b32 v139, 0
v_mov_b32 v140, 0
v_mov_b32 v141, 0
v_mov_b32 v142, 0
v_mov_b32 v143, 0
v_mov_b32 v144, 0
v_mov_b32 v145, 0
v_mov_b32 v146, 0
v_mov_b32 v147, 0
v_mov_b32 v148, 0
v_mov_b32 v149, 0
v_mov_b32 v150, 0
v_mov_b32 v151, 0
v_mov_b32 v152, 0
v_mov_b32 v153, 0
v_mov_b32 v154, 0
v_mov_b32 v155, 0
v_mov_b32 v156, 0
v_mov_b32 v157, 0
v_mov_b32 v158, 0
v_mov_b32 v159, 0
s_mov_b32 s48, s31
s_mov_b32 s49, 16
L_slow_pv:
s_mov_b32 s50, s48
s_add_u32 s51, s48, 8192
buffer_load_dwordx4 v[32:35], v179, s[12:15], s48 offen offset:0
buffer_load_dwordx4 v[36:39], v179, s[12:15], s48 offen offset:64
buffer_load_dwordx4 v[40:43], v179, s[12:15], s48 offen offset:128
buffer_load_dwordx4 v[44:47], v179, s[12:15], s48 offen offset:192
buffer_load_dwordx4 v[48:51], v179, s[12:15], s48 offen offset:256
buffer_load_dwordx4 v[52:55], v179, s[12:15], s48 offen offset:320
buffer_load_dwordx4 v[56:59], v179, s[12:15], s48 offen offset:384
buffer_load_dwordx4 v[60:63], v179, s[12:15], s48 offen offset:448
s_waitcnt vmcnt(0)
v_mfma_f32_16x16x32_bf16 v[160:163], v[32:35], v[0:3], 0
v_mfma_f32_16x16x32_bf16 v[160:163], v[36:39], v[4:7], v[160:163]
v_mfma_f32_16x16x32_bf16 v[160:163], v[40:43], v[8:11], v[160:163]
v_mfma_f32_16x16x32_bf16 v[160:163], v[44:47], v[12:15], v[160:163]
v_mfma_f32_16x16x32_bf16 v[160:163], v[48:51], v[16:19], v[160:163]
v_mfma_f32_16x16x32_bf16 v[160:163], v[52:55], v[20:23], v[160:163]
v_mfma_f32_16x16x32_bf16 v[160:163], v[56:59], v[24:27], v[160:163]
v_mfma_f32_16x16x32_bf16 v[160:163], v[60:63], v[28:31], v[160:163]
s_nop 7
s_nop 1
s_add_u32 s48, s48, 8192
buffer_load_dwordx4 v[32:35], v179, s[12:15], s48 offen offset:0
buffer_load_dwordx4 v[36:39], v179, s[12:15], s48 offen offset:64
buffer_load_dwordx4 v[40:43], v179, s[12:15], s48 offen offset:128
buffer_load_dwordx4 v[44:47], v179, s[12:15], s48 offen offset:192
buffer_load_dwordx4 v[48:51], v179, s[12:15], s48 offen offset:256
buffer_load_dwordx4 v[52:55], v179, s[12:15], s48 offen offset:320
buffer_load_dwordx4 v[56:59], v179, s[12:15], s48 offen offset:384
buffer_load_dwordx4 v[60:63], v179, s[12:15], s48 offen offset:448
s_waitcnt vmcnt(0)
v_mfma_f32_16x16x32_bf16 v[164:167], v[32:35], v[0:3], 0
v_mfma_f32_16x16x32_bf16 v[164:167], v[36:39], v[4:7], v[164:167]
v_mfma_f32_16x16x32_bf16 v[164:167], v[40:43], v[8:11], v[164:167]
v_mfma_f32_16x16x32_bf16 v[164:167], v[44:47], v[12:15], v[164:167]
v_mfma_f32_16x16x32_bf16 v[164:167], v[48:51], v[16:19], v[164:167]
v_mfma_f32_16x16x32_bf16 v[164:167], v[52:55], v[20:23], v[164:167]
v_mfma_f32_16x16x32_bf16 v[164:167], v[56:59], v[24:27], v[164:167]
v_mfma_f32_16x16x32_bf16 v[164:167], v[60:63], v[28:31], v[164:167]
s_nop 7
s_nop 1
s_add_u32 s48, s48, 8192
v_fma_f32 v160, v160, s27, -v176
v_fma_f32 v161, v161, s27, -v176
v_fma_f32 v162, v162, s27, -v176
v_fma_f32 v163, v163, s27, -v176
v_fma_f32 v164, v164, s27, -v176
v_fma_f32 v165, v165, s27, -v176
v_fma_f32 v166, v166, s27, -v176
v_fma_f32 v167, v167, s27, -v176
v_exp_f32 v160, v160
v_exp_f32 v161, v161
v_exp_f32 v162, v162
v_exp_f32 v163, v163
v_exp_f32 v164, v164
v_exp_f32 v165, v165
v_exp_f32 v166, v166
v_exp_f32 v167, v167
s_nop 0
v_add_f32 v177, v177, v160
v_add_f32 v177, v177, v161
v_add_f32 v177, v177, v162
v_add_f32 v177, v177, v163
v_add_f32 v177, v177, v164
v_add_f32 v177, v177, v165
v_add_f32 v177, v177, v166
v_add_f32 v177, v177, v167
v_cvt_pk_bf16_f32 v168, v160, v161
v_cvt_pk_bf16_f32 v169, v162, v163
v_cvt_pk_bf16_f32 v170, v164, v165
v_cvt_pk_bf16_f32 v171, v166, v167
buffer_load_ushort v64, v180, s[16:19], s50 offen offset:0
buffer_load_ushort v65, v180, s[16:19], s50 offen offset:512
buffer_load_ushort v66, v180, s[16:19], s50 offen offset:1024
buffer_load_ushort v67, v180, s[16:19], s50 offen offset:1536
buffer_load_ushort v68, v180, s[16:19], s51 offen offset:0
buffer_load_ushort v69, v180, s[16:19], s51 offen offset:512
buffer_load_ushort v70, v180, s[16:19], s51 offen offset:1024
buffer_load_ushort v71, v180, s[16:19], s51 offen offset:1536
s_waitcnt vmcnt(0)
v_lshl_or_b32 v72, v65, 16, v64
v_lshl_or_b32 v73, v67, 16, v66
v_lshl_or_b32 v74, v69, 16, v68
v_lshl_or_b32 v75, v71, 16, v70
s_nop 1
v_mfma_f32_16x16x32_bf16 v[96:99], v[72:75], v[168:171], v[96:99]
buffer_load_ushort v64, v180, s[16:19], s50 offen offset:32
buffer_load_ushort v65, v180, s[16:19], s50 offen offset:544
buffer_load_ushort v66, v180, s[16:19], s50 offen offset:1056
buffer_load_ushort v67, v180, s[16:19], s50 offen offset:1568
buffer_load_ushort v68, v180, s[16:19], s51 offen offset:32
buffer_load_ushort v69, v180, s[16:19], s51 offen offset:544
buffer_load_ushort v70, v180, s[16:19], s51 offen offset:1056
buffer_load_ushort v71, v180, s[16:19], s51 offen offset:1568
s_waitcnt vmcnt(0)
v_lshl_or_b32 v72, v65, 16, v64
v_lshl_or_b32 v73, v67, 16, v66
v_lshl_or_b32 v74, v69, 16, v68
v_lshl_or_b32 v75, v71, 16, v70
s_nop 1
v_mfma_f32_16x16x32_bf16 v[100:103], v[72:75], v[168:171], v[100:103]
buffer_load_ushort v64, v180, s[16:19], s50 offen offset:64
buffer_load_ushort v65, v180, s[16:19], s50 offen offset:576
buffer_load_ushort v66, v180, s[16:19], s50 offen offset:1088
buffer_load_ushort v67, v180, s[16:19], s50 offen offset:1600
buffer_load_ushort v68, v180, s[16:19], s51 offen offset:64
buffer_load_ushort v69, v180, s[16:19], s51 offen offset:576
buffer_load_ushort v70, v180, s[16:19], s51 offen offset:1088
buffer_load_ushort v71, v180, s[16:19], s51 offen offset:1600
s_waitcnt vmcnt(0)
v_lshl_or_b32 v72, v65, 16, v64
v_lshl_or_b32 v73, v67, 16, v66
v_lshl_or_b32 v74, v69, 16, v68
v_lshl_or_b32 v75, v71, 16, v70
s_nop 1
v_mfma_f32_16x16x32_bf16 v[104:107], v[72:75], v[168:171], v[104:107]
buffer_load_ushort v64, v180, s[16:19], s50 offen offset:96
buffer_load_ushort v65, v180, s[16:19], s50 offen offset:608
buffer_load_ushort v66, v180, s[16:19], s50 offen offset:1120
buffer_load_ushort v67, v180, s[16:19], s50 offen offset:1632
buffer_load_ushort v68, v180, s[16:19], s51 offen offset:96
buffer_load_ushort v69, v180, s[16:19], s51 offen offset:608
buffer_load_ushort v70, v180, s[16:19], s51 offen offset:1120
buffer_load_ushort v71, v180, s[16:19], s51 offen offset:1632
s_waitcnt vmcnt(0)
v_lshl_or_b32 v72, v65, 16, v64
v_lshl_or_b32 v73, v67, 16, v66
v_lshl_or_b32 v74, v69, 16, v68
v_lshl_or_b32 v75, v71, 16, v70
s_nop 1
v_mfma_f32_16x16x32_bf16 v[108:111], v[72:75], v[168:171], v[108:111]
buffer_load_ushort v64, v180, s[16:19], s50 offen offset:128
buffer_load_ushort v65, v180, s[16:19], s50 offen offset:640
buffer_load_ushort v66, v180, s[16:19], s50 offen offset:1152
buffer_load_ushort v67, v180, s[16:19], s50 offen offset:1664
buffer_load_ushort v68, v180, s[16:19], s51 offen offset:128
buffer_load_ushort v69, v180, s[16:19], s51 offen offset:640
buffer_load_ushort v70, v180, s[16:19], s51 offen offset:1152
buffer_load_ushort v71, v180, s[16:19], s51 offen offset:1664
s_waitcnt vmcnt(0)
v_lshl_or_b32 v72, v65, 16, v64
v_lshl_or_b32 v73, v67, 16, v66
v_lshl_or_b32 v74, v69, 16, v68
v_lshl_or_b32 v75, v71, 16, v70
s_nop 1
v_mfma_f32_16x16x32_bf16 v[112:115], v[72:75], v[168:171], v[112:115]
buffer_load_ushort v64, v180, s[16:19], s50 offen offset:160
buffer_load_ushort v65, v180, s[16:19], s50 offen offset:672
buffer_load_ushort v66, v180, s[16:19], s50 offen offset:1184
buffer_load_ushort v67, v180, s[16:19], s50 offen offset:1696
buffer_load_ushort v68, v180, s[16:19], s51 offen offset:160
buffer_load_ushort v69, v180, s[16:19], s51 offen offset:672
buffer_load_ushort v70, v180, s[16:19], s51 offen offset:1184
buffer_load_ushort v71, v180, s[16:19], s51 offen offset:1696
s_waitcnt vmcnt(0)
v_lshl_or_b32 v72, v65, 16, v64
v_lshl_or_b32 v73, v67, 16, v66
v_lshl_or_b32 v74, v69, 16, v68
v_lshl_or_b32 v75, v71, 16, v70
s_nop 1
v_mfma_f32_16x16x32_bf16 v[116:119], v[72:75], v[168:171], v[116:119]
buffer_load_ushort v64, v180, s[16:19], s50 offen offset:192
buffer_load_ushort v65, v180, s[16:19], s50 offen offset:704
buffer_load_ushort v66, v180, s[16:19], s50 offen offset:1216
buffer_load_ushort v67, v180, s[16:19], s50 offen offset:1728
buffer_load_ushort v68, v180, s[16:19], s51 offen offset:192
buffer_load_ushort v69, v180, s[16:19], s51 offen offset:704
buffer_load_ushort v70, v180, s[16:19], s51 offen offset:1216
buffer_load_ushort v71, v180, s[16:19], s51 offen offset:1728
s_waitcnt vmcnt(0)
v_lshl_or_b32 v72, v65, 16, v64
v_lshl_or_b32 v73, v67, 16, v66
v_lshl_or_b32 v74, v69, 16, v68
v_lshl_or_b32 v75, v71, 16, v70
s_nop 1
v_mfma_f32_16x16x32_bf16 v[120:123], v[72:75], v[168:171], v[120:123]
buffer_load_ushort v64, v180, s[16:19], s50 offen offset:224
buffer_load_ushort v65, v180, s[16:19], s50 offen offset:736
buffer_load_ushort v66, v180, s[16:19], s50 offen offset:1248
buffer_load_ushort v67, v180, s[16:19], s50 offen offset:1760
buffer_load_ushort v68, v180, s[16:19], s51 offen offset:224
buffer_load_ushort v69, v180, s[16:19], s51 offen offset:736
buffer_load_ushort v70, v180, s[16:19], s51 offen offset:1248
buffer_load_ushort v71, v180, s[16:19], s51 offen offset:1760
s_waitcnt vmcnt(0)
v_lshl_or_b32 v72, v65, 16, v64
v_lshl_or_b32 v73, v67, 16, v66
v_lshl_or_b32 v74, v69, 16, v68
v_lshl_or_b32 v75, v71, 16, v70
s_nop 1
v_mfma_f32_16x16x32_bf16 v[124:127], v[72:75], v[168:171], v[124:127]
buffer_load_ushort v64, v180, s[16:19], s50 offen offset:256
buffer_load_ushort v65, v180, s[16:19], s50 offen offset:768
buffer_load_ushort v66, v180, s[16:19], s50 offen offset:1280
buffer_load_ushort v67, v180, s[16:19], s50 offen offset:1792
buffer_load_ushort v68, v180, s[16:19], s51 offen offset:256
buffer_load_ushort v69, v180, s[16:19], s51 offen offset:768
buffer_load_ushort v70, v180, s[16:19], s51 offen offset:1280
buffer_load_ushort v71, v180, s[16:19], s51 offen offset:1792
s_waitcnt vmcnt(0)
v_lshl_or_b32 v72, v65, 16, v64
v_lshl_or_b32 v73, v67, 16, v66
v_lshl_or_b32 v74, v69, 16, v68
v_lshl_or_b32 v75, v71, 16, v70
s_nop 1
v_mfma_f32_16x16x32_bf16 v[128:131], v[72:75], v[168:171], v[128:131]
buffer_load_ushort v64, v180, s[16:19], s50 offen offset:288
buffer_load_ushort v65, v180, s[16:19], s50 offen offset:800
buffer_load_ushort v66, v180, s[16:19], s50 offen offset:1312
buffer_load_ushort v67, v180, s[16:19], s50 offen offset:1824
buffer_load_ushort v68, v180, s[16:19], s51 offen offset:288
buffer_load_ushort v69, v180, s[16:19], s51 offen offset:800
buffer_load_ushort v70, v180, s[16:19], s51 offen offset:1312
buffer_load_ushort v71, v180, s[16:19], s51 offen offset:1824
s_waitcnt vmcnt(0)
v_lshl_or_b32 v72, v65, 16, v64
v_lshl_or_b32 v73, v67, 16, v66
v_lshl_or_b32 v74, v69, 16, v68
v_lshl_or_b32 v75, v71, 16, v70
s_nop 1
v_mfma_f32_16x16x32_bf16 v[132:135], v[72:75], v[168:171], v[132:135]
buffer_load_ushort v64, v180, s[16:19], s50 offen offset:320
buffer_load_ushort v65, v180, s[16:19], s50 offen offset:832
buffer_load_ushort v66, v180, s[16:19], s50 offen offset:1344
buffer_load_ushort v67, v180, s[16:19], s50 offen offset:1856
buffer_load_ushort v68, v180, s[16:19], s51 offen offset:320
buffer_load_ushort v69, v180, s[16:19], s51 offen offset:832
buffer_load_ushort v70, v180, s[16:19], s51 offen offset:1344
buffer_load_ushort v71, v180, s[16:19], s51 offen offset:1856
s_waitcnt vmcnt(0)
v_lshl_or_b32 v72, v65, 16, v64
v_lshl_or_b32 v73, v67, 16, v66
v_lshl_or_b32 v74, v69, 16, v68
v_lshl_or_b32 v75, v71, 16, v70
s_nop 1
v_mfma_f32_16x16x32_bf16 v[136:139], v[72:75], v[168:171], v[136:139]
buffer_load_ushort v64, v180, s[16:19], s50 offen offset:352
buffer_load_ushort v65, v180, s[16:19], s50 offen offset:864
buffer_load_ushort v66, v180, s[16:19], s50 offen offset:1376
buffer_load_ushort v67, v180, s[16:19], s50 offen offset:1888
buffer_load_ushort v68, v180, s[16:19], s51 offen offset:352
buffer_load_ushort v69, v180, s[16:19], s51 offen offset:864
buffer_load_ushort v70, v180, s[16:19], s51 offen offset:1376
buffer_load_ushort v71, v180, s[16:19], s51 offen offset:1888
s_waitcnt vmcnt(0)
v_lshl_or_b32 v72, v65, 16, v64
v_lshl_or_b32 v73, v67, 16, v66
v_lshl_or_b32 v74, v69, 16, v68
v_lshl_or_b32 v75, v71, 16, v70
s_nop 1
v_mfma_f32_16x16x32_bf16 v[140:143], v[72:75], v[168:171], v[140:143]
buffer_load_ushort v64, v180, s[16:19], s50 offen offset:384
buffer_load_ushort v65, v180, s[16:19], s50 offen offset:896
buffer_load_ushort v66, v180, s[16:19], s50 offen offset:1408
buffer_load_ushort v67, v180, s[16:19], s50 offen offset:1920
buffer_load_ushort v68, v180, s[16:19], s51 offen offset:384
buffer_load_ushort v69, v180, s[16:19], s51 offen offset:896
buffer_load_ushort v70, v180, s[16:19], s51 offen offset:1408
buffer_load_ushort v71, v180, s[16:19], s51 offen offset:1920
s_waitcnt vmcnt(0)
v_lshl_or_b32 v72, v65, 16, v64
v_lshl_or_b32 v73, v67, 16, v66
v_lshl_or_b32 v74, v69, 16, v68
v_lshl_or_b32 v75, v71, 16, v70
s_nop 1
v_mfma_f32_16x16x32_bf16 v[144:147], v[72:75], v[168:171], v[144:147]
buffer_load_ushort v64, v180, s[16:19], s50 offen offset:416
buffer_load_ushort v65, v180, s[16:19], s50 offen offset:928
buffer_load_ushort v66, v180, s[16:19], s50 offen offset:1440
buffer_load_ushort v67, v180, s[16:19], s50 offen offset:1952
buffer_load_ushort v68, v180, s[16:19], s51 offen offset:416
buffer_load_ushort v69, v180, s[16:19], s51 offen offset:928
buffer_load_ushort v70, v180, s[16:19], s51 offen offset:1440
buffer_load_ushort v71, v180, s[16:19], s51 offen offset:1952
s_waitcnt vmcnt(0)
v_lshl_or_b32 v72, v65, 16, v64
v_lshl_or_b32 v73, v67, 16, v66
v_lshl_or_b32 v74, v69, 16, v68
v_lshl_or_b32 v75, v71, 16, v70
s_nop 1
v_mfma_f32_16x16x32_bf16 v[148:151], v[72:75], v[168:171], v[148:151]
buffer_load_ushort v64, v180, s[16:19], s50 offen offset:448
buffer_load_ushort v65, v180, s[16:19], s50 offen offset:960
buffer_load_ushort v66, v180, s[16:19], s50 offen offset:1472
buffer_load_ushort v67, v180, s[16:19], s50 offen offset:1984
buffer_load_ushort v68, v180, s[16:19], s51 offen offset:448
buffer_load_ushort v69, v180, s[16:19], s51 offen offset:960
buffer_load_ushort v70, v180, s[16:19], s51 offen offset:1472
buffer_load_ushort v71, v180, s[16:19], s51 offen offset:1984
s_waitcnt vmcnt(0)
v_lshl_or_b32 v72, v65, 16, v64
v_lshl_or_b32 v73, v67, 16, v66
v_lshl_or_b32 v74, v69, 16, v68
v_lshl_or_b32 v75, v71, 16, v70
s_nop 1
v_mfma_f32_16x16x32_bf16 v[152:155], v[72:75], v[168:171], v[152:155]
buffer_load_ushort v64, v180, s[16:19], s50 offen offset:480
buffer_load_ushort v65, v180, s[16:19], s50 offen offset:992
buffer_load_ushort v66, v180, s[16:19], s50 offen offset:1504
buffer_load_ushort v67, v180, s[16:19], s50 offen offset:2016
buffer_load_ushort v68, v180, s[16:19], s51 offen offset:480
buffer_load_ushort v69, v180, s[16:19], s51 offen offset:992
buffer_load_ushort v70, v180, s[16:19], s51 offen offset:1504
buffer_load_ushort v71, v180, s[16:19], s51 offen offset:2016
s_waitcnt vmcnt(0)
v_lshl_or_b32 v72, v65, 16, v64
v_lshl_or_b32 v73, v67, 16, v66
v_lshl_or_b32 v74, v69, 16, v68
v_lshl_or_b32 v75, v71, 16, v70
s_nop 1
v_mfma_f32_16x16x32_bf16 v[156:159], v[72:75], v[168:171], v[156:159]
s_sub_u32 s49, s49, 1
s_cmp_lg_u32 s49, 0
s_cbranch_scc1 L_slow_pv
s_nop 1
v_mov_b32 v178, v177
s_nop 1
v_permlane32_swap_b32 v177, v178
s_nop 1
v_add_f32 v177, v177, v178
s_nop 1
v_mov_b32 v178, v177
s_nop 1
v_permlane16_swap_b32 v177, v178
s_nop 1
v_add_f32 v177, v177, v178
v_rcp_f32 v177, v177
s_nop 7
v_mul_f32 v96, v96, v177
v_mul_f32 v97, v97, v177
v_mul_f32 v98, v98, v177
v_mul_f32 v99, v99, v177
v_cvt_pk_bf16_f32 v96, v96, v97
v_cvt_pk_bf16_f32 v97, v98, v99
buffer_store_dwordx2 v[96:97], v181, s[20:23], s47 offen offset:0
v_mul_f32 v100, v100, v177
v_mul_f32 v101, v101, v177
v_mul_f32 v102, v102, v177
v_mul_f32 v103, v103, v177
v_cvt_pk_bf16_f32 v100, v100, v101
v_cvt_pk_bf16_f32 v101, v102, v103
buffer_store_dwordx2 v[100:101], v181, s[20:23], s47 offen offset:32
v_mul_f32 v104, v104, v177
v_mul_f32 v105, v105, v177
v_mul_f32 v106, v106, v177
v_mul_f32 v107, v107, v177
v_cvt_pk_bf16_f32 v104, v104, v105
v_cvt_pk_bf16_f32 v105, v106, v107
buffer_store_dwordx2 v[104:105], v181, s[20:23], s47 offen offset:64
v_mul_f32 v108, v108, v177
v_mul_f32 v109, v109, v177
v_mul_f32 v110, v110, v177
v_mul_f32 v111, v111, v177
v_cvt_pk_bf16_f32 v108, v108, v109
v_cvt_pk_bf16_f32 v109, v110, v111
buffer_store_dwordx2 v[108:109], v181, s[20:23], s47 offen offset:96
v_mul_f32 v112, v112, v177
v_mul_f32 v113, v113, v177
v_mul_f32 v114, v114, v177
v_mul_f32 v115, v115, v177
v_cvt_pk_bf16_f32 v112, v112, v113
v_cvt_pk_bf16_f32 v113, v114, v115
buffer_store_dwordx2 v[112:113], v181, s[20:23], s47 offen offset:128
v_mul_f32 v116, v116, v177
v_mul_f32 v117, v117, v177
v_mul_f32 v118, v118, v177
v_mul_f32 v119, v119, v177
v_cvt_pk_bf16_f32 v116, v116, v117
v_cvt_pk_bf16_f32 v117, v118, v119
buffer_store_dwordx2 v[116:117], v181, s[20:23], s47 offen offset:160
v_mul_f32 v120, v120, v177
v_mul_f32 v121, v121, v177
v_mul_f32 v122, v122, v177
v_mul_f32 v123, v123, v177
v_cvt_pk_bf16_f32 v120, v120, v121
v_cvt_pk_bf16_f32 v121, v122, v123
buffer_store_dwordx2 v[120:121], v181, s[20:23], s47 offen offset:192
v_mul_f32 v124, v124, v177
v_mul_f32 v125, v125, v177
v_mul_f32 v126, v126, v177
v_mul_f32 v127, v127, v177
v_cvt_pk_bf16_f32 v124, v124, v125
v_cvt_pk_bf16_f32 v125, v126, v127
buffer_store_dwordx2 v[124:125], v181, s[20:23], s47 offen offset:224
v_mul_f32 v128, v128, v177
v_mul_f32 v129, v129, v177
v_mul_f32 v130, v130, v177
v_mul_f32 v131, v131, v177
v_cvt_pk_bf16_f32 v128, v128, v129
v_cvt_pk_bf16_f32 v129, v130, v131
buffer_store_dwordx2 v[128:129], v181, s[20:23], s47 offen offset:256
v_mul_f32 v132, v132, v177
v_mul_f32 v133, v133, v177
v_mul_f32 v134, v134, v177
v_mul_f32 v135, v135, v177
v_cvt_pk_bf16_f32 v132, v132, v133
v_cvt_pk_bf16_f32 v133, v134, v135
buffer_store_dwordx2 v[132:133], v181, s[20:23], s47 offen offset:288
v_mul_f32 v136, v136, v177
v_mul_f32 v137, v137, v177
v_mul_f32 v138, v138, v177
v_mul_f32 v139, v139, v177
v_cvt_pk_bf16_f32 v136, v136, v137
v_cvt_pk_bf16_f32 v137, v138, v139
buffer_store_dwordx2 v[136:137], v181, s[20:23], s47 offen offset:320
v_mul_f32 v140, v140, v177
v_mul_f32 v141, v141, v177
v_mul_f32 v142, v142, v177
v_mul_f32 v143, v143, v177
v_cvt_pk_bf16_f32 v140, v140, v141
v_cvt_pk_bf16_f32 v141, v142, v143
buffer_store_dwordx2 v[140:141], v181, s[20:23], s47 offen offset:352
v_mul_f32 v144, v144, v177
v_mul_f32 v145, v145, v177
v_mul_f32 v146, v146, v177
v_mul_f32 v147, v147, v177
v_cvt_pk_bf16_f32 v144, v144, v145
v_cvt_pk_bf16_f32 v145, v146, v147
buffer_store_dwordx2 v[144:145], v181, s[20:23], s47 offen offset:384
v_mul_f32 v148, v148, v177
v_mul_f32 v149, v149, v177
v_mul_f32 v150, v150, v177
v_mul_f32 v151, v151, v177
v_cvt_pk_bf16_f32 v148, v148, v149
v_cvt_pk_bf16_f32 v149, v150, v151
buffer_store_dwordx2 v[148:149], v181, s[20:23], s47 offen offset:416
v_mul_f32 v152, v152, v177
v_mul_f32 v153, v153, v177
v_mul_f32 v154, v154, v177
v_mul_f32 v155, v155, v177
v_cvt_pk_bf16_f32 v152, v152, v153
v_cvt_pk_bf16_f32 v153, v154, v155
buffer_store_dwordx2 v[152:153], v181, s[20:23], s47 offen offset:448
v_mul_f32 v156, v156, v177
v_mul_f32 v157, v157, v177
v_mul_f32 v158, v158, v177
v_mul_f32 v159, v159, v177
v_cvt_pk_bf16_f32 v156, v156, v157
v_cvt_pk_bf16_f32 v157, v158, v159
buffer_store_dwordx2 v[156:157], v181, s[20:23], s47 offen offset:480
s_waitcnt vmcnt(0)
s_add_u32 s46, s46, 1
s_add_u32 s47, s47, 8192
s_cmp_lt_u32 s46, s40
s_cbranch_scc1 L_slow_tile
s_branch L_next
.section .rodata,"a"
.p2align 6
.amdhsa_kernel standalone__mha_softmax__near_ridge_kernel
  .amdhsa_next_free_vgpr 512
  .amdhsa_next_free_sgpr 102
  .amdhsa_accum_offset 256
  .amdhsa_group_segment_fixed_size 0
  .amdhsa_kernarg_size 48
  .amdhsa_user_sgpr_count 2
  .amdhsa_user_sgpr_kernarg_segment_ptr 1
  .amdhsa_system_sgpr_workgroup_id_x 1
.end_amdhsa_kernel
```
